```python
import torch

def _softmax(x, axis=-1):
    return torch.softmax(x, dim=axis)

def _gelu(x):
    return torch.nn.functional.gelu(x, approximate='tanh')

def _silu(x):
    return torch.nn.functional.silu(x)

def _sigmoid(x):
    return torch.sigmoid(x)

def _layernorm(x, axis=-1, eps=1e-05):
    m = x.mean(dim=axis, keepdim=True)
    v = x.var(dim=axis, keepdim=True, unbiased=False)
    return (x - m) / torch.sqrt(v + eps)

def _scatter_add(tgt, idx, src, axis=0):
    return tgt.clone().index_add_(axis, idx, src)

def _segment_sum(src, seg, n):
    out = torch.zeros((n,) + src.shape[1:], dtype=src.dtype)
    return out.index_add_(0, seg, src)

def _pad(x, pw):
    flat = tuple((v for pair in reversed(pw) for v in pair))
    return torch.nn.functional.pad(x, flat)
kernel_name = 'gated_mix__memory_aug_recurrent_mem_tr__sliding_block__prompt'

def setup_inputs():

    _w = lambda a: (lambda t: t.to(torch.bfloat16) if t.is_floating_point() else t)(torch.as_tensor(a))

    def _A_setup():
        B, S, Dm = (1, 2048, 576)
        H, Dh = (32, 128)
        M, seg = (8, 32)
        seg = min(seg, S)
        S = S // seg * seg
        return {'x': _w((lambda *s: torch.randn(*s, dtype=torch.bfloat16) * 0.05)(B, S, Dm)), 'mem0': _w((lambda *s: torch.randn(*s, dtype=torch.bfloat16) * 1.6)(B, M, Dm)), 'Wq': _w((lambda *s: torch.randn(*s, dtype=torch.bfloat16) * 0.8)(Dm, H, Dh) * Dm ** (-0.5)), 'Wk': _w((lambda *s: torch.randn(*s, dtype=torch.bfloat16) * 0.8)(Dm, H, Dh) * Dm ** (-0.5)), 'Wv': _w((lambda *s: torch.randn(*s, dtype=torch.bfloat16) * 1.6)(Dm, H, Dh) * Dm ** (-0.5)), 'Wo': _w((lambda *s: torch.randn(*s, dtype=torch.bfloat16) * 1.6)(H, Dh, Dm) * (H * Dh) ** (-0.5)), 'seg_len': seg}
    _A_in = _A_setup()

    def _B_setup():
        B, S, D = (1, 2048, 576)
        return {'x': _w((lambda *s: torch.randn(*s, dtype=torch.bfloat16) * 0.05)(B, S, D)), 'wqkv': _w((lambda *s: torch.randn(*s, dtype=torch.bfloat16) * 1.6)(D, 3 * D)), 'wo': _w((lambda *s: torch.randn(*s, dtype=torch.bfloat16) * 0.05)(D, D))}
    _B_in = _B_setup()
    return {'A_x': _A_in['x'], 'A_mem0': _A_in['mem0'], 'A_Wq': _A_in['Wq'], 'A_Wk': _A_in['Wk'], 'A_Wv': _A_in['Wv'], 'A_Wo': _A_in['Wo'], 'A_seg_len': _A_in['seg_len'], 'B_x': _B_in['x'], 'B_wqkv': _B_in['wqkv'], 'B_wo': _B_in['wo'], 'gate_w': _w((lambda *s: torch.randn(*s, dtype=torch.bfloat16) * 0.05)(576) * 16.0)}

def reference(A_x, A_mem0, A_Wq, A_Wk, A_Wv, A_Wo, A_seg_len, B_x, B_wqkv, B_wo, gate_w):

    def _A_ref(x, mem0, Wq, Wk, Wv, Wo, seg_len):
        B, S, Dm = x.shape
        H, Dh = (Wq.shape[1], Wq.shape[2])
        M = mem0.shape[1]
        scale = Dh ** (-0.5)
        n_seg = S // seg_len
        L = M + seg_len
        idx = torch.arange(L)
        mask = (idx[:, None] < M) | (idx[:, None] >= idx[None, :])
        mem = mem0
        outs = []
        for s in range(n_seg):
            xs = x[:, s * seg_len:(s + 1) * seg_len, :].clone()
            h = torch.concatenate([mem, xs], axis=1)
            q = torch.einsum('btd,dhe->bhte', h, Wq)
            k = torch.einsum('btd,dhe->bhte', h, Wk)
            v = torch.einsum('btd,dhe->bhte', h, Wv)
            scores = torch.einsum('bhqe,bhke->bhqk', q, k) * scale
            scores = torch.where(mask[None, None], scores, -1000000000.0)
            p = _softmax(scores, axis=-1)
            o = torch.einsum('bhqk,bhke->bhqe', p, v)
            o = torch.einsum('bhte,hed->btd', o, Wo)
            mem = o[:, :M, :].clone()
            outs.append(o[:, M:, :])
        return torch.concatenate(outs, axis=1)

    def _B_ref(x, wqkv, wo):
        B, S, D = x.shape
        H = 32
        Dh = D // H
        W = 256
        qkv = (lambda x, *d: x.permute(*d))((x @ wqkv).reshape(B, S, 3, H, Dh), 2, 0, 3, 1, 4)
        q, k, v = (qkv[0], qkv[1], qkv[2])
        scores = torch.einsum('bhqd,bhkd->bhqk', q, k) * Dh ** (-0.5)
        idx = torch.arange(S)
        mask = (idx[:, None] - idx[None, :] >= 0) & (idx[:, None] - idx[None, :] < W)
        scores = torch.where(mask[None, None], scores, -1000000000.0)
        p = _softmax(scores, axis=-1)
        o = torch.einsum('bhqk,bhkd->bhqd', p, v)
        return (lambda x, *d: x.permute(*d))(o, 0, 2, 1, 3).reshape(B, S, D) @ wo
    x = A_x
    g = _sigmoid((x * gate_w).sum(-1, keepdims=True))
    a = _A_ref(x, A_mem0, A_Wq, A_Wk, A_Wv, A_Wo, A_seg_len)
    b = _B_ref(x, B_wqkv, B_wo)
    return g * a + (1 - g) * b
```

```asm
; @launch kernel=chain_kernel grid=(256,1,1) block=(256,1,1) lds=163840
.amdgcn_target "amdgcn-amd-amdhsa--gfx950"
.text
.globl chain_kernel
.p2align 8
.type chain_kernel,@function
chain_kernel:
    s_cmp_ge_u32 s2, 256
    s_cbranch_scc1 Lend_1
    s_load_dwordx16 s[64:79], s[0:1], 0
    s_load_dwordx8 s[80:87], s[0:1], 64
    s_load_dwordx4 s[88:91], s[0:1], 96
    s_waitcnt lgkmcnt(0)
    s_mov_b32 s12, s88
    s_and_b32 s13, s89, 0xffff
    s_mov_b32 s14, 256
    s_mov_b32 s15, 0x00020000
    s_mov_b32 s16, s90
    s_and_b32 s17, s91, 0xffff
    s_mov_b32 s18, 268435456
    s_mov_b32 s19, 0x00020000
    s_mov_b32 s20, s66
    s_and_b32 s21, s67, 0xffff
    s_mov_b32 s22, 9216
    s_mov_b32 s23, 0x00020000
    v_lshrrev_b32 v1, 6, v0
    s_nop 0
    v_readfirstlane_b32 s25, v1
    s_mov_b32 s36, 0x00ff00ff
    s_mov_b32 s37, 0x00ff00ff
    s_mov_b32 s38, -1
    s_mov_b32 s39, 0
    s_mov_b32 s42, -1
    s_mov_b32 s43, 0xffff
    s_mov_b32 s46, 0x3e0293ee
    s_mov_b32 s47, 0x3e0293ee
    s_cmp_lg_u32 s25, 0
    s_cbranch_scc1 Lz1_2
    s_mov_b64 exec, 1
    v_mov_b32 v1, 48
    v_mov_b32 v2, 1
    buffer_atomic_add v2, v1, s[12:15], 0 offen sc0
    v_mov_b32 v1, 162944
    s_waitcnt vmcnt(0)
    ds_write_b32 v1, v2
    s_waitcnt lgkmcnt(0)
    s_mov_b64 exec, -1
Lz1_2:
    s_barrier
    v_mov_b32 v1, 162944
    ds_read_b32 v2, v1
    s_waitcnt lgkmcnt(0)
    v_readfirstlane_b32 s4, v2
    s_barrier
    s_cmp_lg_u32 s4, 0
    s_nop 2
    s_cbranch_scc1 Lz2_3
    v_mov_b32 v4, 0
    v_mov_b32 v5, 0
    v_mov_b32 v6, 0
    v_mov_b32 v7, 0
    v_lshlrev_b32 v1, 4, v0
    s_mov_b32 s5, 98566144
    buffer_store_dwordx4 v[4:7], v1, s[16:19], s5 offen sc1
    s_mov_b32 s5, 98570240
    buffer_store_dwordx4 v[4:7], v1, s[16:19], s5 offen sc1
    s_mov_b32 s5, 98574336
    buffer_store_dwordx4 v[4:7], v1, s[16:19], s5 offen sc1
    s_mov_b32 s5, 98578432
    buffer_store_dwordx4 v[4:7], v1, s[16:19], s5 offen sc1
    s_mov_b32 s5, 98582528
    buffer_store_dwordx4 v[4:7], v1, s[16:19], s5 offen sc1
    s_mov_b32 s5, 98586624
    buffer_store_dwordx4 v[4:7], v1, s[16:19], s5 offen sc1
    s_waitcnt vmcnt(0)
    s_barrier
    s_cmp_lg_u32 s25, 0
    s_cbranch_scc1 Lz2_3
    s_mov_b64 exec, 1
    v_mov_b32 v1, 52
    v_mov_b32 v2, 1
    buffer_atomic_add v2, v1, s[12:15], 0 offen
    s_mov_b64 exec, -1
Lz2_3:
    s_cmp_lg_u32 s25, 0
    s_cbranch_scc1 Lrd_6
    s_mov_b64 exec, 1
    s_getreg_b32 s4, hwreg(HW_REG_XCC_ID)
    s_and_b32 s4, s4, 7
    s_lshl_b32 s5, s4, 2
    v_mov_b32 v1, s5
    v_mov_b32 v2, 1
    buffer_atomic_add v2, v1, s[12:15], 0 offen sc0
    s_waitcnt vmcnt(0)
    v_readfirstlane_b32 s5, v2
    s_mov_b32 s24, -1
    s_cmp_ge_u32 s5, 32
    s_nop 2
    s_cbranch_scc1 Lrs_7
    s_add_u32 s6, s4, 1
    s_cmp_lg_u32 s5, 31
    s_cbranch_scc1 Lrn_9
    v_mov_b32 v2, s6
    v_mov_b32 v3, 0
    v_mov_b32 v1, 32
    buffer_atomic_cmpswap v[2:3], v1, s[12:15], 0 offen sc0
    s_waitcnt vmcnt(0)
Lrn_9:
    s_mov_b32 s44, 0
    v_mov_b32 v1, 32
    s_nop 1
Lrp_8:
    buffer_load_dword v2, v1, s[12:15], 0 offen sc1
    s_waitcnt vmcnt(0)
    v_readfirstlane_b32 s7, v2
    s_add_u32 s44, s44, 1
    s_cmp_gt_u32 s44, 0x40000
    s_nop 2
    s_cbranch_scc1 Lrs_7
    s_cmp_eq_u32 s7, 0
    s_cbranch_scc1 Lrp_8
    s_cmp_eq_u32 s7, s6
    s_cselect_b32 s24, s5, -1
Lrs_7:
    v_mov_b32 v1, s24
    v_mov_b32 v2, 162944
    ds_write_b32 v2, v1
    s_waitcnt lgkmcnt(0)
    s_mov_b64 exec, -1
Lrd_6:
    s_barrier
    v_mov_b32 v2, 162944
    ds_read_b32 v1, v2
    s_waitcnt lgkmcnt(0)
    v_readfirstlane_b32 s24, v1
    s_cmp_lt_i32 s24, 0
    s_nop 3
    s_cbranch_scc1 Lworker
    s_mov_b32 s40, 0xff
    s_mov_b32 s41, 0
    v_mov_b32 v16, -1
    v_mov_b32 v17, -1
    v_mov_b32 v18, -1
    v_mov_b32 v19, -1
    s_lshl_b32 s4, s24, 14
    v_lshlrev_b32 v1, 4, v0
    v_add_u32 v1, s4, v1
    s_lshl_b32 s48, s24, 8
    v_and_b32 v2, 31, v0
    v_lshlrev_b32 v2, 3, v2
    v_add_u32 v2, s48, v2
    s_mov_b32 s5, 94371840
    buffer_store_dwordx4 v[16:19], v1, s[16:19], s5 offen
    s_mov_b32 s5, 94375936
    buffer_store_dwordx4 v[16:19], v1, s[16:19], s5 offen
    s_mov_b32 s5, 94380032
    buffer_store_dwordx4 v[16:19], v1, s[16:19], s5 offen
    s_mov_b32 s5, 94384128
    buffer_store_dwordx4 v[16:19], v1, s[16:19], s5 offen
    s_mov_b32 s5, 95420416
    buffer_store_dwordx4 v[16:19], v1, s[16:19], s5 offen
    s_mov_b32 s5, 95424512
    buffer_store_dwordx4 v[16:19], v1, s[16:19], s5 offen
    s_mov_b32 s5, 95428608
    buffer_store_dwordx4 v[16:19], v1, s[16:19], s5 offen
    s_mov_b32 s5, 95432704
    buffer_store_dwordx4 v[16:19], v1, s[16:19], s5 offen
    s_mov_b32 s5, 96468992
    buffer_store_dwordx2 v[16:17], v2, s[16:19], s5 offen
    s_mov_b32 s5, 96478208
    buffer_store_dwordx2 v[16:17], v2, s[16:19], s5 offen
    s_mov_b32 s5, 96487424
    buffer_store_dwordx2 v[16:17], v2, s[16:19], s5 offen
    s_cmp_ge_u32 s24, 4
    s_cbranch_scc1 Lc2_10
    s_mov_b32 s5, 94896128
    buffer_store_dwordx4 v[16:19], v1, s[16:19], s5 offen
    s_mov_b32 s5, 94900224
    buffer_store_dwordx4 v[16:19], v1, s[16:19], s5 offen
    s_mov_b32 s5, 94904320
    buffer_store_dwordx4 v[16:19], v1, s[16:19], s5 offen
    s_mov_b32 s5, 94908416
    buffer_store_dwordx4 v[16:19], v1, s[16:19], s5 offen
    s_mov_b32 s5, 95944704
    buffer_store_dwordx4 v[16:19], v1, s[16:19], s5 offen
    s_mov_b32 s5, 95948800
    buffer_store_dwordx4 v[16:19], v1, s[16:19], s5 offen
    s_mov_b32 s5, 95952896
    buffer_store_dwordx4 v[16:19], v1, s[16:19], s5 offen
    s_mov_b32 s5, 95956992
    buffer_store_dwordx4 v[16:19], v1, s[16:19], s5 offen
    s_mov_b32 s5, 96477184
    buffer_store_dwordx2 v[16:17], v2, s[16:19], s5 offen
    s_mov_b32 s5, 96486400
    buffer_store_dwordx2 v[16:17], v2, s[16:19], s5 offen
    s_mov_b32 s5, 96495616
    buffer_store_dwordx2 v[16:17], v2, s[16:19], s5 offen
Lc2_10:
    s_waitcnt vmcnt(0)
    s_barrier
    s_cmp_lg_u32 s25, 0
    s_cbranch_scc1 Lnr_11
    s_mov_b64 exec, 1
    v_mov_b32 v1, 36
    v_mov_b32 v2, 1
    buffer_atomic_add v2, v1, s[12:15], 0 offen
    s_mov_b64 exec, -1
Lnr_11:
    v_lshrrev_b32 v1, 4, v0
    v_and_b32 v2, 15, v0
    v_and_b32 v3, 3, v1
    v_bfe_u32 v6, v1, 3, 1
    v_lshl_add_u32 v3, v6, 2, v3
    v_lshrrev_b32 v6, 1, v2
    v_xor_b32 v3, v3, v6
    v_lshlrev_b32 v3, 5, v3
    v_and_b32 v6, 1, v2
    v_lshl_add_u32 v3, v6, 4, v3
    v_lshl_add_u32 v4, v1, 8, v3
    v_lshlrev_b32 v5, 13, v1
    v_lshl_add_u32 v5, v2, 4, v5
    s_lshl_b32 s4, s24, 8
    v_add_u32 v5, s4, v5
    v_bfe_u32 v6, v0, 4, 2
    v_bfe_u32 v7, v0, 2, 2
    v_and_b32 v8, 1, v6
    v_lshl_add_u32 v8, v8, 2, v7
    v_lshl_add_u32 v9, v6, 3, v7
    v_lshlrev_b32 v9, 8, v9
    v_and_b32 v10, 3, v0
    v_lshl_add_u32 v9, v10, 3, v9
    s_lshl_b32 s4, s25, 1
    s_add_u32 s5, s4, 0
    v_xor_b32 v10, s5, v8
    v_lshl_add_u32 v1, v10, 5, v9
    s_add_u32 s5, s4, 1
    v_xor_b32 v10, s5, v8
    v_lshl_add_u32 v2, v10, 5, v9
    s_mov_b32 s8, s68
    s_and_b32 s9, s69, 0xffff
    s_mov_b32 s10, 4718592
    s_mov_b32 s11, 0x00020000
    v_mov_b32 v11, v5
    buffer_load_dwordx4 v[112:115], v11, s[8:11], 0 offen
    v_add_u32 v11, 0x20000, v11
    buffer_load_dwordx4 v[116:119], v11, s[8:11], 0 offen
    v_add_u32 v11, 0x20000, v11
    buffer_load_dwordx4 v[120:123], v11, s[8:11], 0 offen
    v_add_u32 v11, 0x20000, v11
    buffer_load_dwordx4 v[124:127], v11, s[8:11], 0 offen
    v_add_u32 v11, 0x20000, v11
    buffer_load_dwordx4 v[128:131], v11, s[8:11], 0 offen
    v_add_u32 v11, 0x20000, v11
    buffer_load_dwordx4 v[132:135], v11, s[8:11], 0 offen
    v_add_u32 v11, 0x20000, v11
    buffer_load_dwordx4 v[136:139], v11, s[8:11], 0 offen
    v_add_u32 v11, 0x20000, v11
    buffer_load_dwordx4 v[140:143], v11, s[8:11], 0 offen
    v_add_u32 v11, 0x20000, v11
    buffer_load_dwordx4 v[144:147], v11, s[8:11], 0 offen
    v_add_u32 v11, 0x20000, v11
    buffer_load_dwordx4 v[148:151], v11, s[8:11], 0 offen
    v_add_u32 v11, 0x20000, v11
    buffer_load_dwordx4 v[152:155], v11, s[8:11], 0 offen
    v_add_u32 v11, 0x20000, v11
    buffer_load_dwordx4 v[156:159], v11, s[8:11], 0 offen
    v_add_u32 v11, 0x20000, v11
    buffer_load_dwordx4 v[160:163], v11, s[8:11], 0 offen
    v_add_u32 v11, 0x20000, v11
    buffer_load_dwordx4 v[164:167], v11, s[8:11], 0 offen
    v_add_u32 v11, 0x20000, v11
    buffer_load_dwordx4 v[168:171], v11, s[8:11], 0 offen
    v_add_u32 v11, 0x20000, v11
    buffer_load_dwordx4 v[172:175], v11, s[8:11], 0 offen
    v_add_u32 v11, 0x20000, v11
    buffer_load_dwordx4 v[176:179], v11, s[8:11], 0 offen
    v_add_u32 v11, 0x20000, v11
    buffer_load_dwordx4 v[180:183], v11, s[8:11], 0 offen
    v_add_u32 v11, 0x20000, v11
    buffer_load_dwordx4 v[184:187], v11, s[8:11], 0 offen
    v_add_u32 v11, 0x20000, v11
    buffer_load_dwordx4 v[188:191], v11, s[8:11], 0 offen
    v_add_u32 v11, 0x20000, v11
    buffer_load_dwordx4 v[192:195], v11, s[8:11], 0 offen
    v_add_u32 v11, 0x20000, v11
    buffer_load_dwordx4 v[196:199], v11, s[8:11], 0 offen
    v_add_u32 v11, 0x20000, v11
    buffer_load_dwordx4 v[200:203], v11, s[8:11], 0 offen
    v_add_u32 v11, 0x20000, v11
    buffer_load_dwordx4 v[204:207], v11, s[8:11], 0 offen
    v_add_u32 v11, 0x20000, v11
    buffer_load_dwordx4 v[208:211], v11, s[8:11], 0 offen
    v_add_u32 v11, 0x20000, v11
    buffer_load_dwordx4 v[212:215], v11, s[8:11], 0 offen
    v_add_u32 v11, 0x20000, v11
    buffer_load_dwordx4 v[216:219], v11, s[8:11], 0 offen
    v_add_u32 v11, 0x20000, v11
    buffer_load_dwordx4 v[220:223], v11, s[8:11], 0 offen
    v_add_u32 v11, 0x20000, v11
    buffer_load_dwordx4 v[224:227], v11, s[8:11], 0 offen
    v_add_u32 v11, 0x20000, v11
    buffer_load_dwordx4 v[228:231], v11, s[8:11], 0 offen
    v_add_u32 v11, 0x20000, v11
    buffer_load_dwordx4 v[232:235], v11, s[8:11], 0 offen
    v_add_u32 v11, 0x20000, v11
    buffer_load_dwordx4 v[236:239], v11, s[8:11], 0 offen
    v_add_u32 v11, 0x20000, v11
    buffer_load_dwordx4 v[240:243], v11, s[8:11], 0 offen
    v_add_u32 v11, 0x20000, v11
    buffer_load_dwordx4 v[244:247], v11, s[8:11], 0 offen
    v_add_u32 v11, 0x20000, v11
    buffer_load_dwordx4 v[248:251], v11, s[8:11], 0 offen
    v_add_u32 v11, 0x20000, v11
    buffer_load_dwordx4 v[252:255], v11, s[8:11], 0 offen
    v_add_u32 v11, 0x20000, v11
    s_mov_b32 s8, s72
    s_and_b32 s9, s73, 0xffff
    s_mov_b32 s10, 4718592
    s_mov_b32 s11, 0x00020000
    v_mov_b32 v11, v5
    buffer_load_dwordx4 a[144:147], v11, s[8:11], 0 offen
    v_add_u32 v11, 0x20000, v11
    buffer_load_dwordx4 a[148:151], v11, s[8:11], 0 offen
    v_add_u32 v11, 0x20000, v11
    buffer_load_dwordx4 a[152:155], v11, s[8:11], 0 offen
    v_add_u32 v11, 0x20000, v11
    buffer_load_dwordx4 a[156:159], v11, s[8:11], 0 offen
    v_add_u32 v11, 0x20000, v11
    buffer_load_dwordx4 a[160:163], v11, s[8:11], 0 offen
    v_add_u32 v11, 0x20000, v11
    buffer_load_dwordx4 a[164:167], v11, s[8:11], 0 offen
    v_add_u32 v11, 0x20000, v11
    buffer_load_dwordx4 a[168:171], v11, s[8:11], 0 offen
    v_add_u32 v11, 0x20000, v11
    buffer_load_dwordx4 a[172:175], v11, s[8:11], 0 offen
    v_add_u32 v11, 0x20000, v11
    buffer_load_dwordx4 a[176:179], v11, s[8:11], 0 offen
    v_add_u32 v11, 0x20000, v11
    buffer_load_dwordx4 a[180:183], v11, s[8:11], 0 offen
    v_add_u32 v11, 0x20000, v11
    buffer_load_dwordx4 a[184:187], v11, s[8:11], 0 offen
    v_add_u32 v11, 0x20000, v11
    buffer_load_dwordx4 a[188:191], v11, s[8:11], 0 offen
    v_add_u32 v11, 0x20000, v11
    buffer_load_dwordx4 a[192:195], v11, s[8:11], 0 offen
    v_add_u32 v11, 0x20000, v11
    buffer_load_dwordx4 a[196:199], v11, s[8:11], 0 offen
    v_add_u32 v11, 0x20000, v11
    buffer_load_dwordx4 a[200:203], v11, s[8:11], 0 offen
    v_add_u32 v11, 0x20000, v11
    buffer_load_dwordx4 a[204:207], v11, s[8:11], 0 offen
    v_add_u32 v11, 0x20000, v11
    buffer_load_dwordx4 a[208:211], v11, s[8:11], 0 offen
    v_add_u32 v11, 0x20000, v11
    buffer_load_dwordx4 a[212:215], v11, s[8:11], 0 offen
    v_add_u32 v11, 0x20000, v11
    buffer_load_dwordx4 a[216:219], v11, s[8:11], 0 offen
    v_add_u32 v11, 0x20000, v11
    buffer_load_dwordx4 a[220:223], v11, s[8:11], 0 offen
    v_add_u32 v11, 0x20000, v11
    buffer_load_dwordx4 a[224:227], v11, s[8:11], 0 offen
    v_add_u32 v11, 0x20000, v11
    buffer_load_dwordx4 a[228:231], v11, s[8:11], 0 offen
    v_add_u32 v11, 0x20000, v11
    buffer_load_dwordx4 a[232:235], v11, s[8:11], 0 offen
    v_add_u32 v11, 0x20000, v11
    buffer_load_dwordx4 a[236:239], v11, s[8:11], 0 offen
    v_add_u32 v11, 0x20000, v11
    buffer_load_dwordx4 a[240:243], v11, s[8:11], 0 offen
    v_add_u32 v11, 0x20000, v11
    buffer_load_dwordx4 a[244:247], v11, s[8:11], 0 offen
    v_add_u32 v11, 0x20000, v11
    buffer_load_dwordx4 a[248:251], v11, s[8:11], 0 offen
    v_add_u32 v11, 0x20000, v11
    buffer_load_dwordx4 a[252:255], v11, s[8:11], 0 offen
    v_add_u32 v11, 0x20000, v11
    buffer_load_dwordx4 v[80:83], v11, s[8:11], 0 offen
    v_add_u32 v11, 0x20000, v11
    buffer_load_dwordx4 v[84:87], v11, s[8:11], 0 offen
    v_add_u32 v11, 0x20000, v11
    buffer_load_dwordx4 v[88:91], v11, s[8:11], 0 offen
    v_add_u32 v11, 0x20000, v11
    buffer_load_dwordx4 v[92:95], v11, s[8:11], 0 offen
    v_add_u32 v11, 0x20000, v11
    buffer_load_dwordx4 v[96:99], v11, s[8:11], 0 offen
    v_add_u32 v11, 0x20000, v11
    buffer_load_dwordx4 v[100:103], v11, s[8:11], 0 offen
    v_add_u32 v11, 0x20000, v11
    buffer_load_dwordx4 v[104:107], v11, s[8:11], 0 offen
    v_add_u32 v11, 0x20000, v11
    buffer_load_dwordx4 v[108:111], v11, s[8:11], 0 offen
    v_add_u32 v11, 0x20000, v11
    v_mov_b32 v12, v4
    s_waitcnt vmcnt(63)
    ds_write_b128 v12, v[112:115]
    v_add_u32 v12, 0x1000, v12
    s_waitcnt vmcnt(63)
    ds_write_b128 v12, v[116:119]
    v_add_u32 v12, 0x1000, v12
    s_waitcnt vmcnt(63)
    ds_write_b128 v12, v[120:123]
    v_add_u32 v12, 0x1000, v12
    s_waitcnt vmcnt(63)
    ds_write_b128 v12, v[124:127]
    v_add_u32 v12, 0x1000, v12
    s_waitcnt vmcnt(63)
    ds_write_b128 v12, v[128:131]
    v_add_u32 v12, 0x1000, v12
    s_waitcnt vmcnt(63)
    ds_write_b128 v12, v[132:135]
    v_add_u32 v12, 0x1000, v12
    s_waitcnt vmcnt(63)
    ds_write_b128 v12, v[136:139]
    v_add_u32 v12, 0x1000, v12
    s_waitcnt vmcnt(63)
    ds_write_b128 v12, v[140:143]
    v_add_u32 v12, 0x1000, v12
    s_waitcnt vmcnt(63)
    ds_write_b128 v12, v[144:147]
    v_add_u32 v12, 0x1000, v12
    s_waitcnt vmcnt(62)
    ds_write_b128 v12, v[148:151]
    v_add_u32 v12, 0x1000, v12
    s_waitcnt vmcnt(61)
    ds_write_b128 v12, v[152:155]
    v_add_u32 v12, 0x1000, v12
    s_waitcnt vmcnt(60)
    ds_write_b128 v12, v[156:159]
    v_add_u32 v12, 0x1000, v12
    s_waitcnt vmcnt(59)
    ds_write_b128 v12, v[160:163]
    v_add_u32 v12, 0x1000, v12
    s_waitcnt vmcnt(58)
    ds_write_b128 v12, v[164:167]
    v_add_u32 v12, 0x1000, v12
    s_waitcnt vmcnt(57)
    ds_write_b128 v12, v[168:171]
    v_add_u32 v12, 0x1000, v12
    s_waitcnt vmcnt(56)
    ds_write_b128 v12, v[172:175]
    v_add_u32 v12, 0x1000, v12
    s_waitcnt vmcnt(55)
    ds_write_b128 v12, v[176:179]
    v_add_u32 v12, 0x1000, v12
    s_waitcnt vmcnt(54)
    ds_write_b128 v12, v[180:183]
    v_add_u32 v12, 0x1000, v12
    s_waitcnt vmcnt(53)
    ds_write_b128 v12, v[184:187]
    v_add_u32 v12, 0x1000, v12
    s_waitcnt vmcnt(52)
    ds_write_b128 v12, v[188:191]
    v_add_u32 v12, 0x1000, v12
    s_waitcnt vmcnt(51)
    ds_write_b128 v12, v[192:195]
    v_add_u32 v12, 0x1000, v12
    s_waitcnt vmcnt(50)
    ds_write_b128 v12, v[196:199]
    v_add_u32 v12, 0x1000, v12
    s_waitcnt vmcnt(49)
    ds_write_b128 v12, v[200:203]
    v_add_u32 v12, 0x1000, v12
    s_waitcnt vmcnt(48)
    ds_write_b128 v12, v[204:207]
    v_add_u32 v12, 0x1000, v12
    s_waitcnt vmcnt(47)
    ds_write_b128 v12, v[208:211]
    v_add_u32 v12, 0x1000, v12
    s_waitcnt vmcnt(46)
    ds_write_b128 v12, v[212:215]
    v_add_u32 v12, 0x1000, v12
    s_waitcnt vmcnt(45)
    ds_write_b128 v12, v[216:219]
    v_add_u32 v12, 0x1000, v12
    s_waitcnt vmcnt(44)
    ds_write_b128 v12, v[220:223]
    v_add_u32 v12, 0x1000, v12
    s_waitcnt vmcnt(43)
    ds_write_b128 v12, v[224:227]
    v_add_u32 v12, 0x1000, v12
    s_waitcnt vmcnt(42)
    ds_write_b128 v12, v[228:231]
    v_add_u32 v12, 0x1000, v12
    s_waitcnt vmcnt(41)
    ds_write_b128 v12, v[232:235]
    v_add_u32 v12, 0x1000, v12
    s_waitcnt vmcnt(40)
    ds_write_b128 v12, v[236:239]
    v_add_u32 v12, 0x1000, v12
    s_waitcnt vmcnt(39)
    ds_write_b128 v12, v[240:243]
    v_add_u32 v12, 0x1000, v12
    s_waitcnt vmcnt(38)
    ds_write_b128 v12, v[244:247]
    v_add_u32 v12, 0x1000, v12
    s_waitcnt vmcnt(37)
    ds_write_b128 v12, v[248:251]
    v_add_u32 v12, 0x1000, v12
    s_waitcnt vmcnt(36)
    ds_write_b128 v12, v[252:255]
    v_add_u32 v12, 0x1000, v12
    s_waitcnt lgkmcnt(0)
    s_barrier
    s_mov_b32 s8, s74
    s_and_b32 s9, s75, 0xffff
    s_mov_b32 s10, 4718592
    s_mov_b32 s11, 0x00020000
    s_mul_i32 s4, s24, 147456
    v_lshlrev_b32 v13, 4, v0
    v_add_u32 v11, s4, v13
    buffer_load_dwordx4 v[112:115], v11, s[8:11], 0 offen
    v_add_u32 v11, 0x1000, v11
    buffer_load_dwordx4 v[116:119], v11, s[8:11], 0 offen
    v_add_u32 v11, 0x1000, v11
    buffer_load_dwordx4 v[120:123], v11, s[8:11], 0 offen
    v_add_u32 v11, 0x1000, v11
    buffer_load_dwordx4 v[124:127], v11, s[8:11], 0 offen
    v_add_u32 v11, 0x1000, v11
    buffer_load_dwordx4 v[128:131], v11, s[8:11], 0 offen
    v_add_u32 v11, 0x1000, v11
    buffer_load_dwordx4 v[132:135], v11, s[8:11], 0 offen
    v_add_u32 v11, 0x1000, v11
    buffer_load_dwordx4 v[136:139], v11, s[8:11], 0 offen
    v_add_u32 v11, 0x1000, v11
    buffer_load_dwordx4 v[140:143], v11, s[8:11], 0 offen
    v_add_u32 v11, 0x1000, v11
    buffer_load_dwordx4 v[144:147], v11, s[8:11], 0 offen
    v_add_u32 v11, 0x1000, v11
    buffer_load_dwordx4 v[148:151], v11, s[8:11], 0 offen
    v_add_u32 v11, 0x1000, v11
    buffer_load_dwordx4 v[152:155], v11, s[8:11], 0 offen
    v_add_u32 v11, 0x1000, v11
    buffer_load_dwordx4 v[156:159], v11, s[8:11], 0 offen
    v_add_u32 v11, 0x1000, v11
    buffer_load_dwordx4 v[160:163], v11, s[8:11], 0 offen
    v_add_u32 v11, 0x1000, v11
    buffer_load_dwordx4 v[164:167], v11, s[8:11], 0 offen
    v_add_u32 v11, 0x1000, v11
    buffer_load_dwordx4 v[168:171], v11, s[8:11], 0 offen
    v_add_u32 v11, 0x1000, v11
    buffer_load_dwordx4 v[172:175], v11, s[8:11], 0 offen
    v_add_u32 v11, 0x1000, v11
    buffer_load_dwordx4 v[176:179], v11, s[8:11], 0 offen
    v_add_u32 v11, 0x1000, v11
    buffer_load_dwordx4 v[180:183], v11, s[8:11], 0 offen
    v_add_u32 v11, 0x1000, v11
    buffer_load_dwordx4 v[184:187], v11, s[8:11], 0 offen
    v_add_u32 v11, 0x1000, v11
    buffer_load_dwordx4 v[188:191], v11, s[8:11], 0 offen
    v_add_u32 v11, 0x1000, v11
    buffer_load_dwordx4 v[192:195], v11, s[8:11], 0 offen
    v_add_u32 v11, 0x1000, v11
    buffer_load_dwordx4 v[196:199], v11, s[8:11], 0 offen
    v_add_u32 v11, 0x1000, v11
    buffer_load_dwordx4 v[200:203], v11, s[8:11], 0 offen
    v_add_u32 v11, 0x1000, v11
    buffer_load_dwordx4 v[204:207], v11, s[8:11], 0 offen
    v_add_u32 v11, 0x1000, v11
    buffer_load_dwordx4 v[208:211], v11, s[8:11], 0 offen
    v_add_u32 v11, 0x1000, v11
    buffer_load_dwordx4 v[212:215], v11, s[8:11], 0 offen
    v_add_u32 v11, 0x1000, v11
    buffer_load_dwordx4 v[216:219], v11, s[8:11], 0 offen
    v_add_u32 v11, 0x1000, v11
    buffer_load_dwordx4 v[220:223], v11, s[8:11], 0 offen
    v_add_u32 v11, 0x1000, v11
    buffer_load_dwordx4 v[224:227], v11, s[8:11], 0 offen
    v_add_u32 v11, 0x1000, v11
    buffer_load_dwordx4 v[228:231], v11, s[8:11], 0 offen
    v_add_u32 v11, 0x1000, v11
    buffer_load_dwordx4 v[232:235], v11, s[8:11], 0 offen
    v_add_u32 v11, 0x1000, v11
    buffer_load_dwordx4 v[236:239], v11, s[8:11], 0 offen
    v_add_u32 v11, 0x1000, v11
    buffer_load_dwordx4 v[240:243], v11, s[8:11], 0 offen
    v_add_u32 v11, 0x1000, v11
    buffer_load_dwordx4 v[244:247], v11, s[8:11], 0 offen
    v_add_u32 v11, 0x1000, v11
    buffer_load_dwordx4 v[248:251], v11, s[8:11], 0 offen
    v_add_u32 v11, 0x1000, v11
    buffer_load_dwordx4 v[252:255], v11, s[8:11], 0 offen
    v_add_u32 v11, 0x1000, v11
    v_mov_b32 v11, v1
    v_mov_b32 v12, v2
    ds_read_b64_tr_b16 a[0:1], v11 offset:0
    ds_read_b64_tr_b16 a[2:3], v11 offset:1024
    ds_read_b64_tr_b16 a[4:5], v12 offset:0
    ds_read_b64_tr_b16 a[6:7], v12 offset:1024
    ds_read_b64_tr_b16 a[8:9], v11 offset:8192
    ds_read_b64_tr_b16 a[10:11], v11 offset:9216
    ds_read_b64_tr_b16 a[12:13], v12 offset:8192
    ds_read_b64_tr_b16 a[14:15], v12 offset:9216
    ds_read_b64_tr_b16 a[16:17], v11 offset:16384
    ds_read_b64_tr_b16 a[18:19], v11 offset:17408
    ds_read_b64_tr_b16 a[20:21], v12 offset:16384
    ds_read_b64_tr_b16 a[22:23], v12 offset:17408
    ds_read_b64_tr_b16 a[24:25], v11 offset:24576
    ds_read_b64_tr_b16 a[26:27], v11 offset:25600
    ds_read_b64_tr_b16 a[28:29], v12 offset:24576
    ds_read_b64_tr_b16 a[30:31], v12 offset:25600
    ds_read_b64_tr_b16 a[32:33], v11 offset:32768
    ds_read_b64_tr_b16 a[34:35], v11 offset:33792
    ds_read_b64_tr_b16 a[36:37], v12 offset:32768
    ds_read_b64_tr_b16 a[38:39], v12 offset:33792
    ds_read_b64_tr_b16 a[40:41], v11 offset:40960
    ds_read_b64_tr_b16 a[42:43], v11 offset:41984
    ds_read_b64_tr_b16 a[44:45], v12 offset:40960
    ds_read_b64_tr_b16 a[46:47], v12 offset:41984
    ds_read_b64_tr_b16 a[48:49], v11 offset:49152
    ds_read_b64_tr_b16 a[50:51], v11 offset:50176
    ds_read_b64_tr_b16 a[52:53], v12 offset:49152
    ds_read_b64_tr_b16 a[54:55], v12 offset:50176
    ds_read_b64_tr_b16 a[56:57], v11 offset:57344
    ds_read_b64_tr_b16 a[58:59], v11 offset:58368
    ds_read_b64_tr_b16 a[60:61], v12 offset:57344
    ds_read_b64_tr_b16 a[62:63], v12 offset:58368
    v_add_u32 v11, 0x10000, v11
    v_add_u32 v12, 0x10000, v12
    ds_read_b64_tr_b16 a[64:65], v11 offset:0
    ds_read_b64_tr_b16 a[66:67], v11 offset:1024
    ds_read_b64_tr_b16 a[68:69], v12 offset:0
    ds_read_b64_tr_b16 a[70:71], v12 offset:1024
    ds_read_b64_tr_b16 a[72:73], v11 offset:8192
    ds_read_b64_tr_b16 a[74:75], v11 offset:9216
    ds_read_b64_tr_b16 a[76:77], v12 offset:8192
    ds_read_b64_tr_b16 a[78:79], v12 offset:9216
    ds_read_b64_tr_b16 a[80:81], v11 offset:16384
    ds_read_b64_tr_b16 a[82:83], v11 offset:17408
    ds_read_b64_tr_b16 a[84:85], v12 offset:16384
    ds_read_b64_tr_b16 a[86:87], v12 offset:17408
    ds_read_b64_tr_b16 a[88:89], v11 offset:24576
    ds_read_b64_tr_b16 a[90:91], v11 offset:25600
    ds_read_b64_tr_b16 a[92:93], v12 offset:24576
    ds_read_b64_tr_b16 a[94:95], v12 offset:25600
    ds_read_b64_tr_b16 a[96:97], v11 offset:32768
    ds_read_b64_tr_b16 a[98:99], v11 offset:33792
    ds_read_b64_tr_b16 a[100:101], v12 offset:32768
    ds_read_b64_tr_b16 a[102:103], v12 offset:33792
    ds_read_b64_tr_b16 a[104:105], v11 offset:40960
    ds_read_b64_tr_b16 a[106:107], v11 offset:41984
    ds_read_b64_tr_b16 a[108:109], v12 offset:40960
    ds_read_b64_tr_b16 a[110:111], v12 offset:41984
    ds_read_b64_tr_b16 a[112:113], v11 offset:49152
    ds_read_b64_tr_b16 a[114:115], v11 offset:50176
    ds_read_b64_tr_b16 a[116:117], v12 offset:49152
    ds_read_b64_tr_b16 a[118:119], v12 offset:50176
    ds_read_b64_tr_b16 a[120:121], v11 offset:57344
    ds_read_b64_tr_b16 a[122:123], v11 offset:58368
    ds_read_b64_tr_b16 a[124:125], v12 offset:57344
    ds_read_b64_tr_b16 a[126:127], v12 offset:58368
    v_add_u32 v11, 0x10000, v11
    v_add_u32 v12, 0x10000, v12
    ds_read_b64_tr_b16 a[128:129], v11 offset:0
    ds_read_b64_tr_b16 a[130:131], v11 offset:1024
    ds_read_b64_tr_b16 a[132:133], v12 offset:0
    ds_read_b64_tr_b16 a[134:135], v12 offset:1024
    ds_read_b64_tr_b16 a[136:137], v11 offset:8192
    ds_read_b64_tr_b16 a[138:139], v11 offset:9216
    ds_read_b64_tr_b16 a[140:141], v12 offset:8192
    ds_read_b64_tr_b16 a[142:143], v12 offset:9216
    s_waitcnt lgkmcnt(0)
    s_barrier
    v_mov_b32 v12, v4
    s_waitcnt vmcnt(63)
    ds_write_b128 v12, a[144:147]
    v_add_u32 v12, 0x1000, v12
    s_waitcnt vmcnt(63)
    ds_write_b128 v12, a[148:151]
    v_add_u32 v12, 0x1000, v12
    s_waitcnt vmcnt(63)
    ds_write_b128 v12, a[152:155]
    v_add_u32 v12, 0x1000, v12
    s_waitcnt vmcnt(63)
    ds_write_b128 v12, a[156:159]
    v_add_u32 v12, 0x1000, v12
    s_waitcnt vmcnt(63)
    ds_write_b128 v12, a[160:163]
    v_add_u32 v12, 0x1000, v12
    s_waitcnt vmcnt(63)
    ds_write_b128 v12, a[164:167]
    v_add_u32 v12, 0x1000, v12
    s_waitcnt vmcnt(63)
    ds_write_b128 v12, a[168:171]
    v_add_u32 v12, 0x1000, v12
    s_waitcnt vmcnt(63)
    ds_write_b128 v12, a[172:175]
    v_add_u32 v12, 0x1000, v12
    s_waitcnt vmcnt(63)
    ds_write_b128 v12, a[176:179]
    v_add_u32 v12, 0x1000, v12
    s_waitcnt vmcnt(62)
    ds_write_b128 v12, a[180:183]
    v_add_u32 v12, 0x1000, v12
    s_waitcnt vmcnt(61)
    ds_write_b128 v12, a[184:187]
    v_add_u32 v12, 0x1000, v12
    s_waitcnt vmcnt(60)
    ds_write_b128 v12, a[188:191]
    v_add_u32 v12, 0x1000, v12
    s_waitcnt vmcnt(59)
    ds_write_b128 v12, a[192:195]
    v_add_u32 v12, 0x1000, v12
    s_waitcnt vmcnt(58)
    ds_write_b128 v12, a[196:199]
    v_add_u32 v12, 0x1000, v12
    s_waitcnt vmcnt(57)
    ds_write_b128 v12, a[200:203]
    v_add_u32 v12, 0x1000, v12
    s_waitcnt vmcnt(56)
    ds_write_b128 v12, a[204:207]
    v_add_u32 v12, 0x1000, v12
    s_waitcnt vmcnt(55)
    ds_write_b128 v12, a[208:211]
    v_add_u32 v12, 0x1000, v12
    s_waitcnt vmcnt(54)
    ds_write_b128 v12, a[212:215]
    v_add_u32 v12, 0x1000, v12
    s_waitcnt vmcnt(53)
    ds_write_b128 v12, a[216:219]
    v_add_u32 v12, 0x1000, v12
    s_waitcnt vmcnt(52)
    ds_write_b128 v12, a[220:223]
    v_add_u32 v12, 0x1000, v12
    s_waitcnt vmcnt(51)
    ds_write_b128 v12, a[224:227]
    v_add_u32 v12, 0x1000, v12
    s_waitcnt vmcnt(50)
    ds_write_b128 v12, a[228:231]
    v_add_u32 v12, 0x1000, v12
    s_waitcnt vmcnt(49)
    ds_write_b128 v12, a[232:235]
    v_add_u32 v12, 0x1000, v12
    s_waitcnt vmcnt(48)
    ds_write_b128 v12, a[236:239]
    v_add_u32 v12, 0x1000, v12
    s_waitcnt vmcnt(47)
    ds_write_b128 v12, a[240:243]
    v_add_u32 v12, 0x1000, v12
    s_waitcnt vmcnt(46)
    ds_write_b128 v12, a[244:247]
    v_add_u32 v12, 0x1000, v12
    s_waitcnt vmcnt(45)
    ds_write_b128 v12, a[248:251]
    v_add_u32 v12, 0x1000, v12
    s_waitcnt vmcnt(44)
    ds_write_b128 v12, a[252:255]
    v_add_u32 v12, 0x1000, v12
    s_waitcnt vmcnt(43)
    ds_write_b128 v12, v[80:83]
    v_add_u32 v12, 0x1000, v12
    s_waitcnt vmcnt(42)
    ds_write_b128 v12, v[84:87]
    v_add_u32 v12, 0x1000, v12
    s_waitcnt vmcnt(41)
    ds_write_b128 v12, v[88:91]
    v_add_u32 v12, 0x1000, v12
    s_waitcnt vmcnt(40)
    ds_write_b128 v12, v[92:95]
    v_add_u32 v12, 0x1000, v12
    s_waitcnt vmcnt(39)
    ds_write_b128 v12, v[96:99]
    v_add_u32 v12, 0x1000, v12
    s_waitcnt vmcnt(38)
    ds_write_b128 v12, v[100:103]
    v_add_u32 v12, 0x1000, v12
    s_waitcnt vmcnt(37)
    ds_write_b128 v12, v[104:107]
    v_add_u32 v12, 0x1000, v12
    s_waitcnt vmcnt(36)
    ds_write_b128 v12, v[108:111]
    v_add_u32 v12, 0x1000, v12
    s_waitcnt lgkmcnt(0)
    s_barrier
    v_mov_b32 v11, v1
    v_mov_b32 v12, v2
    ds_read_b64_tr_b16 a[144:145], v11 offset:0
    ds_read_b64_tr_b16 a[146:147], v11 offset:1024
    ds_read_b64_tr_b16 a[148:149], v12 offset:0
    ds_read_b64_tr_b16 a[150:151], v12 offset:1024
    ds_read_b64_tr_b16 a[152:153], v11 offset:8192
    ds_read_b64_tr_b16 a[154:155], v11 offset:9216
    ds_read_b64_tr_b16 a[156:157], v12 offset:8192
    ds_read_b64_tr_b16 a[158:159], v12 offset:9216
    ds_read_b64_tr_b16 a[160:161], v11 offset:16384
    ds_read_b64_tr_b16 a[162:163], v11 offset:17408
    ds_read_b64_tr_b16 a[164:165], v12 offset:16384
    ds_read_b64_tr_b16 a[166:167], v12 offset:17408
    ds_read_b64_tr_b16 a[168:169], v11 offset:24576
    ds_read_b64_tr_b16 a[170:171], v11 offset:25600
    ds_read_b64_tr_b16 a[172:173], v12 offset:24576
    ds_read_b64_tr_b16 a[174:175], v12 offset:25600
    ds_read_b64_tr_b16 a[176:177], v11 offset:32768
    ds_read_b64_tr_b16 a[178:179], v11 offset:33792
    ds_read_b64_tr_b16 a[180:181], v12 offset:32768
    ds_read_b64_tr_b16 a[182:183], v12 offset:33792
    ds_read_b64_tr_b16 a[184:185], v11 offset:40960
    ds_read_b64_tr_b16 a[186:187], v11 offset:41984
    ds_read_b64_tr_b16 a[188:189], v12 offset:40960
    ds_read_b64_tr_b16 a[190:191], v12 offset:41984
    ds_read_b64_tr_b16 a[192:193], v11 offset:49152
    ds_read_b64_tr_b16 a[194:195], v11 offset:50176
    ds_read_b64_tr_b16 a[196:197], v12 offset:49152
    ds_read_b64_tr_b16 a[198:199], v12 offset:50176
    ds_read_b64_tr_b16 a[200:201], v11 offset:57344
    ds_read_b64_tr_b16 a[202:203], v11 offset:58368
    ds_read_b64_tr_b16 a[204:205], v12 offset:57344
    ds_read_b64_tr_b16 a[206:207], v12 offset:58368
    v_add_u32 v11, 0x10000, v11
    v_add_u32 v12, 0x10000, v12
    ds_read_b64_tr_b16 a[208:209], v11 offset:0
    ds_read_b64_tr_b16 a[210:211], v11 offset:1024
    ds_read_b64_tr_b16 a[212:213], v12 offset:0
    ds_read_b64_tr_b16 a[214:215], v12 offset:1024
    ds_read_b64_tr_b16 a[216:217], v11 offset:8192
    ds_read_b64_tr_b16 a[218:219], v11 offset:9216
    ds_read_b64_tr_b16 a[220:221], v12 offset:8192
    ds_read_b64_tr_b16 a[222:223], v12 offset:9216
    ds_read_b64_tr_b16 a[224:225], v11 offset:16384
    ds_read_b64_tr_b16 a[226:227], v11 offset:17408
    ds_read_b64_tr_b16 a[228:229], v12 offset:16384
    ds_read_b64_tr_b16 a[230:231], v12 offset:17408
    ds_read_b64_tr_b16 a[232:233], v11 offset:24576
    ds_read_b64_tr_b16 a[234:235], v11 offset:25600
    ds_read_b64_tr_b16 a[236:237], v12 offset:24576
    ds_read_b64_tr_b16 a[238:239], v12 offset:25600
    ds_read_b64_tr_b16 a[240:241], v11 offset:32768
    ds_read_b64_tr_b16 a[242:243], v11 offset:33792
    ds_read_b64_tr_b16 a[244:245], v12 offset:32768
    ds_read_b64_tr_b16 a[246:247], v12 offset:33792
    ds_read_b64_tr_b16 a[248:249], v11 offset:40960
    ds_read_b64_tr_b16 a[250:251], v11 offset:41984
    ds_read_b64_tr_b16 a[252:253], v12 offset:40960
    ds_read_b64_tr_b16 a[254:255], v12 offset:41984
    ds_read_b64_tr_b16 v[80:81], v11 offset:49152
    ds_read_b64_tr_b16 v[82:83], v11 offset:50176
    ds_read_b64_tr_b16 v[84:85], v12 offset:49152
    ds_read_b64_tr_b16 v[86:87], v12 offset:50176
    ds_read_b64_tr_b16 v[88:89], v11 offset:57344
    ds_read_b64_tr_b16 v[90:91], v11 offset:58368
    ds_read_b64_tr_b16 v[92:93], v12 offset:57344
    ds_read_b64_tr_b16 v[94:95], v12 offset:58368
    v_add_u32 v11, 0x10000, v11
    v_add_u32 v12, 0x10000, v12
    ds_read_b64_tr_b16 v[96:97], v11 offset:0
    ds_read_b64_tr_b16 v[98:99], v11 offset:1024
    ds_read_b64_tr_b16 v[100:101], v12 offset:0
    ds_read_b64_tr_b16 v[102:103], v12 offset:1024
    ds_read_b64_tr_b16 v[104:105], v11 offset:8192
    ds_read_b64_tr_b16 v[106:107], v11 offset:9216
    ds_read_b64_tr_b16 v[108:109], v12 offset:8192
    ds_read_b64_tr_b16 v[110:111], v12 offset:9216
    s_waitcnt lgkmcnt(0)
    s_barrier
    v_mov_b32 v12, v13
    s_waitcnt vmcnt(35)
    ds_write_b128 v12, v[112:115]
    v_add_u32 v12, 0x1000, v12
    s_waitcnt vmcnt(34)
    ds_write_b128 v12, v[116:119]
    v_add_u32 v12, 0x1000, v12
    s_waitcnt vmcnt(33)
    ds_write_b128 v12, v[120:123]
    v_add_u32 v12, 0x1000, v12
    s_waitcnt vmcnt(32)
    ds_write_b128 v12, v[124:127]
    v_add_u32 v12, 0x1000, v12
    s_waitcnt vmcnt(31)
    ds_write_b128 v12, v[128:131]
    v_add_u32 v12, 0x1000, v12
    s_waitcnt vmcnt(30)
    ds_write_b128 v12, v[132:135]
    v_add_u32 v12, 0x1000, v12
    s_waitcnt vmcnt(29)
    ds_write_b128 v12, v[136:139]
    v_add_u32 v12, 0x1000, v12
    s_waitcnt vmcnt(28)
    ds_write_b128 v12, v[140:143]
    v_add_u32 v12, 0x1000, v12
    s_waitcnt vmcnt(27)
    ds_write_b128 v12, v[144:147]
    v_add_u32 v12, 0x1000, v12
    s_waitcnt vmcnt(26)
    ds_write_b128 v12, v[148:151]
    v_add_u32 v12, 0x1000, v12
    s_waitcnt vmcnt(25)
    ds_write_b128 v12, v[152:155]
    v_add_u32 v12, 0x1000, v12
    s_waitcnt vmcnt(24)
    ds_write_b128 v12, v[156:159]
    v_add_u32 v12, 0x1000, v12
    s_waitcnt vmcnt(23)
    ds_write_b128 v12, v[160:163]
    v_add_u32 v12, 0x1000, v12
    s_waitcnt vmcnt(22)
    ds_write_b128 v12, v[164:167]
    v_add_u32 v12, 0x1000, v12
    s_waitcnt vmcnt(21)
    ds_write_b128 v12, v[168:171]
    v_add_u32 v12, 0x1000, v12
    s_waitcnt vmcnt(20)
    ds_write_b128 v12, v[172:175]
    v_add_u32 v12, 0x1000, v12
    s_waitcnt vmcnt(19)
    ds_write_b128 v12, v[176:179]
    v_add_u32 v12, 0x1000, v12
    s_waitcnt vmcnt(18)
    ds_write_b128 v12, v[180:183]
    v_add_u32 v12, 0x1000, v12
    s_waitcnt vmcnt(17)
    ds_write_b128 v12, v[184:187]
    v_add_u32 v12, 0x1000, v12
    s_waitcnt vmcnt(16)
    ds_write_b128 v12, v[188:191]
    v_add_u32 v12, 0x1000, v12
    s_waitcnt vmcnt(15)
    ds_write_b128 v12, v[192:195]
    v_add_u32 v12, 0x1000, v12
    s_waitcnt vmcnt(14)
    ds_write_b128 v12, v[196:199]
    v_add_u32 v12, 0x1000, v12
    s_waitcnt vmcnt(13)
    ds_write_b128 v12, v[200:203]
    v_add_u32 v12, 0x1000, v12
    s_waitcnt vmcnt(12)
    ds_write_b128 v12, v[204:207]
    v_add_u32 v12, 0x1000, v12
    s_waitcnt vmcnt(11)
    ds_write_b128 v12, v[208:211]
    v_add_u32 v12, 0x1000, v12
    s_waitcnt vmcnt(10)
    ds_write_b128 v12, v[212:215]
    v_add_u32 v12, 0x1000, v12
    s_waitcnt vmcnt(9)
    ds_write_b128 v12, v[216:219]
    v_add_u32 v12, 0x1000, v12
    s_waitcnt vmcnt(8)
    ds_write_b128 v12, v[220:223]
    v_add_u32 v12, 0x1000, v12
    s_waitcnt vmcnt(7)
    ds_write_b128 v12, v[224:227]
    v_add_u32 v12, 0x1000, v12
    s_waitcnt vmcnt(6)
    ds_write_b128 v12, v[228:231]
    v_add_u32 v12, 0x1000, v12
    s_waitcnt vmcnt(5)
    ds_write_b128 v12, v[232:235]
    v_add_u32 v12, 0x1000, v12
    s_waitcnt vmcnt(4)
    ds_write_b128 v12, v[236:239]
    v_add_u32 v12, 0x1000, v12
    s_waitcnt vmcnt(3)
    ds_write_b128 v12, v[240:243]
    v_add_u32 v12, 0x1000, v12
    s_waitcnt vmcnt(2)
    ds_write_b128 v12, v[244:247]
    v_add_u32 v12, 0x1000, v12
    s_waitcnt vmcnt(1)
    ds_write_b128 v12, v[248:251]
    v_add_u32 v12, 0x1000, v12
    s_waitcnt vmcnt(0)
    ds_write_b128 v12, v[252:255]
    v_add_u32 v12, 0x1000, v12
    s_waitcnt lgkmcnt(0)
    s_barrier
    v_bfe_u32 v6, v0, 4, 2
    v_bfe_u32 v7, v0, 2, 2
    v_lshl_add_u32 v9, v6, 2, v7
    v_mul_u32_u24 v9, 1152, v9
    v_and_b32 v10, 3, v0
    v_lshl_add_u32 v9, v10, 3, v9
    s_mul_i32 s4, s25, 288
    v_add_u32 v11, s4, v9
    ds_read_b64_tr_b16 v[112:113], v11 offset:0
    ds_read_b64_tr_b16 v[114:115], v11 offset:18432
    ds_read_b64_tr_b16 v[128:129], v11 offset:32
    ds_read_b64_tr_b16 v[130:131], v11 offset:18464
    ds_read_b64_tr_b16 v[144:145], v11 offset:64
    ds_read_b64_tr_b16 v[146:147], v11 offset:18496
    ds_read_b64_tr_b16 v[160:161], v11 offset:96
    ds_read_b64_tr_b16 v[162:163], v11 offset:18528
    ds_read_b64_tr_b16 v[176:177], v11 offset:128
    ds_read_b64_tr_b16 v[178:179], v11 offset:18560
    ds_read_b64_tr_b16 v[192:193], v11 offset:160
    ds_read_b64_tr_b16 v[194:195], v11 offset:18592
    ds_read_b64_tr_b16 v[208:209], v11 offset:192
    ds_read_b64_tr_b16 v[210:211], v11 offset:18624
    ds_read_b64_tr_b16 v[224:225], v11 offset:224
    ds_read_b64_tr_b16 v[226:227], v11 offset:18656
    ds_read_b64_tr_b16 v[240:241], v11 offset:256
    ds_read_b64_tr_b16 v[242:243], v11 offset:18688
    v_add_u32 v11, 36864, v11
    ds_read_b64_tr_b16 v[116:117], v11 offset:0
    ds_read_b64_tr_b16 v[118:119], v11 offset:18432
    ds_read_b64_tr_b16 v[132:133], v11 offset:32
    ds_read_b64_tr_b16 v[134:135], v11 offset:18464
    ds_read_b64_tr_b16 v[148:149], v11 offset:64
    ds_read_b64_tr_b16 v[150:151], v11 offset:18496
    ds_read_b64_tr_b16 v[164:165], v11 offset:96
    ds_read_b64_tr_b16 v[166:167], v11 offset:18528
    ds_read_b64_tr_b16 v[180:181], v11 offset:128
    ds_read_b64_tr_b16 v[182:183], v11 offset:18560
    ds_read_b64_tr_b16 v[196:197], v11 offset:160
    ds_read_b64_tr_b16 v[198:199], v11 offset:18592
    ds_read_b64_tr_b16 v[212:213], v11 offset:192
    ds_read_b64_tr_b16 v[214:215], v11 offset:18624
    ds_read_b64_tr_b16 v[228:229], v11 offset:224
    ds_read_b64_tr_b16 v[230:231], v11 offset:18656
    ds_read_b64_tr_b16 v[244:245], v11 offset:256
    ds_read_b64_tr_b16 v[246:247], v11 offset:18688
    v_add_u32 v11, 36864, v11
    ds_read_b64_tr_b16 v[120:121], v11 offset:0
    ds_read_b64_tr_b16 v[122:123], v11 offset:18432
    ds_read_b64_tr_b16 v[136:137], v11 offset:32
    ds_read_b64_tr_b16 v[138:139], v11 offset:18464
    ds_read_b64_tr_b16 v[152:153], v11 offset:64
    ds_read_b64_tr_b16 v[154:155], v11 offset:18496
    ds_read_b64_tr_b16 v[168:169], v11 offset:96
    ds_read_b64_tr_b16 v[170:171], v11 offset:18528
    ds_read_b64_tr_b16 v[184:185], v11 offset:128
    ds_read_b64_tr_b16 v[186:187], v11 offset:18560
    ds_read_b64_tr_b16 v[200:201], v11 offset:160
    ds_read_b64_tr_b16 v[202:203], v11 offset:18592
    ds_read_b64_tr_b16 v[216:217], v11 offset:192
    ds_read_b64_tr_b16 v[218:219], v11 offset:18624
    ds_read_b64_tr_b16 v[232:233], v11 offset:224
    ds_read_b64_tr_b16 v[234:235], v11 offset:18656
    ds_read_b64_tr_b16 v[248:249], v11 offset:256
    ds_read_b64_tr_b16 v[250:251], v11 offset:18688
    v_add_u32 v11, 36864, v11
    ds_read_b64_tr_b16 v[124:125], v11 offset:0
    ds_read_b64_tr_b16 v[126:127], v11 offset:18432
    ds_read_b64_tr_b16 v[140:141], v11 offset:32
    ds_read_b64_tr_b16 v[142:143], v11 offset:18464
    ds_read_b64_tr_b16 v[156:157], v11 offset:64
    ds_read_b64_tr_b16 v[158:159], v11 offset:18496
    ds_read_b64_tr_b16 v[172:173], v11 offset:96
    ds_read_b64_tr_b16 v[174:175], v11 offset:18528
    ds_read_b64_tr_b16 v[188:189], v11 offset:128
    ds_read_b64_tr_b16 v[190:191], v11 offset:18560
    ds_read_b64_tr_b16 v[204:205], v11 offset:160
    ds_read_b64_tr_b16 v[206:207], v11 offset:18592
    ds_read_b64_tr_b16 v[220:221], v11 offset:192
    ds_read_b64_tr_b16 v[222:223], v11 offset:18624
    ds_read_b64_tr_b16 v[236:237], v11 offset:224
    ds_read_b64_tr_b16 v[238:239], v11 offset:18656
    ds_read_b64_tr_b16 v[252:253], v11 offset:256
    ds_read_b64_tr_b16 v[254:255], v11 offset:18688
    v_add_u32 v11, 36864, v11
    s_waitcnt lgkmcnt(0)
    s_barrier
    s_mov_b32 s8, s70
    s_and_b32 s9, s71, 0xffff
    s_mov_b32 s10, 4718592
    s_mov_b32 s11, 0x00020000
    v_mov_b32 v6, v5
    v_add_u32 v7, 147456, v4
    v_add_u32 v1, 147456, v1
    v_add_u32 v2, 147456, v2
    v_and_b32 v3, 63, v0
    v_lshlrev_b32 v3, 4, v3
    s_mul_i32 s4, s25, 36864
    v_add_u32 v3, s4, v3
    buffer_load_dwordx4 v[16:19], v6, s[8:11], 0 offen
    v_add_u32 v6, 0x20000, v6
    buffer_load_dwordx4 v[20:23], v6, s[8:11], 0 offen
    v_add_u32 v6, 0x20000, v6
    buffer_load_dwordx4 v[24:27], v6, s[8:11], 0 offen
    v_add_u32 v6, 0x20000, v6
    buffer_load_dwordx4 v[28:31], v6, s[8:11], 0 offen
    v_add_u32 v6, 0x20000, v6
    buffer_load_dwordx4 v[32:35], v6, s[8:11], 0 offen
    v_add_u32 v6, 0x20000, v6
    buffer_load_dwordx4 v[36:39], v6, s[8:11], 0 offen
    v_add_u32 v6, 0x20000, v6
    buffer_load_dwordx4 v[40:43], v6, s[8:11], 0 offen
    v_add_u32 v6, 0x20000, v6
    buffer_load_dwordx4 v[44:47], v6, s[8:11], 0 offen
    v_add_u32 v6, 0x20000, v6
    buffer_load_dwordx4 v[48:51], v6, s[8:11], 0 offen
    v_add_u32 v6, 0x20000, v6
    buffer_load_dwordx4 v[52:55], v6, s[8:11], 0 offen
    v_add_u32 v6, 0x20000, v6
    buffer_load_dwordx4 v[56:59], v6, s[8:11], 0 offen
    v_add_u32 v6, 0x20000, v6
    buffer_load_dwordx4 v[60:63], v6, s[8:11], 0 offen
    v_add_u32 v6, 0x20000, v6
    buffer_load_dwordx4 v[64:67], v6, s[8:11], 0 offen
    v_add_u32 v6, 0x20000, v6
    buffer_load_dwordx4 v[68:71], v6, s[8:11], 0 offen
    v_add_u32 v6, 0x20000, v6
    buffer_load_dwordx4 v[72:75], v6, s[8:11], 0 offen
    v_add_u32 v6, 0x20000, v6
    buffer_load_dwordx4 v[76:79], v6, s[8:11], 0 offen
    v_add_u32 v6, 0x20000, v6
    s_waitcnt vmcnt(14)
    ds_write_b128 v7, v[16:19]
    ds_write_b128 v7, v[20:23] offset:4096
    s_waitcnt lgkmcnt(0)
    s_barrier
    ds_read_b64_tr_b16 v[8:9], v1 offset:0
    ds_read_b64_tr_b16 v[10:11], v1 offset:1024
    ds_read_b64_tr_b16 v[12:13], v2 offset:0
    ds_read_b64_tr_b16 v[14:15], v2 offset:1024
    s_waitcnt lgkmcnt(0)
    ds_write_b128 v3, v[8:11] offset:0
    ds_write_b128 v3, v[12:15] offset:1024
    s_waitcnt lgkmcnt(0)
    s_barrier
    s_waitcnt vmcnt(12)
    ds_write_b128 v7, v[24:27]
    ds_write_b128 v7, v[28:31] offset:4096
    s_waitcnt lgkmcnt(0)
    s_barrier
    ds_read_b64_tr_b16 v[8:9], v1 offset:0
    ds_read_b64_tr_b16 v[10:11], v1 offset:1024
    ds_read_b64_tr_b16 v[12:13], v2 offset:0
    ds_read_b64_tr_b16 v[14:15], v2 offset:1024
    s_waitcnt lgkmcnt(0)
    ds_write_b128 v3, v[8:11] offset:2048
    ds_write_b128 v3, v[12:15] offset:3072
    s_waitcnt lgkmcnt(0)
    s_barrier
    s_waitcnt vmcnt(10)
    ds_write_b128 v7, v[32:35]
    ds_write_b128 v7, v[36:39] offset:4096
    s_waitcnt lgkmcnt(0)
    s_barrier
    ds_read_b64_tr_b16 v[8:9], v1 offset:0
    ds_read_b64_tr_b16 v[10:11], v1 offset:1024
    ds_read_b64_tr_b16 v[12:13], v2 offset:0
    ds_read_b64_tr_b16 v[14:15], v2 offset:1024
    s_waitcnt lgkmcnt(0)
    ds_write_b128 v3, v[8:11] offset:4096
    ds_write_b128 v3, v[12:15] offset:5120
    s_waitcnt lgkmcnt(0)
    s_barrier
    s_waitcnt vmcnt(8)
    ds_write_b128 v7, v[40:43]
    ds_write_b128 v7, v[44:47] offset:4096
    s_waitcnt lgkmcnt(0)
    s_barrier
    ds_read_b64_tr_b16 v[8:9], v1 offset:0
    ds_read_b64_tr_b16 v[10:11], v1 offset:1024
    ds_read_b64_tr_b16 v[12:13], v2 offset:0
    ds_read_b64_tr_b16 v[14:15], v2 offset:1024
    s_waitcnt lgkmcnt(0)
    ds_write_b128 v3, v[8:11] offset:6144
    ds_write_b128 v3, v[12:15] offset:7168
    s_waitcnt lgkmcnt(0)
    s_barrier
    s_waitcnt vmcnt(6)
    ds_write_b128 v7, v[48:51]
    ds_write_b128 v7, v[52:55] offset:4096
    s_waitcnt lgkmcnt(0)
    s_barrier
    ds_read_b64_tr_b16 v[8:9], v1 offset:0
    ds_read_b64_tr_b16 v[10:11], v1 offset:1024
    ds_read_b64_tr_b16 v[12:13], v2 offset:0
    ds_read_b64_tr_b16 v[14:15], v2 offset:1024
    s_waitcnt lgkmcnt(0)
    ds_write_b128 v3, v[8:11] offset:8192
    ds_write_b128 v3, v[12:15] offset:9216
    s_waitcnt lgkmcnt(0)
    s_barrier
    s_waitcnt vmcnt(4)
    ds_write_b128 v7, v[56:59]
    ds_write_b128 v7, v[60:63] offset:4096
    s_waitcnt lgkmcnt(0)
    s_barrier
    ds_read_b64_tr_b16 v[8:9], v1 offset:0
    ds_read_b64_tr_b16 v[10:11], v1 offset:1024
    ds_read_b64_tr_b16 v[12:13], v2 offset:0
    ds_read_b64_tr_b16 v[14:15], v2 offset:1024
    s_waitcnt lgkmcnt(0)
    ds_write_b128 v3, v[8:11] offset:10240
    ds_write_b128 v3, v[12:15] offset:11264
    s_waitcnt lgkmcnt(0)
    s_barrier
    s_waitcnt vmcnt(2)
    ds_write_b128 v7, v[64:67]
    ds_write_b128 v7, v[68:71] offset:4096
    s_waitcnt lgkmcnt(0)
    s_barrier
    ds_read_b64_tr_b16 v[8:9], v1 offset:0
    ds_read_b64_tr_b16 v[10:11], v1 offset:1024
    ds_read_b64_tr_b16 v[12:13], v2 offset:0
    ds_read_b64_tr_b16 v[14:15], v2 offset:1024
    s_waitcnt lgkmcnt(0)
    ds_write_b128 v3, v[8:11] offset:12288
    ds_write_b128 v3, v[12:15] offset:13312
    s_waitcnt lgkmcnt(0)
    s_barrier
    s_waitcnt vmcnt(0)
    ds_write_b128 v7, v[72:75]
    ds_write_b128 v7, v[76:79] offset:4096
    s_waitcnt lgkmcnt(0)
    s_barrier
    ds_read_b64_tr_b16 v[8:9], v1 offset:0
    ds_read_b64_tr_b16 v[10:11], v1 offset:1024
    ds_read_b64_tr_b16 v[12:13], v2 offset:0
    ds_read_b64_tr_b16 v[14:15], v2 offset:1024
    s_waitcnt lgkmcnt(0)
    ds_write_b128 v3, v[8:11] offset:14336
    ds_write_b128 v3, v[12:15] offset:15360
    s_waitcnt lgkmcnt(0)
    s_barrier
    buffer_load_dwordx4 v[16:19], v6, s[8:11], 0 offen
    v_add_u32 v6, 0x20000, v6
    buffer_load_dwordx4 v[20:23], v6, s[8:11], 0 offen
    v_add_u32 v6, 0x20000, v6
    buffer_load_dwordx4 v[24:27], v6, s[8:11], 0 offen
    v_add_u32 v6, 0x20000, v6
    buffer_load_dwordx4 v[28:31], v6, s[8:11], 0 offen
    v_add_u32 v6, 0x20000, v6
    buffer_load_dwordx4 v[32:35], v6, s[8:11], 0 offen
    v_add_u32 v6, 0x20000, v6
    buffer_load_dwordx4 v[36:39], v6, s[8:11], 0 offen
    v_add_u32 v6, 0x20000, v6
    buffer_load_dwordx4 v[40:43], v6, s[8:11], 0 offen
    v_add_u32 v6, 0x20000, v6
    buffer_load_dwordx4 v[44:47], v6, s[8:11], 0 offen
    v_add_u32 v6, 0x20000, v6
    buffer_load_dwordx4 v[48:51], v6, s[8:11], 0 offen
    v_add_u32 v6, 0x20000, v6
    buffer_load_dwordx4 v[52:55], v6, s[8:11], 0 offen
    v_add_u32 v6, 0x20000, v6
    buffer_load_dwordx4 v[56:59], v6, s[8:11], 0 offen
    v_add_u32 v6, 0x20000, v6
    buffer_load_dwordx4 v[60:63], v6, s[8:11], 0 offen
    v_add_u32 v6, 0x20000, v6
    buffer_load_dwordx4 v[64:67], v6, s[8:11], 0 offen
    v_add_u32 v6, 0x20000, v6
    buffer_load_dwordx4 v[68:71], v6, s[8:11], 0 offen
    v_add_u32 v6, 0x20000, v6
    buffer_load_dwordx4 v[72:75], v6, s[8:11], 0 offen
    v_add_u32 v6, 0x20000, v6
    buffer_load_dwordx4 v[76:79], v6, s[8:11], 0 offen
    v_add_u32 v6, 0x20000, v6
    s_waitcnt vmcnt(14)
    ds_write_b128 v7, v[16:19]
    ds_write_b128 v7, v[20:23] offset:4096
    s_waitcnt lgkmcnt(0)
    s_barrier
    ds_read_b64_tr_b16 v[8:9], v1 offset:0
    ds_read_b64_tr_b16 v[10:11], v1 offset:1024
    ds_read_b64_tr_b16 v[12:13], v2 offset:0
    ds_read_b64_tr_b16 v[14:15], v2 offset:1024
    s_waitcnt lgkmcnt(0)
    ds_write_b128 v3, v[8:11] offset:16384
    ds_write_b128 v3, v[12:15] offset:17408
    s_waitcnt lgkmcnt(0)
    s_barrier
    s_waitcnt vmcnt(12)
    ds_write_b128 v7, v[24:27]
    ds_write_b128 v7, v[28:31] offset:4096
    s_waitcnt lgkmcnt(0)
    s_barrier
    ds_read_b64_tr_b16 v[8:9], v1 offset:0
    ds_read_b64_tr_b16 v[10:11], v1 offset:1024
    ds_read_b64_tr_b16 v[12:13], v2 offset:0
    ds_read_b64_tr_b16 v[14:15], v2 offset:1024
    s_waitcnt lgkmcnt(0)
    ds_write_b128 v3, v[8:11] offset:18432
    ds_write_b128 v3, v[12:15] offset:19456
    s_waitcnt lgkmcnt(0)
    s_barrier
    s_waitcnt vmcnt(10)
    ds_write_b128 v7, v[32:35]
    ds_write_b128 v7, v[36:39] offset:4096
    s_waitcnt lgkmcnt(0)
    s_barrier
    ds_read_b64_tr_b16 v[8:9], v1 offset:0
    ds_read_b64_tr_b16 v[10:11], v1 offset:1024
    ds_read_b64_tr_b16 v[12:13], v2 offset:0
    ds_read_b64_tr_b16 v[14:15], v2 offset:1024
    s_waitcnt lgkmcnt(0)
    ds_write_b128 v3, v[8:11] offset:20480
    ds_write_b128 v3, v[12:15] offset:21504
    s_waitcnt lgkmcnt(0)
    s_barrier
    s_waitcnt vmcnt(8)
    ds_write_b128 v7, v[40:43]
    ds_write_b128 v7, v[44:47] offset:4096
    s_waitcnt lgkmcnt(0)
    s_barrier
    ds_read_b64_tr_b16 v[8:9], v1 offset:0
    ds_read_b64_tr_b16 v[10:11], v1 offset:1024
    ds_read_b64_tr_b16 v[12:13], v2 offset:0
    ds_read_b64_tr_b16 v[14:15], v2 offset:1024
    s_waitcnt lgkmcnt(0)
    ds_write_b128 v3, v[8:11] offset:22528
    ds_write_b128 v3, v[12:15] offset:23552
    s_waitcnt lgkmcnt(0)
    s_barrier
    s_waitcnt vmcnt(6)
    ds_write_b128 v7, v[48:51]
    ds_write_b128 v7, v[52:55] offset:4096
    s_waitcnt lgkmcnt(0)
    s_barrier
    ds_read_b64_tr_b16 v[8:9], v1 offset:0
    ds_read_b64_tr_b16 v[10:11], v1 offset:1024
    ds_read_b64_tr_b16 v[12:13], v2 offset:0
    ds_read_b64_tr_b16 v[14:15], v2 offset:1024
    s_waitcnt lgkmcnt(0)
    ds_write_b128 v3, v[8:11] offset:24576
    ds_write_b128 v3, v[12:15] offset:25600
    s_waitcnt lgkmcnt(0)
    s_barrier
    s_waitcnt vmcnt(4)
    ds_write_b128 v7, v[56:59]
    ds_write_b128 v7, v[60:63] offset:4096
    s_waitcnt lgkmcnt(0)
    s_barrier
    ds_read_b64_tr_b16 v[8:9], v1 offset:0
    ds_read_b64_tr_b16 v[10:11], v1 offset:1024
    ds_read_b64_tr_b16 v[12:13], v2 offset:0
    ds_read_b64_tr_b16 v[14:15], v2 offset:1024
    s_waitcnt lgkmcnt(0)
    ds_write_b128 v3, v[8:11] offset:26624
    ds_write_b128 v3, v[12:15] offset:27648
    s_waitcnt lgkmcnt(0)
    s_barrier
    s_waitcnt vmcnt(2)
    ds_write_b128 v7, v[64:67]
    ds_write_b128 v7, v[68:71] offset:4096
    s_waitcnt lgkmcnt(0)
    s_barrier
    ds_read_b64_tr_b16 v[8:9], v1 offset:0
    ds_read_b64_tr_b16 v[10:11], v1 offset:1024
    ds_read_b64_tr_b16 v[12:13], v2 offset:0
    ds_read_b64_tr_b16 v[14:15], v2 offset:1024
    s_waitcnt lgkmcnt(0)
    ds_write_b128 v3, v[8:11] offset:28672
    ds_write_b128 v3, v[12:15] offset:29696
    s_waitcnt lgkmcnt(0)
    s_barrier
    s_waitcnt vmcnt(0)
    ds_write_b128 v7, v[72:75]
    ds_write_b128 v7, v[76:79] offset:4096
    s_waitcnt lgkmcnt(0)
    s_barrier
    ds_read_b64_tr_b16 v[8:9], v1 offset:0
    ds_read_b64_tr_b16 v[10:11], v1 offset:1024
    ds_read_b64_tr_b16 v[12:13], v2 offset:0
    ds_read_b64_tr_b16 v[14:15], v2 offset:1024
    s_waitcnt lgkmcnt(0)
    ds_write_b128 v3, v[8:11] offset:30720
    ds_write_b128 v3, v[12:15] offset:31744
    s_waitcnt lgkmcnt(0)
    s_barrier
    buffer_load_dwordx4 v[16:19], v6, s[8:11], 0 offen
    v_add_u32 v6, 0x20000, v6
    buffer_load_dwordx4 v[20:23], v6, s[8:11], 0 offen
    v_add_u32 v6, 0x20000, v6
    buffer_load_dwordx4 v[24:27], v6, s[8:11], 0 offen
    v_add_u32 v6, 0x20000, v6
    buffer_load_dwordx4 v[28:31], v6, s[8:11], 0 offen
    v_add_u32 v6, 0x20000, v6
    s_waitcnt vmcnt(2)
    ds_write_b128 v7, v[16:19]
    ds_write_b128 v7, v[20:23] offset:4096
    s_waitcnt lgkmcnt(0)
    s_barrier
    ds_read_b64_tr_b16 v[8:9], v1 offset:0
    ds_read_b64_tr_b16 v[10:11], v1 offset:1024
    ds_read_b64_tr_b16 v[12:13], v2 offset:0
    ds_read_b64_tr_b16 v[14:15], v2 offset:1024
    s_waitcnt lgkmcnt(0)
    ds_write_b128 v3, v[8:11] offset:32768
    ds_write_b128 v3, v[12:15] offset:33792
    s_waitcnt lgkmcnt(0)
    s_barrier
    s_waitcnt vmcnt(0)
    ds_write_b128 v7, v[24:27]
    ds_write_b128 v7, v[28:31] offset:4096
    s_waitcnt lgkmcnt(0)
    s_barrier
    ds_read_b64_tr_b16 v[8:9], v1 offset:0
    ds_read_b64_tr_b16 v[10:11], v1 offset:1024
    ds_read_b64_tr_b16 v[12:13], v2 offset:0
    ds_read_b64_tr_b16 v[14:15], v2 offset:1024
    s_waitcnt lgkmcnt(0)
    ds_write_b128 v3, v[8:11] offset:34816
    ds_write_b128 v3, v[12:15] offset:35840
    s_waitcnt lgkmcnt(0)
    s_barrier
    v_mov_b32 v1, v3
    v_mbcnt_lo_u32_b32 v12, -1, 0
    v_mbcnt_hi_u32_b32 v12, -1, v12
    v_and_b32 v13, 15, v12
    v_lshrrev_b32 v14, 4, v12
    v_and_b32 v15, 7, v12
    s_mul_i32 s4, s25, 9
    v_mul_u32_u24 v16, 3, v14
    v_add_u32 v16, s4, v16
    v_lshlrev_b32 v11, 8, v16
    v_lshl_add_u32 v11, v13, 4, v11
    v_lshrrev_b32 v17, 1, v13
    v_and_b32 v18, 1, v13
    v_lshlrev_b32 v19, 5, v16
    v_lshl_add_u32 v19, v18, 4, v19
    v_mul_u32_u24 v4, 1168, v17
    v_add_u32 v4, v4, v19
    v_add_u32 v4, 147456, v4
    v_mul_u32_u24 v20, 1152, v17
    v_add_u32 v20, v20, v19
    s_mov_b64 exec, s[42:43]
    buffer_load_dwordx4 v[24:27], v20, s[20:23], 0 offen offset:0
    buffer_load_dwordx4 v[28:31], v20, s[20:23], 0 offen offset:32
    buffer_load_dwordx4 v[32:35], v20, s[20:23], 0 offen offset:64
    s_waitcnt vmcnt(0)
    ds_write_b128 v4, v[24:27] offset:0
    ds_write_b128 v4, v[28:31] offset:32
    ds_write_b128 v4, v[32:35] offset:64
    s_mov_b64 exec, -1
    v_mul_u32_u24 v0, 1168, v15
    v_lshl_add_u32 v0, v14, 4, v0
    v_add_u32 v0, 147456, v0
    v_lshlrev_b32 v3, 4, v12
    v_lshl_add_u32 v8, v14, 3, v15
    v_lshlrev_b32 v8, 4, v8
    v_add_u32 v8, 156800, v8
    s_mul_i32 s4, s25, 1536
    v_add_u32 v7, s4, v8
    s_add_u32 s4, s25, 1
    s_and_b32 s4, s4, 3
    s_mul_i32 s4, s4, 1536
    v_add_u32 v5, s4, v8
    s_add_u32 s4, s25, 2
    s_and_b32 s4, s4, 3
    s_mul_i32 s57, s4, 1536
    s_add_u32 s4, s25, 3
    s_and_b32 s4, s4, 3
    s_mul_i32 s45, s4, 1536
    v_lshl_add_u32 v9, v15, 2, v14
    v_lshlrev_b32 v9, 4, v9
    v_lshrrev_b32 v16, 3, v13
    v_lshl_add_u32 v9, v16, 14, v9
    s_lshl_b32 s4, s24, 9
    v_add_u32 v9, s4, v9
    v_lshrrev_b32 v16, 3, v12
    v_lshlrev_b32 v10, 11, v16
    v_lshl_add_u32 v10, v15, 4, v10
    s_lshl_b32 s4, s24, 14
    s_lshl_b32 s5, s25, 7
    s_add_u32 s4, s4, s5
    v_add_u32 v10, s4, v10
    v_lshlrev_b32 v2, 3, v15
    s_lshl_b32 s4, s25, 6
    s_add_u32 s4, s4, s48
    v_add_u32 v2, s4, v2
    s_mul_i32 s4, s25, 9
    s_add_u32 s4, s4, 0
    s_lshl_b32 s5, s4, 14
    s_add_u32 s50, s5, 94371840
    s_mul_i32 s4, s25, 9
    s_add_u32 s4, s4, 2
    s_lshl_b32 s5, s4, 14
    s_add_u32 s51, s5, 94371840
    s_mul_i32 s4, s25, 9
    s_add_u32 s4, s4, 4
    s_lshl_b32 s5, s4, 14
    s_add_u32 s52, s5, 94371840
    s_mul_i32 s4, s25, 9
    s_add_u32 s4, s4, 6
    s_lshl_b32 s5, s4, 14
    s_add_u32 s53, s5, 94371840
    s_mul_i32 s4, s25, 9
    s_add_u32 s4, s4, 8
    s_lshl_b32 s5, s4, 14
    s_add_u32 s54, s5, 94371840
    s_lshr_b32 s4, s24, 3
    s_add_u32 s4, s4, 32
    s_and_b32 s5, s24, 7
    s_lshl_b32 s58, s4, 14
    s_lshl_b32 s6, s5, 6
    s_add_u32 s58, s58, s6
    s_lshl_b32 s59, s4, 8
    s_lshl_b32 s6, s5, 5
    s_add_u32 s59, s59, s6
    s_mov_b32 s26, 0
    s_lshl_b32 s4, s24, 2
    s_add_u32 s4, s4, s25
    s_lshl_b32 s4, s4, 10
    s_add_u32 s27, s4, 16777216
    s_add_u32 s28, s27, 131072
    s_lshl_b32 s5, s4, 1
    s_add_u32 s29, s5, 33554432
    s_lshr_b32 s5, s4, 1
    s_add_u32 s31, s5, 83729280
    s_add_u32 s32, s5, 88080384
    s_mov_b32 s33, 94371840
    s_mov_b32 s49, 94896128
    s_mov_b32 s34, 96468992
    s_mov_b32 s35, 96478208
    s_mov_b32 s30, 96487424
    s_mov_b32 s56, 98566400
    s_mov_b32 s55, 64
    s_cmp_lg_u32 s25, 0
    s_cbranch_scc1 Lz4_13
    s_mov_b32 s44, 0
    v_mov_b32 v12, 52
    s_nop 1
Lz3_12:
    buffer_load_dword v13, v12, s[12:15], 0 offen sc1
    s_waitcnt vmcnt(0)
    v_readfirstlane_b32 s4, v13
    s_cmp_lg_u32 s4, 0
    s_nop 3
    s_cbranch_scc1 Lz4_13
    s_sleep 2
    s_add_u32 s44, s44, 1
    s_cmp_lt_u32 s44, 0x40000
    s_cbranch_scc1 Lz3_12
Lz4_13:
    s_barrier
    s_mov_b32 s44, 0
    v_mov_b32 v12, s56
    s_nop 1
Lkw_14:
    buffer_load_dword v13, v12, s[16:19], 0 offen sc1
    s_waitcnt vmcnt(0)
    v_readfirstlane_b32 s4, v13
    s_cmp_ge_u32 s4, 64
    s_nop 3
    s_cbranch_scc1 Lkwd_15
    s_sleep 2
    s_add_u32 s44, s44, 1
    s_cmp_lt_u32 s44, 0x40000
    s_cbranch_scc1 Lkw_14
Lkwd_15:
    s_mov_b32 s44, 0
    v_mov_b32 v12, 36
    s_nop 1
Lrw_16:
    buffer_load_dword v13, v12, s[12:15], 0 offen sc1
    s_waitcnt vmcnt(0)
    v_readfirstlane_b32 s4, v13
    s_add_u32 s44, s44, 1
    s_cmp_gt_u32 s44, 0x40000
    s_nop 2
    s_cbranch_scc1 Lrw2_17
    s_cmp_lt_u32 s4, 32
    s_cbranch_scc1 Lrw_16
Lrw2_17:
    s_waitcnt lgkmcnt(0)
    s_barrier
Lstep_18:
    s_cmp_ge_u32 s55, 64
    s_cbranch_scc1 Lkok_19
    s_mov_b32 s44, 0
    v_mov_b32 v12, s56
    s_nop 1
Lkw_20:
    buffer_load_dword v13, v12, s[16:19], 0 offen sc1
    s_waitcnt vmcnt(0)
    v_readfirstlane_b32 s4, v13
    s_cmp_ge_u32 s4, 64
    s_nop 3
    s_cbranch_scc1 Lkwd_21
    s_sleep 2
    s_add_u32 s44, s44, 1
    s_cmp_lt_u32 s44, 0x40000
    s_cbranch_scc1 Lkw_20
Lkwd_21:
Lkok_19:
    ds_read_b128 v[40:43], v0 offset:0
    ds_read_b128 v[52:55], v1 offset:0
    ds_read_b128 v[56:59], v1 offset:1024
    ds_read_b128 v[44:47], v0 offset:64
    ds_read_b128 v[48:51], v0 offset:128
    ds_read_b128 v[60:63], v1 offset:2048
    ds_read_b128 v[12:15], v1 offset:3072
    s_waitcnt lgkmcnt(6)
    v_mfma_f32_16x16x32_bf16 v[16:19], a[0:3], v[40:43], 0
    v_mfma_f32_16x16x32_bf16 v[20:23], a[4:7], v[40:43], 0
    v_mfma_f32_16x16x32_bf16 v[32:35], v[40:43], a[144:147], 0
    v_mfma_f32_16x16x32_bf16 v[36:39], v[40:43], a[148:151], 0
    s_waitcnt lgkmcnt(4)
    v_mfma_f32_16x16x32_bf16 v[24:27], v[52:55], v[40:43], 0
    v_mfma_f32_16x16x32_bf16 v[28:31], v[56:59], v[40:43], 0
    buffer_load_dwordx4 v[64:67], v3, s[16:19], s27 offen sc1
    ds_read_b128 v[40:43], v0 offset:192
    ds_read_b128 v[52:55], v1 offset:4096
    ds_read_b128 v[56:59], v1 offset:5120
    s_waitcnt lgkmcnt(6)
    v_mfma_f32_16x16x32_bf16 v[16:19], a[8:11], v[44:47], v[16:19]
    v_mfma_f32_16x16x32_bf16 v[20:23], a[12:15], v[44:47], v[20:23]
    v_mfma_f32_16x16x32_bf16 v[32:35], v[44:47], a[152:155], v[32:35]
    v_mfma_f32_16x16x32_bf16 v[36:39], v[44:47], a[156:159], v[36:39]
    s_waitcnt lgkmcnt(3)
    v_mfma_f32_16x16x32_bf16 v[24:27], v[60:63], v[44:47], v[24:27]
    v_mfma_f32_16x16x32_bf16 v[28:31], v[12:15], v[44:47], v[28:31]
    buffer_load_dwordx4 v[68:71], v3, s[16:19], s28 offen sc1
    ds_read_b128 v[44:47], v0 offset:256
    ds_read_b128 v[60:63], v1 offset:6144
    ds_read_b128 v[12:15], v1 offset:7168
    s_waitcnt lgkmcnt(8)
    v_mfma_f32_16x16x32_bf16 v[16:19], a[16:19], v[48:51], v[16:19]
    v_mfma_f32_16x16x32_bf16 v[20:23], a[20:23], v[48:51], v[20:23]
    v_mfma_f32_16x16x32_bf16 v[32:35], v[48:51], a[160:163], v[32:35]
    v_mfma_f32_16x16x32_bf16 v[36:39], v[48:51], a[164:167], v[36:39]
    s_waitcnt lgkmcnt(3)
    v_mfma_f32_16x16x32_bf16 v[24:27], v[52:55], v[48:51], v[24:27]
    v_mfma_f32_16x16x32_bf16 v[28:31], v[56:59], v[48:51], v[28:31]
    buffer_load_dwordx4 v[72:75], v3, s[16:19], s29 offen sc1
    ds_read_b128 v[48:51], v0 offset:320
    ds_read_b128 v[52:55], v1 offset:8192
    ds_read_b128 v[56:59], v1 offset:9216
    s_waitcnt lgkmcnt(8)
    v_mfma_f32_16x16x32_bf16 v[16:19], a[24:27], v[40:43], v[16:19]
    v_mfma_f32_16x16x32_bf16 v[20:23], a[28:31], v[40:43], v[20:23]
    v_mfma_f32_16x16x32_bf16 v[32:35], v[40:43], a[168:171], v[32:35]
    v_mfma_f32_16x16x32_bf16 v[36:39], v[40:43], a[172:175], v[36:39]
    s_waitcnt lgkmcnt(3)
    v_mfma_f32_16x16x32_bf16 v[24:27], v[60:63], v[40:43], v[24:27]
    v_mfma_f32_16x16x32_bf16 v[28:31], v[12:15], v[40:43], v[28:31]
    buffer_load_dwordx4 v[76:79], v3, s[16:19], s29 offen offset:1024 sc1
    s_add_u32 s27, s27, 262144
    s_add_u32 s28, s28, 262144
    s_add_u32 s29, s29, 262144
    ds_read_b128 v[40:43], v0 offset:384
    ds_read_b128 v[60:63], v1 offset:10240
    ds_read_b128 v[12:15], v1 offset:11264
    s_waitcnt lgkmcnt(8)
    v_mfma_f32_16x16x32_bf16 v[16:19], a[32:35], v[44:47], v[16:19]
    v_mfma_f32_16x16x32_bf16 v[20:23], a[36:39], v[44:47], v[20:23]
    v_mfma_f32_16x16x32_bf16 v[32:35], v[44:47], a[176:179], v[32:35]
    v_mfma_f32_16x16x32_bf16 v[36:39], v[44:47], a[180:183], v[36:39]
    s_waitcnt lgkmcnt(3)
    v_mfma_f32_16x16x32_bf16 v[24:27], v[52:55], v[44:47], v[24:27]
    v_mfma_f32_16x16x32_bf16 v[28:31], v[56:59], v[44:47], v[28:31]
    ds_read_b128 v[44:47], v0 offset:448
    ds_read_b128 v[52:55], v1 offset:12288
    ds_read_b128 v[56:59], v1 offset:13312
    s_waitcnt lgkmcnt(8)
    v_mfma_f32_16x16x32_bf16 v[16:19], a[40:43], v[48:51], v[16:19]
    v_mfma_f32_16x16x32_bf16 v[20:23], a[44:47], v[48:51], v[20:23]
    v_mfma_f32_16x16x32_bf16 v[32:35], v[48:51], a[184:187], v[32:35]
    v_mfma_f32_16x16x32_bf16 v[36:39], v[48:51], a[188:191], v[36:39]
    s_waitcnt lgkmcnt(3)
    v_mfma_f32_16x16x32_bf16 v[24:27], v[60:63], v[48:51], v[24:27]
    v_mfma_f32_16x16x32_bf16 v[28:31], v[12:15], v[48:51], v[28:31]
    s_sub_u32 s6, s26, 1
    s_max_i32 s6, s6, 0
    s_lshl_b32 s4, s6, 7
    s_add_u32 s4, s4, 98570496
    s_cmp_eq_u32 s26, 0
    s_cselect_b32 s5, 0, 1
    v_mov_b32 v6, s5
    s_mov_b64 exec, 1
    buffer_atomic_add v6, v3, s[16:19], s4 offen
    s_mov_b64 exec, -1
    ds_read_b128 v[48:51], v0 offset:512
    ds_read_b128 v[60:63], v1 offset:14336
    ds_read_b128 v[12:15], v1 offset:15360
    s_waitcnt lgkmcnt(8)
    v_mfma_f32_16x16x32_bf16 v[16:19], a[48:51], v[40:43], v[16:19]
    v_mfma_f32_16x16x32_bf16 v[20:23], a[52:55], v[40:43], v[20:23]
    v_mfma_f32_16x16x32_bf16 v[32:35], v[40:43], a[192:195], v[32:35]
    v_mfma_f32_16x16x32_bf16 v[36:39], v[40:43], a[196:199], v[36:39]
    s_waitcnt lgkmcnt(3)
    v_mfma_f32_16x16x32_bf16 v[24:27], v[52:55], v[40:43], v[24:27]
    v_mfma_f32_16x16x32_bf16 v[28:31], v[56:59], v[40:43], v[28:31]
    ds_read_b128 v[40:43], v0 offset:576
    ds_read_b128 v[52:55], v1 offset:16384
    ds_read_b128 v[56:59], v1 offset:17408
    s_waitcnt lgkmcnt(8)
    v_mfma_f32_16x16x32_bf16 v[16:19], a[56:59], v[44:47], v[16:19]
    v_mfma_f32_16x16x32_bf16 v[20:23], a[60:63], v[44:47], v[20:23]
    v_mfma_f32_16x16x32_bf16 v[32:35], v[44:47], a[200:203], v[32:35]
    v_mfma_f32_16x16x32_bf16 v[36:39], v[44:47], a[204:207], v[36:39]
    s_waitcnt lgkmcnt(3)
    v_mfma_f32_16x16x32_bf16 v[24:27], v[60:63], v[44:47], v[24:27]
    v_mfma_f32_16x16x32_bf16 v[28:31], v[12:15], v[44:47], v[28:31]
    s_add_u32 s4, s26, 1
    s_lshr_b32 s4, s4, 2
    s_min_u32 s4, s4, 15
    s_lshl_b32 s4, s4, 7
    s_add_u32 s56, s4, 98566400
    v_mov_b32 v6, s56
    buffer_load_dword v6, v6, s[16:19], 0 offen sc1
    ds_read_b128 v[44:47], v0 offset:640
    ds_read_b128 v[60:63], v1 offset:18432
    ds_read_b128 v[12:15], v1 offset:19456
    s_waitcnt lgkmcnt(8)
    v_mfma_f32_16x16x32_bf16 v[16:19], a[64:67], v[48:51], v[16:19]
    v_mfma_f32_16x16x32_bf16 v[20:23], a[68:71], v[48:51], v[20:23]
    v_mfma_f32_16x16x32_bf16 v[32:35], v[48:51], a[208:211], v[32:35]
    v_mfma_f32_16x16x32_bf16 v[36:39], v[48:51], a[212:215], v[36:39]
    s_waitcnt lgkmcnt(3)
    v_mfma_f32_16x16x32_bf16 v[24:27], v[52:55], v[48:51], v[24:27]
    v_mfma_f32_16x16x32_bf16 v[28:31], v[56:59], v[48:51], v[28:31]
    ds_read_b128 v[48:51], v0 offset:704
    ds_read_b128 v[52:55], v1 offset:20480
    ds_read_b128 v[56:59], v1 offset:21504
    s_waitcnt lgkmcnt(8)
    v_mfma_f32_16x16x32_bf16 v[16:19], a[72:75], v[40:43], v[16:19]
    v_mfma_f32_16x16x32_bf16 v[20:23], a[76:79], v[40:43], v[20:23]
    v_mfma_f32_16x16x32_bf16 v[32:35], v[40:43], a[216:219], v[32:35]
    v_mfma_f32_16x16x32_bf16 v[36:39], v[40:43], a[220:223], v[36:39]
    s_waitcnt lgkmcnt(3)
    v_mfma_f32_16x16x32_bf16 v[24:27], v[60:63], v[40:43], v[24:27]
    v_mfma_f32_16x16x32_bf16 v[28:31], v[12:15], v[40:43], v[28:31]
    ds_read_b128 v[40:43], v0 offset:768
    ds_read_b128 v[60:63], v1 offset:22528
    ds_read_b128 v[12:15], v1 offset:23552
    s_waitcnt lgkmcnt(8)
    v_mfma_f32_16x16x32_bf16 v[16:19], a[80:83], v[44:47], v[16:19]
    v_mfma_f32_16x16x32_bf16 v[20:23], a[84:87], v[44:47], v[20:23]
    v_mfma_f32_16x16x32_bf16 v[32:35], v[44:47], a[224:227], v[32:35]
    v_mfma_f32_16x16x32_bf16 v[36:39], v[44:47], a[228:231], v[36:39]
    s_waitcnt lgkmcnt(3)
    v_mfma_f32_16x16x32_bf16 v[24:27], v[52:55], v[44:47], v[24:27]
    v_mfma_f32_16x16x32_bf16 v[28:31], v[56:59], v[44:47], v[28:31]
    ds_read_b128 v[44:47], v0 offset:832
    ds_read_b128 v[52:55], v1 offset:24576
    ds_read_b128 v[56:59], v1 offset:25600
    s_waitcnt lgkmcnt(8)
    v_mfma_f32_16x16x32_bf16 v[16:19], a[88:91], v[48:51], v[16:19]
    v_mfma_f32_16x16x32_bf16 v[20:23], a[92:95], v[48:51], v[20:23]
    v_mfma_f32_16x16x32_bf16 v[32:35], v[48:51], a[232:235], v[32:35]
    v_mfma_f32_16x16x32_bf16 v[36:39], v[48:51], a[236:239], v[36:39]
    s_waitcnt lgkmcnt(3)
    v_mfma_f32_16x16x32_bf16 v[24:27], v[60:63], v[48:51], v[24:27]
    v_mfma_f32_16x16x32_bf16 v[28:31], v[12:15], v[48:51], v[28:31]
    ds_read_b128 v[48:51], v0 offset:896
    ds_read_b128 v[60:63], v1 offset:26624
    ds_read_b128 v[12:15], v1 offset:27648
    s_waitcnt lgkmcnt(8)
    v_mfma_f32_16x16x32_bf16 v[16:19], a[96:99], v[40:43], v[16:19]
    v_mfma_f32_16x16x32_bf16 v[20:23], a[100:103], v[40:43], v[20:23]
    v_mfma_f32_16x16x32_bf16 v[32:35], v[40:43], a[240:243], v[32:35]
    v_mfma_f32_16x16x32_bf16 v[36:39], v[40:43], a[244:247], v[36:39]
    s_waitcnt lgkmcnt(3)
    v_mfma_f32_16x16x32_bf16 v[24:27], v[52:55], v[40:43], v[24:27]
    v_mfma_f32_16x16x32_bf16 v[28:31], v[56:59], v[40:43], v[28:31]
    ds_read_b128 v[40:43], v0 offset:960
    ds_read_b128 v[52:55], v1 offset:28672
    ds_read_b128 v[56:59], v1 offset:29696
    s_waitcnt lgkmcnt(8)
    v_mfma_f32_16x16x32_bf16 v[16:19], a[104:107], v[44:47], v[16:19]
    v_mfma_f32_16x16x32_bf16 v[20:23], a[108:111], v[44:47], v[20:23]
    v_mfma_f32_16x16x32_bf16 v[32:35], v[44:47], a[248:251], v[32:35]
    v_mfma_f32_16x16x32_bf16 v[36:39], v[44:47], a[252:255], v[36:39]
    s_waitcnt lgkmcnt(3)
    v_mfma_f32_16x16x32_bf16 v[24:27], v[60:63], v[44:47], v[24:27]
    v_mfma_f32_16x16x32_bf16 v[28:31], v[12:15], v[44:47], v[28:31]
    ds_read_b128 v[44:47], v0 offset:1024
    ds_read_b128 v[60:63], v1 offset:30720
    ds_read_b128 v[12:15], v1 offset:31744
    s_waitcnt lgkmcnt(8)
    v_mfma_f32_16x16x32_bf16 v[16:19], a[112:115], v[48:51], v[16:19]
    v_mfma_f32_16x16x32_bf16 v[20:23], a[116:119], v[48:51], v[20:23]
    v_mfma_f32_16x16x32_bf16 v[32:35], v[48:51], v[80:83], v[32:35]
    v_mfma_f32_16x16x32_bf16 v[36:39], v[48:51], v[84:87], v[36:39]
    s_waitcnt lgkmcnt(3)
    v_mfma_f32_16x16x32_bf16 v[24:27], v[52:55], v[48:51], v[24:27]
    v_mfma_f32_16x16x32_bf16 v[28:31], v[56:59], v[48:51], v[28:31]
    ds_read_b128 v[48:51], v0 offset:1088
    ds_read_b128 v[52:55], v1 offset:32768
    ds_read_b128 v[56:59], v1 offset:33792
    s_waitcnt lgkmcnt(8)
    v_mfma_f32_16x16x32_bf16 v[16:19], a[120:123], v[40:43], v[16:19]
    v_mfma_f32_16x16x32_bf16 v[20:23], a[124:127], v[40:43], v[20:23]
    v_mfma_f32_16x16x32_bf16 v[32:35], v[40:43], v[88:91], v[32:35]
    v_mfma_f32_16x16x32_bf16 v[36:39], v[40:43], v[92:95], v[36:39]
    s_waitcnt lgkmcnt(3)
    v_mfma_f32_16x16x32_bf16 v[24:27], v[60:63], v[40:43], v[24:27]
    v_mfma_f32_16x16x32_bf16 v[28:31], v[12:15], v[40:43], v[28:31]
    ds_read_b128 v[60:63], v1 offset:34816
    ds_read_b128 v[12:15], v1 offset:35840
    s_waitcnt lgkmcnt(7)
    v_mfma_f32_16x16x32_bf16 v[16:19], a[128:131], v[44:47], v[16:19]
    v_mfma_f32_16x16x32_bf16 v[20:23], a[132:135], v[44:47], v[20:23]
    v_mfma_f32_16x16x32_bf16 v[32:35], v[44:47], v[96:99], v[32:35]
    v_mfma_f32_16x16x32_bf16 v[36:39], v[44:47], v[100:103], v[36:39]
    s_waitcnt lgkmcnt(2)
    v_mfma_f32_16x16x32_bf16 v[24:27], v[52:55], v[44:47], v[24:27]
    v_mfma_f32_16x16x32_bf16 v[28:31], v[56:59], v[44:47], v[28:31]
    s_waitcnt lgkmcnt(4)
    v_mfma_f32_16x16x32_bf16 v[16:19], a[136:139], v[48:51], v[16:19]
    v_mfma_f32_16x16x32_bf16 v[20:23], a[140:143], v[48:51], v[20:23]
    s_waitcnt lgkmcnt(0)
    v_mfma_f32_16x16x32_bf16 v[24:27], v[60:63], v[48:51], v[24:27]
    v_mfma_f32_16x16x32_bf16 v[28:31], v[12:15], v[48:51], v[28:31]
    v_mfma_f32_16x16x32_bf16 v[32:35], v[48:51], v[104:107], v[32:35]
    v_mfma_f32_16x16x32_bf16 v[36:39], v[48:51], v[108:111], v[36:39]
    s_nop 1
    v_cvt_pk_bf16_f32 v16, v16, v17
    v_cvt_pk_bf16_f32 v17, v18, v19
    v_cvt_pk_bf16_f32 v18, v20, v21
    v_cvt_pk_bf16_f32 v19, v22, v23
    v_cvt_pk_bf16_f32 v24, v24, v25
    v_cvt_pk_bf16_f32 v25, v26, v27
    v_cvt_pk_bf16_f32 v26, v28, v29
    v_cvt_pk_bf16_f32 v27, v30, v31
    s_waitcnt vmcnt(4)
    v_mfma_f32_16x16x32_bf16 v[20:23], v[64:67], v[16:19], 0
    v_mfma_f32_16x16x32_bf16 v[28:31], v[68:71], v[16:19], 0
    v_mfma_f32_16x16x32_bf16 v[64:67], v[24:27], v[16:19], 0
    v_cvt_pk_bf16_f32 v32, v32, v33
    v_cvt_pk_bf16_f32 v33, v34, v35
    v_cvt_pk_bf16_f32 v34, v36, v37
    v_cvt_pk_bf16_f32 v35, v38, v39
    s_mov_b64 exec, s[36:37]
    s_nop 0
    ds_write_b128 v7, v[20:23] offset:0
    ds_write_b128 v7, v[28:31] offset:512
    ds_write_b128 v7, v[64:67] offset:1024
    s_mov_b64 exec, -1
    s_cmp_eq_u32 s26, 63
    s_cbranch_scc1 Lfin_22
    v_add_u32 v71, s45, v8
    v_add_u32 v70, s57, v8
    s_waitcnt lgkmcnt(0)
    s_barrier
    ds_read_b128 v[40:43], v5 offset:0
    ds_read_b128 v[44:47], v5 offset:512
    ds_read_b128 v[48:51], v5 offset:1024
    ds_read_b128 v[52:55], v70 offset:0
    ds_read_b128 v[56:59], v70 offset:512
    ds_read_b128 v[60:63], v70 offset:1024
    ds_read_b128 v[12:15], v71 offset:0
    ds_read_b128 v[16:19], v71 offset:512
    ds_read_b128 v[36:39], v71 offset:1024
    s_mov_b64 exec, s[36:37]
    buffer_store_dwordx4 v[24:27], v8, s[16:19], s31 offen sc1
    s_mov_b64 exec, s[38:39]
    buffer_store_dwordx4 v[32:35], v3, s[16:19], s32 offen sc1
    s_mov_b64 exec, -1
    s_add_u32 s31, s31, 65536
    s_add_u32 s32, s32, 65536
    s_waitcnt lgkmcnt(6)
    v_pk_add_f32 v[20:21], v[20:21], v[40:41]
    v_pk_add_f32 v[22:23], v[22:23], v[42:43]
    v_pk_add_f32 v[28:29], v[28:29], v[44:45]
    v_pk_add_f32 v[30:31], v[30:31], v[46:47]
    v_pk_add_f32 v[64:65], v[64:65], v[48:49]
    v_pk_add_f32 v[66:67], v[66:67], v[50:51]
    s_waitcnt lgkmcnt(0)
    v_pk_add_f32 v[52:53], v[52:53], v[12:13]
    v_pk_add_f32 v[54:55], v[54:55], v[14:15]
    v_pk_add_f32 v[56:57], v[56:57], v[16:17]
    v_pk_add_f32 v[58:59], v[58:59], v[18:19]
    v_pk_add_f32 v[60:61], v[60:61], v[36:37]
    v_pk_add_f32 v[62:63], v[62:63], v[38:39]
    v_pk_add_f32 v[20:21], v[20:21], v[52:53]
    v_pk_add_f32 v[22:23], v[22:23], v[54:55]
    v_pk_add_f32 v[28:29], v[28:29], v[56:57]
    v_pk_add_f32 v[30:31], v[30:31], v[58:59]
    v_pk_add_f32 v[64:65], v[64:65], v[60:61]
    v_pk_add_f32 v[66:67], v[66:67], v[62:63]
    v_max3_f32 v68, v20, v21, v22
    v_max3_f32 v69, v23, v28, v29
    v_max3_f32 v70, v30, v31, v64
    v_max3_f32 v71, v65, v66, v67
    v_max3_f32 v68, v68, v69, v70
    v_max_f32 v68, v68, v71
    v_mov_b32 v69, v68
    s_nop 1
    v_permlane16_swap_b32 v68, v69
    v_max_f32 v68, v68, v69
    v_mov_b32 v69, v68
    s_nop 1
    v_permlane32_swap_b32 v68, v69
    v_max_f32 v68, v68, v69
    v_mul_f32 v70, s46, v68
    v_sub_f32 v70, 0, v70
    v_mov_b32 v71, v70
    v_pk_fma_f32 v[20:21], v[20:21], s[46:47], v[70:71]
    v_pk_fma_f32 v[22:23], v[22:23], s[46:47], v[70:71]
    v_pk_fma_f32 v[28:29], v[28:29], s[46:47], v[70:71]
    v_pk_fma_f32 v[30:31], v[30:31], s[46:47], v[70:71]
    v_pk_fma_f32 v[64:65], v[64:65], s[46:47], v[70:71]
    v_pk_fma_f32 v[66:67], v[66:67], s[46:47], v[70:71]
    v_exp_f32 v20, v20
    v_exp_f32 v21, v21
    v_exp_f32 v22, v22
    v_exp_f32 v23, v23
    v_exp_f32 v28, v28
    v_exp_f32 v29, v29
    v_exp_f32 v30, v30
    v_exp_f32 v31, v31
    v_exp_f32 v64, v64
    v_exp_f32 v65, v65
    v_exp_f32 v66, v66
    v_exp_f32 v67, v67
    v_cvt_pk_bf16_f32 v16, v20, v21
    v_cvt_pk_bf16_f32 v17, v22, v23
    v_cvt_pk_bf16_f32 v18, v28, v29
    v_cvt_pk_bf16_f32 v19, v30, v31
    v_cndmask_b32 v64, 0, v64, s[38:39]
    v_cndmask_b32 v65, 0, v65, s[38:39]
    v_cndmask_b32 v66, 0, v66, s[38:39]
    v_cndmask_b32 v67, 0, v67, s[38:39]
    v_cvt_pk_bf16_f32 v24, v64, v65
    v_cvt_pk_bf16_f32 v25, v66, v67
    s_waitcnt vmcnt(4)
    v_mfma_f32_16x16x32_bf16 v[40:43], v[72:75], v[16:19], 0
    v_mfma_f32_16x16x32_bf16 v[44:47], v[76:79], v[16:19], 0
    v_mfma_f32_16x16x16_bf16 v[40:43], v[32:33], v[24:25], v[40:43]
    v_mfma_f32_16x16x16_bf16 v[44:47], v[34:35], v[24:25], v[44:47]
    v_pk_add_f32 v[68:69], v[20:21], v[22:23]
    v_pk_add_f32 v[70:71], v[28:29], v[30:31]
    v_pk_add_f32 v[64:65], v[64:65], v[66:67]
    v_pk_add_f32 v[68:69], v[68:69], v[70:71]
    v_pk_add_f32 v[68:69], v[68:69], v[64:65]
    v_add_f32 v68, v68, v69
    v_mov_b32 v69, v68
    s_nop 1
    v_permlane16_swap_b32 v68, v69
    v_add_f32 v68, v68, v69
    v_mov_b32 v69, v68
    s_nop 1
    v_permlane32_swap_b32 v68, v69
    v_add_f32 v68, v68, v69
    v_rcp_f32 v68, v68
    s_nop 0
    v_mov_b32 v69, v68
    v_pk_mul_f32 v[20:21], v[40:41], v[68:69]
    v_pk_mul_f32 v[28:29], v[44:45], v[68:69]
    v_pk_mul_f32 v[22:23], v[42:43], v[68:69]
    v_pk_mul_f32 v[30:31], v[46:47], v[68:69]
    v_add_u32 v40, 4294957952, v8
    s_lshl_b32 s4, s25, 9
    v_add_u32 v41, s4, v40
    v_cvt_pk_bf16_f32 v36, v20, v21
    v_cvt_pk_bf16_f32 v37, v22, v23
    v_cvt_pk_bf16_f32 v38, v28, v29
    v_cvt_pk_bf16_f32 v39, v30, v31
    s_mov_b64 exec, s[36:37]
    ds_write_b128 v41, v[36:39]
    s_mov_b64 exec, -1
    v_mov_b32 v63, v40
    s_waitcnt lgkmcnt(0)
    s_barrier
    ds_read_b128 v[40:43], v63 offset:0
    ds_read_b128 v[44:47], v63 offset:512
    ds_read_b128 v[48:51], v63 offset:1024
    ds_read_b128 v[52:55], v63 offset:1536
    s_waitcnt lgkmcnt(0)
    v_mfma_f32_16x16x32_bf16 v[16:19], v[112:115], v[40:43], 0
    v_mfma_f32_16x16x32_bf16 v[16:19], v[116:119], v[44:47], v[16:19]
    v_mfma_f32_16x16x32_bf16 v[16:19], v[120:123], v[48:51], v[16:19]
    v_mfma_f32_16x16x32_bf16 v[16:19], v[124:127], v[52:55], v[16:19]
    v_mfma_f32_16x16x32_bf16 v[20:23], v[128:131], v[40:43], 0
    v_mfma_f32_16x16x32_bf16 v[20:23], v[132:135], v[44:47], v[20:23]
    v_mfma_f32_16x16x32_bf16 v[20:23], v[136:139], v[48:51], v[20:23]
    v_mfma_f32_16x16x32_bf16 v[20:23], v[140:143], v[52:55], v[20:23]
    v_mfma_f32_16x16x32_bf16 v[24:27], v[144:147], v[40:43], 0
    v_mfma_f32_16x16x32_bf16 v[24:27], v[148:151], v[44:47], v[24:27]
    v_mfma_f32_16x16x32_bf16 v[24:27], v[152:155], v[48:51], v[24:27]
    v_mfma_f32_16x16x32_bf16 v[24:27], v[156:159], v[52:55], v[24:27]
    s_nop 3
    v_mov_b32_dpp v16, v20 row_shr:8 row_mask:0xf bank_mask:0xc
    v_mov_b32_dpp v17, v21 row_shr:8 row_mask:0xf bank_mask:0xc
    v_mov_b32_dpp v18, v22 row_shr:8 row_mask:0xf bank_mask:0xc
    v_mov_b32_dpp v19, v23 row_shr:8 row_mask:0xf bank_mask:0xc
    buffer_store_dwordx4 v[16:19], v9, s[16:19], s50 offen
    v_mfma_f32_16x16x32_bf16 v[28:31], v[160:163], v[40:43], 0
    v_mfma_f32_16x16x32_bf16 v[28:31], v[164:167], v[44:47], v[28:31]
    v_mfma_f32_16x16x32_bf16 v[28:31], v[168:171], v[48:51], v[28:31]
    v_mfma_f32_16x16x32_bf16 v[28:31], v[172:175], v[52:55], v[28:31]
    v_mfma_f32_16x16x32_bf16 v[32:35], v[176:179], v[40:43], 0
    v_mfma_f32_16x16x32_bf16 v[32:35], v[180:183], v[44:47], v[32:35]
    v_mfma_f32_16x16x32_bf16 v[32:35], v[184:187], v[48:51], v[32:35]
    v_mfma_f32_16x16x32_bf16 v[32:35], v[188:191], v[52:55], v[32:35]
    s_nop 3
    v_mov_b32_dpp v24, v28 row_shr:8 row_mask:0xf bank_mask:0xc
    v_mov_b32_dpp v25, v29 row_shr:8 row_mask:0xf bank_mask:0xc
    v_mov_b32_dpp v26, v30 row_shr:8 row_mask:0xf bank_mask:0xc
    v_mov_b32_dpp v27, v31 row_shr:8 row_mask:0xf bank_mask:0xc
    buffer_store_dwordx4 v[24:27], v9, s[16:19], s51 offen
    v_mfma_f32_16x16x32_bf16 v[36:39], v[192:195], v[40:43], 0
    v_mfma_f32_16x16x32_bf16 v[36:39], v[196:199], v[44:47], v[36:39]
    v_mfma_f32_16x16x32_bf16 v[36:39], v[200:203], v[48:51], v[36:39]
    v_mfma_f32_16x16x32_bf16 v[36:39], v[204:207], v[52:55], v[36:39]
    v_mfma_f32_16x16x32_bf16 v[56:59], v[208:211], v[40:43], 0
    v_mfma_f32_16x16x32_bf16 v[56:59], v[212:215], v[44:47], v[56:59]
    v_mfma_f32_16x16x32_bf16 v[56:59], v[216:219], v[48:51], v[56:59]
    v_mfma_f32_16x16x32_bf16 v[56:59], v[220:223], v[52:55], v[56:59]
    s_nop 3
    v_mov_b32_dpp v32, v36 row_shr:8 row_mask:0xf bank_mask:0xc
    v_mov_b32_dpp v33, v37 row_shr:8 row_mask:0xf bank_mask:0xc
    v_mov_b32_dpp v34, v38 row_shr:8 row_mask:0xf bank_mask:0xc
    v_mov_b32_dpp v35, v39 row_shr:8 row_mask:0xf bank_mask:0xc
    buffer_store_dwordx4 v[32:35], v9, s[16:19], s52 offen
    v_mfma_f32_16x16x32_bf16 v[60:63], v[224:227], v[40:43], 0
    v_mfma_f32_16x16x32_bf16 v[60:63], v[228:231], v[44:47], v[60:63]
    v_mfma_f32_16x16x32_bf16 v[60:63], v[232:235], v[48:51], v[60:63]
    v_mfma_f32_16x16x32_bf16 v[60:63], v[236:239], v[52:55], v[60:63]
    v_mfma_f32_16x16x32_bf16 v[12:15], v[240:243], v[40:43], 0
    v_mfma_f32_16x16x32_bf16 v[12:15], v[244:247], v[44:47], v[12:15]
    v_mfma_f32_16x16x32_bf16 v[12:15], v[248:251], v[48:51], v[12:15]
    v_mfma_f32_16x16x32_bf16 v[12:15], v[252:255], v[52:55], v[12:15]
    s_nop 3
    v_mov_b32_dpp v56, v60 row_shr:8 row_mask:0xf bank_mask:0xc
    v_mov_b32_dpp v57, v61 row_shr:8 row_mask:0xf bank_mask:0xc
    v_mov_b32_dpp v58, v62 row_shr:8 row_mask:0xf bank_mask:0xc
    v_mov_b32_dpp v59, v63 row_shr:8 row_mask:0xf bank_mask:0xc
    buffer_store_dwordx4 v[56:59], v9, s[16:19], s53 offen
    s_mov_b64 exec, s[36:37]
    buffer_store_dwordx4 v[12:15], v9, s[16:19], s54 offen
    s_mov_b64 exec, -1
    s_xor_b32 s50, s50, 1048576
    s_xor_b32 s51, s51, 1048576
    s_xor_b32 s52, s52, 1048576
    s_xor_b32 s53, s53, 1048576
    s_xor_b32 s54, s54, 1048576
    v_mov_b32 v52, 0x7fc07fc0
    s_cmp_eq_u32 s25, 0
    s_nop 0
    s_cbranch_scc1 Lg2_23
    s_mov_b32 s44, 0
    s_sleep 5
Lp1_25:
    buffer_load_dwordx4 v[16:19], v10, s[16:19], s33 offen offset:0 sc1
    buffer_load_dwordx4 v[20:23], v10, s[16:19], s33 offen offset:512 sc1
    buffer_load_dwordx4 v[24:27], v10, s[16:19], s33 offen offset:1024 sc1
    buffer_load_dwordx4 v[28:31], v10, s[16:19], s33 offen offset:1536 sc1
    s_waitcnt vmcnt(0)
    v_max3_u32 v48, v16, v17, v18
    v_max3_u32 v49, v19, v20, v21
    v_max3_u32 v48, v48, v22, v23
    v_max3_u32 v49, v49, v24, v25
    v_max3_u32 v48, v48, v26, v27
    v_max3_u32 v49, v49, v28, v29
    v_max3_u32 v48, v48, v30, v31
    v_max_u32 v48, v48, v49
    v_cmp_eq_u32 vcc, -1, v48
    s_nop 4
    s_cbranch_vccz Lp1d_26
    s_add_u32 s44, s44, 1
    s_cmp_lt_u32 s44, 0x40000
    s_cbranch_scc1 Lp1_25
Lp1d_26:
    v_pk_add_f32 v[16:17], v[16:17], v[20:21]
    v_pk_add_f32 v[24:25], v[24:25], v[28:29]
    v_pk_add_f32 v[18:19], v[18:19], v[22:23]
    v_pk_add_f32 v[26:27], v[26:27], v[30:31]
    v_pk_add_f32 v[16:17], v[16:17], v[24:25]
    v_pk_add_f32 v[18:19], v[18:19], v[26:27]
    s_nop 0
    v_add_f32_dpp v16, v16, v16 row_ror:8 row_mask:0xf bank_mask:0xf
    v_add_f32_dpp v17, v17, v17 row_ror:8 row_mask:0xf bank_mask:0xf
    v_add_f32_dpp v18, v18, v18 row_ror:8 row_mask:0xf bank_mask:0xf
    v_add_f32_dpp v19, v19, v19 row_ror:8 row_mask:0xf bank_mask:0xf
    v_mov_b32 v20, v16
    v_mov_b32 v21, v17
    v_mov_b32 v22, v18
    v_mov_b32 v23, v19
    v_permlane16_swap_b32 v16, v20
    v_permlane16_swap_b32 v17, v21
    v_permlane16_swap_b32 v18, v22
    v_permlane16_swap_b32 v19, v23
    v_pk_add_f32 v[16:17], v[16:17], v[20:21]
    v_pk_add_f32 v[18:19], v[18:19], v[22:23]
    v_mov_b32 v20, v16
    v_mov_b32 v21, v17
    v_mov_b32 v22, v18
    v_mov_b32 v23, v19
    v_permlane32_swap_b32 v16, v20
    v_permlane32_swap_b32 v17, v21
    v_permlane32_swap_b32 v18, v22
    v_permlane32_swap_b32 v19, v23
    v_pk_add_f32 v[16:17], v[16:17], v[20:21]
    v_pk_add_f32 v[18:19], v[18:19], v[22:23]
    v_cvt_pk_bf16_f32 v20, v16, v17
    v_cvt_pk_bf16_f32 v21, v18, v19
    v_cmp_eq_u32 vcc, -1, v20
    v_cmp_eq_u32 s[6:7], -1, v21
    s_nop 0
    v_cndmask_b32 v20, v20, v52, vcc
    v_cndmask_b32 v21, v21, v52, s[6:7]
    s_mov_b64 exec, s[40:41]
    buffer_store_dwordx2 v[20:21], v2, s[16:19], s34 offen
    s_mov_b64 exec, -1
    v_mov_b32 v48, -1
    v_mov_b32 v49, -1
    v_mov_b32 v50, -1
    v_mov_b32 v51, -1
    s_nop 1
    s_branch Lg3_24
Lg2_23:
    v_mbcnt_lo_u32_b32 v58, -1, 0
    v_mbcnt_hi_u32_b32 v58, -1, v58
    v_lshrrev_b32 v56, 2, v58
    v_lshlrev_b32 v56, 10, v56
    v_and_b32 v58, 3, v58
    v_lshl_add_u32 v56, v58, 4, v56
    v_add_u32 v56, s58, v56
    v_lshlrev_b32 v57, 3, v58
    v_add_u32 v57, s59, v57
    s_mov_b32 s44, 0
    s_sleep 5
Lp1_27:
    buffer_load_dwordx4 v[16:19], v10, s[16:19], s33 offen offset:0 sc1
    buffer_load_dwordx4 v[20:23], v10, s[16:19], s33 offen offset:512 sc1
    buffer_load_dwordx4 v[24:27], v10, s[16:19], s33 offen offset:1024 sc1
    buffer_load_dwordx4 v[28:31], v10, s[16:19], s33 offen offset:1536 sc1
    buffer_load_dwordx4 v[32:35], v56, s[16:19], s33 offen offset:0 sc1
    buffer_load_dwordx4 v[36:39], v56, s[16:19], s33 offen offset:512 sc1
    s_waitcnt vmcnt(0)
    v_max3_u32 v48, v16, v17, v18
    v_max3_u32 v49, v19, v20, v21
    v_max3_u32 v48, v48, v22, v23
    v_max3_u32 v49, v49, v24, v25
    v_max3_u32 v48, v48, v26, v27
    v_max3_u32 v49, v49, v28, v29
    v_max3_u32 v48, v48, v30, v31
    v_max3_u32 v49, v49, v32, v33
    v_max3_u32 v48, v48, v34, v35
    v_max3_u32 v49, v49, v36, v37
    v_max3_u32 v48, v48, v38, v39
    v_max_u32 v48, v48, v49
    v_cmp_eq_u32 vcc, -1, v48
    s_nop 4
    s_cbranch_vccz Lp1d_28
    s_add_u32 s44, s44, 1
    s_cmp_lt_u32 s44, 0x40000
    s_cbranch_scc1 Lp1_27
Lp1d_28:
    v_pk_add_f32 v[16:17], v[16:17], v[20:21]
    v_pk_add_f32 v[24:25], v[24:25], v[28:29]
    v_pk_add_f32 v[18:19], v[18:19], v[22:23]
    v_pk_add_f32 v[26:27], v[26:27], v[30:31]
    v_pk_add_f32 v[32:33], v[32:33], v[36:37]
    v_pk_add_f32 v[34:35], v[34:35], v[38:39]
    v_pk_add_f32 v[16:17], v[16:17], v[24:25]
    v_pk_add_f32 v[18:19], v[18:19], v[26:27]
    v_add_f32_dpp v32, v32, v32 row_ror:4 row_mask:0xf bank_mask:0xf
    v_add_f32_dpp v33, v33, v33 row_ror:4 row_mask:0xf bank_mask:0xf
    v_add_f32_dpp v34, v34, v34 row_ror:4 row_mask:0xf bank_mask:0xf
    v_add_f32_dpp v35, v35, v35 row_ror:4 row_mask:0xf bank_mask:0xf
    v_add_f32_dpp v16, v16, v16 row_ror:8 row_mask:0xf bank_mask:0xf
    v_add_f32_dpp v17, v17, v17 row_ror:8 row_mask:0xf bank_mask:0xf
    v_add_f32_dpp v18, v18, v18 row_ror:8 row_mask:0xf bank_mask:0xf
    v_add_f32_dpp v19, v19, v19 row_ror:8 row_mask:0xf bank_mask:0xf
    v_add_f32_dpp v32, v32, v32 row_ror:8 row_mask:0xf bank_mask:0xf
    v_add_f32_dpp v33, v33, v33 row_ror:8 row_mask:0xf bank_mask:0xf
    v_add_f32_dpp v34, v34, v34 row_ror:8 row_mask:0xf bank_mask:0xf
    v_add_f32_dpp v35, v35, v35 row_ror:8 row_mask:0xf bank_mask:0xf
    v_mov_b32_dpp v16, v32 row_shr:8 row_mask:0xf bank_mask:0x4
    v_mov_b32_dpp v17, v33 row_shr:8 row_mask:0xf bank_mask:0x4
    v_mov_b32_dpp v18, v34 row_shr:8 row_mask:0xf bank_mask:0x4
    v_mov_b32_dpp v19, v35 row_shr:8 row_mask:0xf bank_mask:0x4
    v_mov_b32 v20, v16
    v_mov_b32 v21, v17
    v_mov_b32 v22, v18
    v_mov_b32 v23, v19
    v_permlane16_swap_b32 v16, v20
    v_permlane16_swap_b32 v17, v21
    v_permlane16_swap_b32 v18, v22
    v_permlane16_swap_b32 v19, v23
    v_pk_add_f32 v[16:17], v[16:17], v[20:21]
    v_pk_add_f32 v[18:19], v[18:19], v[22:23]
    v_mov_b32 v20, v16
    v_mov_b32 v21, v17
    v_mov_b32 v22, v18
    v_mov_b32 v23, v19
    v_permlane32_swap_b32 v16, v20
    v_permlane32_swap_b32 v17, v21
    v_permlane32_swap_b32 v18, v22
    v_permlane32_swap_b32 v19, v23
    v_pk_add_f32 v[16:17], v[16:17], v[20:21]
    v_pk_add_f32 v[18:19], v[18:19], v[22:23]
    v_cvt_pk_bf16_f32 v20, v16, v17
    v_cvt_pk_bf16_f32 v21, v18, v19
    v_cmp_eq_u32 vcc, -1, v20
    v_cmp_eq_u32 s[6:7], -1, v21
    s_nop 0
    v_cndmask_b32 v20, v20, v52, vcc
    v_cndmask_b32 v21, v21, v52, s[6:7]
    s_mov_b64 exec, s[40:41]
    buffer_store_dwordx2 v[20:21], v2, s[16:19], s34 offen
    s_mov_b64 exec, 0xf00
    buffer_store_dwordx2 v[20:21], v57, s[16:19], s34 offen
    s_mov_b64 exec, -1
    v_mov_b32 v48, -1
    v_mov_b32 v49, -1
    v_mov_b32 v50, -1
    v_mov_b32 v51, -1
    buffer_store_dwordx4 v[48:51], v56, s[16:19], s33 offen offset:0
    buffer_store_dwordx4 v[48:51], v56, s[16:19], s33 offen offset:512
    s_mov_b64 exec, 0xf
    buffer_store_dwordx2 v[48:49], v57, s[16:19], s30 offen
    s_mov_b64 exec, -1
Lg3_24:
    v_readfirstlane_b32 s55, v6
    buffer_store_dwordx4 v[48:51], v10, s[16:19], s33 offen offset:0
    buffer_store_dwordx4 v[48:51], v10, s[16:19], s33 offen offset:512
    buffer_store_dwordx4 v[48:51], v10, s[16:19], s33 offen offset:1024
    buffer_store_dwordx4 v[48:51], v10, s[16:19], s33 offen offset:1536
    s_mov_b64 exec, s[40:41]
    buffer_store_dwordx2 v[48:49], v2, s[16:19], s30 offen
    s_mov_b64 exec, -1
    s_mov_b64 exec, s[42:43]
    s_mov_b32 s44, 0
    s_sleep 4
Lp2_29:
    buffer_load_dwordx4 v[16:19], v11, s[16:19], s34 offen offset:0 sc1
    buffer_load_dwordx4 v[20:23], v11, s[16:19], s34 offen offset:256 sc1
    buffer_load_dwordx4 v[24:27], v11, s[16:19], s34 offen offset:512 sc1
    s_waitcnt vmcnt(0)
    v_max3_u32 v48, v16, v17, v18
    v_max3_u32 v49, v19, v20, v21
    v_max3_u32 v48, v48, v22, v23
    v_max3_u32 v49, v49, v24, v25
    v_max3_u32 v48, v48, v26, v27
    v_max_u32 v48, v48, v49
    v_cmp_eq_u32 vcc, -1, v48
    s_nop 4
    s_cbranch_vccz Lp2d_30
    s_add_u32 s44, s44, 1
    s_cmp_lt_u32 s44, 0x40000
    s_cbranch_scc1 Lp2_29
Lp2d_30:
    ds_write_b128 v4, v[16:19] offset:0
    ds_write_b128 v4, v[20:23] offset:32
    ds_write_b128 v4, v[24:27] offset:64
    s_mov_b64 exec, -1
    s_xor_b32 s33, s33, 1048576
    s_xor_b32 s49, s49, 1048576
    s_mov_b32 s4, s30
    s_mov_b32 s30, s34
    s_mov_b32 s34, s35
    s_mov_b32 s35, s4
    s_add_u32 s26, s26, 1
    s_waitcnt lgkmcnt(0)
    s_barrier
    s_branch Lstep_18
Lfin_22:
    s_mov_b64 exec, s[36:37]
    buffer_store_dwordx4 v[24:27], v8, s[16:19], s31 offen sc1
    s_mov_b64 exec, s[38:39]
    buffer_store_dwordx4 v[32:35], v3, s[16:19], s32 offen sc1
    s_mov_b64 exec, -1
    s_add_u32 s31, s31, 65536
    s_add_u32 s32, s32, 65536
    s_waitcnt vmcnt(0)
    s_lshl_b32 s4, s26, 7
    s_add_u32 s4, s4, 98570496
    v_mov_b32 v54, s4
    v_mov_b32 v55, 1
    s_mov_b64 exec, 1
    buffer_atomic_add v55, v54, s[16:19], 0 offen
    s_mov_b64 exec, -1
    s_branch Lend_1
Lworker:
    s_mov_b32 s92, s12
    s_mov_b32 s93, s13
    s_mov_b32 s94, s14
    s_mov_b32 s95, s15
    s_mov_b32 s100, s25
    s_cmp_lg_u32 s25, 0
    s_cbranch_scc1 Lz4_32
    s_mov_b32 s44, 0
    v_mov_b32 v12, 52
    s_nop 1
Lz3_31:
    buffer_load_dword v13, v12, s[12:15], 0 offen sc1
    s_waitcnt vmcnt(0)
    v_readfirstlane_b32 s4, v13
    s_cmp_lg_u32 s4, 0
    s_nop 3
    s_cbranch_scc1 Lz4_32
    s_sleep 2
    s_add_u32 s44, s44, 1
    s_cmp_lt_u32 s44, 0x40000
    s_cbranch_scc1 Lz3_31
Lz4_32:
Lnext_33:
    s_cmp_lg_u32 s100, 0
    s_cbranch_scc1 Lfetch_34
    s_mov_b64 exec, 1
    v_mov_b32 v1, 98566144
    v_mov_b32 v2, 1
    buffer_atomic_add v2, v1, s[16:19], 0 offen sc0
    v_mov_b32 v1, 162960
    s_waitcnt vmcnt(0)
    ds_write_b32 v1, v2
    s_waitcnt lgkmcnt(0)
    s_mov_b64 exec, -1
Lfetch_34:
    s_barrier
    v_mov_b32 v1, 162960
    ds_read_b32 v2, v1
    s_waitcnt lgkmcnt(0)
    v_readfirstlane_b32 s101, v2
    s_barrier
    s_cmp_ge_u32 s101, 4594
    s_nop 2
    s_cbranch_scc1 Lend_1
    s_cmp_ge_u32 s101, 2930
    s_cbranch_scc1 Lt_40
    s_cmp_ge_u32 s101, 1906
    s_cbranch_scc1 Lt_39
    s_cmp_ge_u32 s101, 1760
    s_cbranch_scc1 Lt_38
    s_cmp_ge_u32 s101, 1536
    s_cbranch_scc1 Lt_37
    s_cmp_ge_u32 s101, 1024
    s_cbranch_scc1 Lt_36
    s_lshr_b32 s5, s101, 6
    s_and_b32 s6, s101, 63
    s_add_u32 s6, s6, 32
    s_branch Lproj_41
Lt_36:
    s_sub_u32 s4, s101, 1024
    s_lshr_b32 s5, s4, 5
    s_and_b32 s6, s4, 31
    s_branch Lproj_41
Lt_37:
    s_sub_u32 s4, s101, 1536
    s_mov_b32 s7, 306783379
    s_mul_hi_u32 s5, s4, s7
    s_mul_i32 s6, s5, 14
    s_sub_u32 s6, s4, s6
    s_add_u32 s6, s6, 96
Lproj_41:
    s_mov_b32 s8, s64
    s_and_b32 s9, s65, 0xffff
    s_mov_b32 s10, 2359296
    s_mov_b32 s11, 0x00020000
    s_mov_b32 s36, s5
    s_mov_b32 s37, s6
    s_cmp_lt_u32 s6, 32
    s_cbranch_scc1 Lsel_45
    s_cmp_lt_u32 s6, 64
    s_cbranch_scc1 Lsel_46
    s_cmp_lt_u32 s6, 96
    s_cbranch_scc1 Lsel_47
    s_branch Lsel_48
Lsel_45:
    s_mov_b32 s12, s68
    s_and_b32 s13, s69, 0xffff
    s_mov_b32 s14, 4718592
    s_mov_b32 s15, 0x00020000
    s_mov_b32 s20, 8192
    s_sub_u32 s21, s6, 0
    s_lshl_b32 s25, s21, 7
    s_lshl_b32 s21, s21, 8
    s_mov_b32 s22, 0
    s_mov_b32 s23, 8192
    s_mov_b32 s24, 0
    s_mov_b32 s26, 4096
    s_mov_b32 s34, 1
    s_branch Lsel_49
Lsel_46:
    s_mov_b32 s12, s70
    s_and_b32 s13, s71, 0xffff
    s_mov_b32 s14, 4718592
    s_mov_b32 s15, 0x00020000
    s_mov_b32 s20, 8192
    s_sub_u32 s21, s6, 32
    s_lshl_b32 s25, s21, 7
    s_lshl_b32 s21, s21, 8
    s_mov_b32 s22, 16777216
    s_mov_b32 s23, 8192
    s_mov_b32 s24, 0
    s_mov_b32 s26, 4096
    s_mov_b32 s34, 1
    s_branch Lsel_49
Lsel_47:
    s_mov_b32 s12, s72
    s_and_b32 s13, s73, 0xffff
    s_mov_b32 s14, 4718592
    s_mov_b32 s15, 0x00020000
    s_mov_b32 s20, 8192
    s_sub_u32 s21, s6, 64
    s_lshl_b32 s25, s21, 7
    s_lshl_b32 s21, s21, 8
    s_mov_b32 s22, 33554432
    s_mov_b32 s23, 4096
    s_mov_b32 s24, 1
    s_mov_b32 s26, 4096
    s_mov_b32 s34, 1
    s_branch Lsel_49
Lsel_48:
    s_mov_b32 s12, s80
    s_and_b32 s13, s81, 0xffff
    s_mov_b32 s14, 1990656
    s_mov_b32 s15, 0x00020000
    s_mov_b32 s20, 3456
    s_sub_u32 s21, s6, 96
    s_lshl_b32 s25, s21, 7
    s_lshl_b32 s21, s21, 8
    s_mov_b32 s22, 67108864
    s_mov_b32 s23, 2304
    s_mov_b32 s24, 0
    s_mov_b32 s26, 1152
    s_mov_b32 s34, 0
    s_cmp_lt_u32 s25, 1152
    s_cbranch_scc1 Lsel_49
    s_sub_u32 s25, s25, 1152
    s_mov_b32 s22, 75497472
    s_mov_b32 s23, 4096
    s_mov_b32 s24, 1
    s_mov_b32 s26, 576
Lsel_49:
    s_mul_i32 s27, s5, 147456
    s_mov_b32 s28, 1152
    s_lshl_b32 s29, s20, 6
    s_mov_b32 s30, 0
    s_mov_b32 s31, 0
    v_lshrrev_b32 v24, 3, v0
    v_mul_u32_u24 v24, 144, v24
    v_and_b32 v25, 7, v0
    v_lshl_add_u32 v16, v25, 4, v24
    v_add_u32 v17, 36864, v16
    v_lshrrev_b32 v24, 4, v0
    v_mul_u32_u24 v24, 288, v24
    v_and_b32 v25, 15, v0
    v_lshl_add_u32 v18, v25, 4, v24
    v_add_u32 v18, 18432, v18
    v_add_u32 v19, 36864, v18
    v_lshrrev_b32 v24, 7, v0
    v_mul_u32_u24 v24, 64, v24
    v_and_b32 v25, 15, v0
    v_add_u32 v24, v24, v25
    v_mul_u32_u24 v24, 144, v24
    v_bfe_u32 v25, v0, 4, 2
    v_lshl_add_u32 v20, v25, 4, v24
    v_add_u32 v21, 36864, v20
    v_bfe_u32 v24, v0, 4, 2
    v_lshlrev_b32 v24, 3, v24
    v_bfe_u32 v25, v0, 2, 2
    v_add_u32 v24, v24, v25
    v_mul_u32_u24 v24, 288, v24
    v_bfe_u32 v25, v0, 6, 1
    v_mul_u32_u24 v25, 128, v25
    v_add_u32 v24, v24, v25
    v_and_b32 v25, 3, v0
    v_lshl_add_u32 v22, v25, 3, v24
    v_add_u32 v22, 18432, v22
    v_add_u32 v23, 36864, v22
    v_lshrrev_b32 v24, 3, v0
    v_mul_lo_u32 v24, v24, s28
    v_and_b32 v25, 7, v0
    v_lshl_add_u32 v24, v25, 4, v24
    v_add_u32 v8, s27, v24
    v_mov_b32 v26, s28
    v_lshl_add_u32 v9, v26, 5, v8
    v_lshl_add_u32 v10, v26, 5, v9
    v_lshl_add_u32 v11, v26, 5, v10
    v_lshrrev_b32 v24, 4, v0
    v_mul_lo_u32 v24, v24, s20
    v_and_b32 v25, 15, v0
    v_lshl_add_u32 v24, v25, 4, v24
    v_add_u32 v12, s21, v24
    v_mov_b32 v26, s20
    v_lshl_add_u32 v13, v26, 4, v12
    v_lshl_add_u32 v14, v26, 4, v13
    v_lshl_add_u32 v15, v26, 4, v14
    v_accvgpr_write_b32 a0, 0
    v_accvgpr_write_b32 a1, 0
    v_accvgpr_write_b32 a2, 0
    v_accvgpr_write_b32 a3, 0
    v_accvgpr_write_b32 a4, 0
    v_accvgpr_write_b32 a5, 0
    v_accvgpr_write_b32 a6, 0
    v_accvgpr_write_b32 a7, 0
    v_accvgpr_write_b32 a8, 0
    v_accvgpr_write_b32 a9, 0
    v_accvgpr_write_b32 a10, 0
    v_accvgpr_write_b32 a11, 0
    v_accvgpr_write_b32 a12, 0
    v_accvgpr_write_b32 a13, 0
    v_accvgpr_write_b32 a14, 0
    v_accvgpr_write_b32 a15, 0
    v_accvgpr_write_b32 a16, 0
    v_accvgpr_write_b32 a17, 0
    v_accvgpr_write_b32 a18, 0
    v_accvgpr_write_b32 a19, 0
    v_accvgpr_write_b32 a20, 0
    v_accvgpr_write_b32 a21, 0
    v_accvgpr_write_b32 a22, 0
    v_accvgpr_write_b32 a23, 0
    v_accvgpr_write_b32 a24, 0
    v_accvgpr_write_b32 a25, 0
    v_accvgpr_write_b32 a26, 0
    v_accvgpr_write_b32 a27, 0
    v_accvgpr_write_b32 a28, 0
    v_accvgpr_write_b32 a29, 0
    v_accvgpr_write_b32 a30, 0
    v_accvgpr_write_b32 a31, 0
    v_accvgpr_write_b32 a32, 0
    v_accvgpr_write_b32 a33, 0
    v_accvgpr_write_b32 a34, 0
    v_accvgpr_write_b32 a35, 0
    v_accvgpr_write_b32 a36, 0
    v_accvgpr_write_b32 a37, 0
    v_accvgpr_write_b32 a38, 0
    v_accvgpr_write_b32 a39, 0
    v_accvgpr_write_b32 a40, 0
    v_accvgpr_write_b32 a41, 0
    v_accvgpr_write_b32 a42, 0
    v_accvgpr_write_b32 a43, 0
    v_accvgpr_write_b32 a44, 0
    v_accvgpr_write_b32 a45, 0
    v_accvgpr_write_b32 a46, 0
    v_accvgpr_write_b32 a47, 0
    v_accvgpr_write_b32 a48, 0
    v_accvgpr_write_b32 a49, 0
    v_accvgpr_write_b32 a50, 0
    v_accvgpr_write_b32 a51, 0
    v_accvgpr_write_b32 a52, 0
    v_accvgpr_write_b32 a53, 0
    v_accvgpr_write_b32 a54, 0
    v_accvgpr_write_b32 a55, 0
    v_accvgpr_write_b32 a56, 0
    v_accvgpr_write_b32 a57, 0
    v_accvgpr_write_b32 a58, 0
    v_accvgpr_write_b32 a59, 0
    v_accvgpr_write_b32 a60, 0
    v_accvgpr_write_b32 a61, 0
    v_accvgpr_write_b32 a62, 0
    v_accvgpr_write_b32 a63, 0
    s_cmp_eq_u32 s24, 1
    s_nop 0
    s_cbranch_scc1 Lv1_50
    buffer_load_dwordx4 v[28:31], v8, s[8:11], s30 offen
    buffer_load_dwordx4 v[32:35], v9, s[8:11], s30 offen
    buffer_load_dwordx4 v[36:39], v10, s[8:11], s30 offen
    buffer_load_dwordx4 v[40:43], v11, s[8:11], s30 offen
    buffer_load_dwordx4 v[44:47], v12, s[12:15], s31 offen
    buffer_load_dwordx4 v[48:51], v13, s[12:15], s31 offen
    buffer_load_dwordx4 v[52:55], v14, s[12:15], s31 offen
    buffer_load_dwordx4 v[56:59], v15, s[12:15], s31 offen
    s_waitcnt vmcnt(0)
    ds_write_b128 v16, v[28:31] offset:0
    ds_write_b128 v16, v[32:35] offset:4608
    ds_write_b128 v16, v[36:39] offset:9216
    ds_write_b128 v16, v[40:43] offset:13824
    ds_write_b128 v18, v[44:47] offset:0
    ds_write_b128 v18, v[48:51] offset:4608
    ds_write_b128 v18, v[52:55] offset:9216
    ds_write_b128 v18, v[56:59] offset:13824
    s_add_u32 s30, s30, 128
    s_add_u32 s31, s31, s29
    buffer_load_dwordx4 v[28:31], v8, s[8:11], s30 offen
    buffer_load_dwordx4 v[32:35], v9, s[8:11], s30 offen
    buffer_load_dwordx4 v[36:39], v10, s[8:11], s30 offen
    buffer_load_dwordx4 v[40:43], v11, s[8:11], s30 offen
    buffer_load_dwordx4 v[44:47], v12, s[12:15], s31 offen
    buffer_load_dwordx4 v[48:51], v13, s[12:15], s31 offen
    buffer_load_dwordx4 v[52:55], v14, s[12:15], s31 offen
    buffer_load_dwordx4 v[56:59], v15, s[12:15], s31 offen
    s_waitcnt lgkmcnt(0)
    s_barrier
    ds_read_b128 v[60:63], v20 offset:0
    ds_read_b128 v[64:67], v20 offset:2304
    ds_read_b128 v[68:71], v20 offset:4608
    ds_read_b128 v[72:75], v20 offset:6912
    ds_read_b64_tr_b16 v[92:93], v22 offset:0
    ds_read_b64_tr_b16 v[94:95], v22 offset:1152
    ds_read_b64_tr_b16 v[96:97], v22 offset:32
    ds_read_b64_tr_b16 v[98:99], v22 offset:1184
    ds_read_b64_tr_b16 v[100:101], v22 offset:64
    ds_read_b64_tr_b16 v[102:103], v22 offset:1216
    ds_read_b64_tr_b16 v[104:105], v22 offset:96
    ds_read_b64_tr_b16 v[106:107], v22 offset:1248
    ds_read_b128 v[76:79], v20 offset:64
    ds_read_b128 v[80:83], v20 offset:2368
    ds_read_b128 v[84:87], v20 offset:4672
    ds_read_b128 v[88:91], v20 offset:6976
    ds_read_b64_tr_b16 v[108:109], v22 offset:9216
    ds_read_b64_tr_b16 v[110:111], v22 offset:10368
    ds_read_b64_tr_b16 v[112:113], v22 offset:9248
    ds_read_b64_tr_b16 v[114:115], v22 offset:10400
    ds_read_b64_tr_b16 v[116:117], v22 offset:9280
    ds_read_b64_tr_b16 v[118:119], v22 offset:10432
    ds_read_b64_tr_b16 v[120:121], v22 offset:9312
    ds_read_b64_tr_b16 v[122:123], v22 offset:10464
    s_waitcnt lgkmcnt(12)
    v_mfma_f32_16x16x32_bf16 a[0:3], v[92:95], v[60:63], a[0:3]
    v_mfma_f32_16x16x32_bf16 a[4:7], v[96:99], v[60:63], a[4:7]
    v_mfma_f32_16x16x32_bf16 a[8:11], v[100:103], v[60:63], a[8:11]
    v_mfma_f32_16x16x32_bf16 a[12:15], v[104:107], v[60:63], a[12:15]
    v_mfma_f32_16x16x32_bf16 a[16:19], v[92:95], v[64:67], a[16:19]
    v_mfma_f32_16x16x32_bf16 a[20:23], v[96:99], v[64:67], a[20:23]
    v_mfma_f32_16x16x32_bf16 a[24:27], v[100:103], v[64:67], a[24:27]
    v_mfma_f32_16x16x32_bf16 a[28:31], v[104:107], v[64:67], a[28:31]
    v_mfma_f32_16x16x32_bf16 a[32:35], v[92:95], v[68:71], a[32:35]
    v_mfma_f32_16x16x32_bf16 a[36:39], v[96:99], v[68:71], a[36:39]
    v_mfma_f32_16x16x32_bf16 a[40:43], v[100:103], v[68:71], a[40:43]
    v_mfma_f32_16x16x32_bf16 a[44:47], v[104:107], v[68:71], a[44:47]
    v_mfma_f32_16x16x32_bf16 a[48:51], v[92:95], v[72:75], a[48:51]
    v_mfma_f32_16x16x32_bf16 a[52:55], v[96:99], v[72:75], a[52:55]
    v_mfma_f32_16x16x32_bf16 a[56:59], v[100:103], v[72:75], a[56:59]
    v_mfma_f32_16x16x32_bf16 a[60:63], v[104:107], v[72:75], a[60:63]
    s_waitcnt lgkmcnt(0)
    s_waitcnt vmcnt(0)
    ds_write_b128 v17, v[28:31] offset:0
    ds_write_b128 v17, v[32:35] offset:4608
    ds_write_b128 v17, v[36:39] offset:9216
    ds_write_b128 v17, v[40:43] offset:13824
    ds_write_b128 v19, v[44:47] offset:0
    ds_write_b128 v19, v[48:51] offset:4608
    ds_write_b128 v19, v[52:55] offset:9216
    ds_write_b128 v19, v[56:59] offset:13824
    s_add_u32 s30, s30, 128
    s_add_u32 s31, s31, s29
    buffer_load_dwordx4 v[28:31], v8, s[8:11], s30 offen
    buffer_load_dwordx4 v[32:35], v9, s[8:11], s30 offen
    buffer_load_dwordx4 v[36:39], v10, s[8:11], s30 offen
    buffer_load_dwordx4 v[40:43], v11, s[8:11], s30 offen
    buffer_load_dwordx4 v[44:47], v12, s[12:15], s31 offen
    buffer_load_dwordx4 v[48:51], v13, s[12:15], s31 offen
    buffer_load_dwordx4 v[52:55], v14, s[12:15], s31 offen
    buffer_load_dwordx4 v[56:59], v15, s[12:15], s31 offen
    v_mfma_f32_16x16x32_bf16 a[0:3], v[108:111], v[76:79], a[0:3]
    v_mfma_f32_16x16x32_bf16 a[4:7], v[112:115], v[76:79], a[4:7]
    v_mfma_f32_16x16x32_bf16 a[8:11], v[116:119], v[76:79], a[8:11]
    v_mfma_f32_16x16x32_bf16 a[12:15], v[120:123], v[76:79], a[12:15]
    v_mfma_f32_16x16x32_bf16 a[16:19], v[108:111], v[80:83], a[16:19]
    v_mfma_f32_16x16x32_bf16 a[20:23], v[112:115], v[80:83], a[20:23]
    v_mfma_f32_16x16x32_bf16 a[24:27], v[116:119], v[80:83], a[24:27]
    v_mfma_f32_16x16x32_bf16 a[28:31], v[120:123], v[80:83], a[28:31]
    v_mfma_f32_16x16x32_bf16 a[32:35], v[108:111], v[84:87], a[32:35]
    v_mfma_f32_16x16x32_bf16 a[36:39], v[112:115], v[84:87], a[36:39]
    v_mfma_f32_16x16x32_bf16 a[40:43], v[116:119], v[84:87], a[40:43]
    v_mfma_f32_16x16x32_bf16 a[44:47], v[120:123], v[84:87], a[44:47]
    v_mfma_f32_16x16x32_bf16 a[48:51], v[108:111], v[88:91], a[48:51]
    v_mfma_f32_16x16x32_bf16 a[52:55], v[112:115], v[88:91], a[52:55]
    v_mfma_f32_16x16x32_bf16 a[56:59], v[116:119], v[88:91], a[56:59]
    v_mfma_f32_16x16x32_bf16 a[60:63], v[120:123], v[88:91], a[60:63]
    s_waitcnt lgkmcnt(0)
    s_barrier
    ds_read_b128 v[60:63], v21 offset:0
    ds_read_b128 v[64:67], v21 offset:2304
    ds_read_b128 v[68:71], v21 offset:4608
    ds_read_b128 v[72:75], v21 offset:6912
    ds_read_b64_tr_b16 v[92:93], v23 offset:0
    ds_read_b64_tr_b16 v[94:95], v23 offset:1152
    ds_read_b64_tr_b16 v[96:97], v23 offset:32
    ds_read_b64_tr_b16 v[98:99], v23 offset:1184
    ds_read_b64_tr_b16 v[100:101], v23 offset:64
    ds_read_b64_tr_b16 v[102:103], v23 offset:1216
    ds_read_b64_tr_b16 v[104:105], v23 offset:96
    ds_read_b64_tr_b16 v[106:107], v23 offset:1248
    ds_read_b128 v[76:79], v21 offset:64
    ds_read_b128 v[80:83], v21 offset:2368
    ds_read_b128 v[84:87], v21 offset:4672
    ds_read_b128 v[88:91], v21 offset:6976
    ds_read_b64_tr_b16 v[108:109], v23 offset:9216
    ds_read_b64_tr_b16 v[110:111], v23 offset:10368
    ds_read_b64_tr_b16 v[112:113], v23 offset:9248
    ds_read_b64_tr_b16 v[114:115], v23 offset:10400
    ds_read_b64_tr_b16 v[116:117], v23 offset:9280
    ds_read_b64_tr_b16 v[118:119], v23 offset:10432
    ds_read_b64_tr_b16 v[120:121], v23 offset:9312
    ds_read_b64_tr_b16 v[122:123], v23 offset:10464
    s_waitcnt lgkmcnt(12)
    v_mfma_f32_16x16x32_bf16 a[0:3], v[92:95], v[60:63], a[0:3]
    v_mfma_f32_16x16x32_bf16 a[4:7], v[96:99], v[60:63], a[4:7]
    v_mfma_f32_16x16x32_bf16 a[8:11], v[100:103], v[60:63], a[8:11]
    v_mfma_f32_16x16x32_bf16 a[12:15], v[104:107], v[60:63], a[12:15]
    v_mfma_f32_16x16x32_bf16 a[16:19], v[92:95], v[64:67], a[16:19]
    v_mfma_f32_16x16x32_bf16 a[20:23], v[96:99], v[64:67], a[20:23]
    v_mfma_f32_16x16x32_bf16 a[24:27], v[100:103], v[64:67], a[24:27]
    v_mfma_f32_16x16x32_bf16 a[28:31], v[104:107], v[64:67], a[28:31]
    v_mfma_f32_16x16x32_bf16 a[32:35], v[92:95], v[68:71], a[32:35]
    v_mfma_f32_16x16x32_bf16 a[36:39], v[96:99], v[68:71], a[36:39]
    v_mfma_f32_16x16x32_bf16 a[40:43], v[100:103], v[68:71], a[40:43]
    v_mfma_f32_16x16x32_bf16 a[44:47], v[104:107], v[68:71], a[44:47]
    v_mfma_f32_16x16x32_bf16 a[48:51], v[92:95], v[72:75], a[48:51]
    v_mfma_f32_16x16x32_bf16 a[52:55], v[96:99], v[72:75], a[52:55]
    v_mfma_f32_16x16x32_bf16 a[56:59], v[100:103], v[72:75], a[56:59]
    v_mfma_f32_16x16x32_bf16 a[60:63], v[104:107], v[72:75], a[60:63]
    s_waitcnt lgkmcnt(0)
    s_waitcnt vmcnt(0)
    ds_write_b128 v16, v[28:31] offset:0
    ds_write_b128 v16, v[32:35] offset:4608
    ds_write_b128 v16, v[36:39] offset:9216
    ds_write_b128 v16, v[40:43] offset:13824
    ds_write_b128 v18, v[44:47] offset:0
    ds_write_b128 v18, v[48:51] offset:4608
    ds_write_b128 v18, v[52:55] offset:9216
    ds_write_b128 v18, v[56:59] offset:13824
    s_add_u32 s30, s30, 128
    s_add_u32 s31, s31, s29
    buffer_load_dwordx4 v[28:31], v8, s[8:11], s30 offen
    buffer_load_dwordx4 v[32:35], v9, s[8:11], s30 offen
    buffer_load_dwordx4 v[36:39], v10, s[8:11], s30 offen
    buffer_load_dwordx4 v[40:43], v11, s[8:11], s30 offen
    buffer_load_dwordx4 v[44:47], v12, s[12:15], s31 offen
    buffer_load_dwordx4 v[48:51], v13, s[12:15], s31 offen
    buffer_load_dwordx4 v[52:55], v14, s[12:15], s31 offen
    buffer_load_dwordx4 v[56:59], v15, s[12:15], s31 offen
    v_mfma_f32_16x16x32_bf16 a[0:3], v[108:111], v[76:79], a[0:3]
    v_mfma_f32_16x16x32_bf16 a[4:7], v[112:115], v[76:79], a[4:7]
    v_mfma_f32_16x16x32_bf16 a[8:11], v[116:119], v[76:79], a[8:11]
    v_mfma_f32_16x16x32_bf16 a[12:15], v[120:123], v[76:79], a[12:15]
    v_mfma_f32_16x16x32_bf16 a[16:19], v[108:111], v[80:83], a[16:19]
    v_mfma_f32_16x16x32_bf16 a[20:23], v[112:115], v[80:83], a[20:23]
    v_mfma_f32_16x16x32_bf16 a[24:27], v[116:119], v[80:83], a[24:27]
    v_mfma_f32_16x16x32_bf16 a[28:31], v[120:123], v[80:83], a[28:31]
    v_mfma_f32_16x16x32_bf16 a[32:35], v[108:111], v[84:87], a[32:35]
    v_mfma_f32_16x16x32_bf16 a[36:39], v[112:115], v[84:87], a[36:39]
    v_mfma_f32_16x16x32_bf16 a[40:43], v[116:119], v[84:87], a[40:43]
    v_mfma_f32_16x16x32_bf16 a[44:47], v[120:123], v[84:87], a[44:47]
    v_mfma_f32_16x16x32_bf16 a[48:51], v[108:111], v[88:91], a[48:51]
    v_mfma_f32_16x16x32_bf16 a[52:55], v[112:115], v[88:91], a[52:55]
    v_mfma_f32_16x16x32_bf16 a[56:59], v[116:119], v[88:91], a[56:59]
    v_mfma_f32_16x16x32_bf16 a[60:63], v[120:123], v[88:91], a[60:63]
    s_waitcnt lgkmcnt(0)
    s_barrier
    ds_read_b128 v[60:63], v20 offset:0
    ds_read_b128 v[64:67], v20 offset:2304
    ds_read_b128 v[68:71], v20 offset:4608
    ds_read_b128 v[72:75], v20 offset:6912
    ds_read_b64_tr_b16 v[92:93], v22 offset:0
    ds_read_b64_tr_b16 v[94:95], v22 offset:1152
    ds_read_b64_tr_b16 v[96:97], v22 offset:32
    ds_read_b64_tr_b16 v[98:99], v22 offset:1184
    ds_read_b64_tr_b16 v[100:101], v22 offset:64
    ds_read_b64_tr_b16 v[102:103], v22 offset:1216
    ds_read_b64_tr_b16 v[104:105], v22 offset:96
    ds_read_b64_tr_b16 v[106:107], v22 offset:1248
    ds_read_b128 v[76:79], v20 offset:64
    ds_read_b128 v[80:83], v20 offset:2368
    ds_read_b128 v[84:87], v20 offset:4672
    ds_read_b128 v[88:91], v20 offset:6976
    ds_read_b64_tr_b16 v[108:109], v22 offset:9216
    ds_read_b64_tr_b16 v[110:111], v22 offset:10368
    ds_read_b64_tr_b16 v[112:113], v22 offset:9248
    ds_read_b64_tr_b16 v[114:115], v22 offset:10400
    ds_read_b64_tr_b16 v[116:117], v22 offset:9280
    ds_read_b64_tr_b16 v[118:119], v22 offset:10432
    ds_read_b64_tr_b16 v[120:121], v22 offset:9312
    ds_read_b64_tr_b16 v[122:123], v22 offset:10464
    s_waitcnt lgkmcnt(12)
    v_mfma_f32_16x16x32_bf16 a[0:3], v[92:95], v[60:63], a[0:3]
    v_mfma_f32_16x16x32_bf16 a[4:7], v[96:99], v[60:63], a[4:7]
    v_mfma_f32_16x16x32_bf16 a[8:11], v[100:103], v[60:63], a[8:11]
    v_mfma_f32_16x16x32_bf16 a[12:15], v[104:107], v[60:63], a[12:15]
    v_mfma_f32_16x16x32_bf16 a[16:19], v[92:95], v[64:67], a[16:19]
    v_mfma_f32_16x16x32_bf16 a[20:23], v[96:99], v[64:67], a[20:23]
    v_mfma_f32_16x16x32_bf16 a[24:27], v[100:103], v[64:67], a[24:27]
    v_mfma_f32_16x16x32_bf16 a[28:31], v[104:107], v[64:67], a[28:31]
    v_mfma_f32_16x16x32_bf16 a[32:35], v[92:95], v[68:71], a[32:35]
    v_mfma_f32_16x16x32_bf16 a[36:39], v[96:99], v[68:71], a[36:39]
    v_mfma_f32_16x16x32_bf16 a[40:43], v[100:103], v[68:71], a[40:43]
    v_mfma_f32_16x16x32_bf16 a[44:47], v[104:107], v[68:71], a[44:47]
    v_mfma_f32_16x16x32_bf16 a[48:51], v[92:95], v[72:75], a[48:51]
    v_mfma_f32_16x16x32_bf16 a[52:55], v[96:99], v[72:75], a[52:55]
    v_mfma_f32_16x16x32_bf16 a[56:59], v[100:103], v[72:75], a[56:59]
    v_mfma_f32_16x16x32_bf16 a[60:63], v[104:107], v[72:75], a[60:63]
    s_waitcnt lgkmcnt(0)
    s_waitcnt vmcnt(0)
    ds_write_b128 v17, v[28:31] offset:0
    ds_write_b128 v17, v[32:35] offset:4608
    ds_write_b128 v17, v[36:39] offset:9216
    ds_write_b128 v17, v[40:43] offset:13824
    ds_write_b128 v19, v[44:47] offset:0
    ds_write_b128 v19, v[48:51] offset:4608
    ds_write_b128 v19, v[52:55] offset:9216
    ds_write_b128 v19, v[56:59] offset:13824
    s_add_u32 s30, s30, 128
    s_add_u32 s31, s31, s29
    buffer_load_dwordx4 v[28:31], v8, s[8:11], s30 offen
    buffer_load_dwordx4 v[32:35], v9, s[8:11], s30 offen
    buffer_load_dwordx4 v[36:39], v10, s[8:11], s30 offen
    buffer_load_dwordx4 v[40:43], v11, s[8:11], s30 offen
    buffer_load_dwordx4 v[44:47], v12, s[12:15], s31 offen
    buffer_load_dwordx4 v[48:51], v13, s[12:15], s31 offen
    buffer_load_dwordx4 v[52:55], v14, s[12:15], s31 offen
    buffer_load_dwordx4 v[56:59], v15, s[12:15], s31 offen
    v_mfma_f32_16x16x32_bf16 a[0:3], v[108:111], v[76:79], a[0:3]
    v_mfma_f32_16x16x32_bf16 a[4:7], v[112:115], v[76:79], a[4:7]
    v_mfma_f32_16x16x32_bf16 a[8:11], v[116:119], v[76:79], a[8:11]
    v_mfma_f32_16x16x32_bf16 a[12:15], v[120:123], v[76:79], a[12:15]
    v_mfma_f32_16x16x32_bf16 a[16:19], v[108:111], v[80:83], a[16:19]
    v_mfma_f32_16x16x32_bf16 a[20:23], v[112:115], v[80:83], a[20:23]
    v_mfma_f32_16x16x32_bf16 a[24:27], v[116:119], v[80:83], a[24:27]
    v_mfma_f32_16x16x32_bf16 a[28:31], v[120:123], v[80:83], a[28:31]
    v_mfma_f32_16x16x32_bf16 a[32:35], v[108:111], v[84:87], a[32:35]
    v_mfma_f32_16x16x32_bf16 a[36:39], v[112:115], v[84:87], a[36:39]
    v_mfma_f32_16x16x32_bf16 a[40:43], v[116:119], v[84:87], a[40:43]
    v_mfma_f32_16x16x32_bf16 a[44:47], v[120:123], v[84:87], a[44:47]
    v_mfma_f32_16x16x32_bf16 a[48:51], v[108:111], v[88:91], a[48:51]
    v_mfma_f32_16x16x32_bf16 a[52:55], v[112:115], v[88:91], a[52:55]
    v_mfma_f32_16x16x32_bf16 a[56:59], v[116:119], v[88:91], a[56:59]
    v_mfma_f32_16x16x32_bf16 a[60:63], v[120:123], v[88:91], a[60:63]
    s_waitcnt lgkmcnt(0)
    s_barrier
    ds_read_b128 v[60:63], v21 offset:0
    ds_read_b128 v[64:67], v21 offset:2304
    ds_read_b128 v[68:71], v21 offset:4608
    ds_read_b128 v[72:75], v21 offset:6912
    ds_read_b64_tr_b16 v[92:93], v23 offset:0
    ds_read_b64_tr_b16 v[94:95], v23 offset:1152
    ds_read_b64_tr_b16 v[96:97], v23 offset:32
    ds_read_b64_tr_b16 v[98:99], v23 offset:1184
    ds_read_b64_tr_b16 v[100:101], v23 offset:64
    ds_read_b64_tr_b16 v[102:103], v23 offset:1216
    ds_read_b64_tr_b16 v[104:105], v23 offset:96
    ds_read_b64_tr_b16 v[106:107], v23 offset:1248
    ds_read_b128 v[76:79], v21 offset:64
    ds_read_b128 v[80:83], v21 offset:2368
    ds_read_b128 v[84:87], v21 offset:4672
    ds_read_b128 v[88:91], v21 offset:6976
    ds_read_b64_tr_b16 v[108:109], v23 offset:9216
    ds_read_b64_tr_b16 v[110:111], v23 offset:10368
    ds_read_b64_tr_b16 v[112:113], v23 offset:9248
    ds_read_b64_tr_b16 v[114:115], v23 offset:10400
    ds_read_b64_tr_b16 v[116:117], v23 offset:9280
    ds_read_b64_tr_b16 v[118:119], v23 offset:10432
    ds_read_b64_tr_b16 v[120:121], v23 offset:9312
    ds_read_b64_tr_b16 v[122:123], v23 offset:10464
    s_waitcnt lgkmcnt(12)
    v_mfma_f32_16x16x32_bf16 a[0:3], v[92:95], v[60:63], a[0:3]
    v_mfma_f32_16x16x32_bf16 a[4:7], v[96:99], v[60:63], a[4:7]
    v_mfma_f32_16x16x32_bf16 a[8:11], v[100:103], v[60:63], a[8:11]
    v_mfma_f32_16x16x32_bf16 a[12:15], v[104:107], v[60:63], a[12:15]
    v_mfma_f32_16x16x32_bf16 a[16:19], v[92:95], v[64:67], a[16:19]
    v_mfma_f32_16x16x32_bf16 a[20:23], v[96:99], v[64:67], a[20:23]
    v_mfma_f32_16x16x32_bf16 a[24:27], v[100:103], v[64:67], a[24:27]
    v_mfma_f32_16x16x32_bf16 a[28:31], v[104:107], v[64:67], a[28:31]
    v_mfma_f32_16x16x32_bf16 a[32:35], v[92:95], v[68:71], a[32:35]
    v_mfma_f32_16x16x32_bf16 a[36:39], v[96:99], v[68:71], a[36:39]
    v_mfma_f32_16x16x32_bf16 a[40:43], v[100:103], v[68:71], a[40:43]
    v_mfma_f32_16x16x32_bf16 a[44:47], v[104:107], v[68:71], a[44:47]
    v_mfma_f32_16x16x32_bf16 a[48:51], v[92:95], v[72:75], a[48:51]
    v_mfma_f32_16x16x32_bf16 a[52:55], v[96:99], v[72:75], a[52:55]
    v_mfma_f32_16x16x32_bf16 a[56:59], v[100:103], v[72:75], a[56:59]
    v_mfma_f32_16x16x32_bf16 a[60:63], v[104:107], v[72:75], a[60:63]
    s_waitcnt lgkmcnt(0)
    s_waitcnt vmcnt(0)
    ds_write_b128 v16, v[28:31] offset:0
    ds_write_b128 v16, v[32:35] offset:4608
    ds_write_b128 v16, v[36:39] offset:9216
    ds_write_b128 v16, v[40:43] offset:13824
    ds_write_b128 v18, v[44:47] offset:0
    ds_write_b128 v18, v[48:51] offset:4608
    ds_write_b128 v18, v[52:55] offset:9216
    ds_write_b128 v18, v[56:59] offset:13824
    s_add_u32 s30, s30, 128
    s_add_u32 s31, s31, s29
    buffer_load_dwordx4 v[28:31], v8, s[8:11], s30 offen
    buffer_load_dwordx4 v[32:35], v9, s[8:11], s30 offen
    buffer_load_dwordx4 v[36:39], v10, s[8:11], s30 offen
    buffer_load_dwordx4 v[40:43], v11, s[8:11], s30 offen
    buffer_load_dwordx4 v[44:47], v12, s[12:15], s31 offen
    buffer_load_dwordx4 v[48:51], v13, s[12:15], s31 offen
    buffer_load_dwordx4 v[52:55], v14, s[12:15], s31 offen
    buffer_load_dwordx4 v[56:59], v15, s[12:15], s31 offen
    v_mfma_f32_16x16x32_bf16 a[0:3], v[108:111], v[76:79], a[0:3]
    v_mfma_f32_16x16x32_bf16 a[4:7], v[112:115], v[76:79], a[4:7]
    v_mfma_f32_16x16x32_bf16 a[8:11], v[116:119], v[76:79], a[8:11]
    v_mfma_f32_16x16x32_bf16 a[12:15], v[120:123], v[76:79], a[12:15]
    v_mfma_f32_16x16x32_bf16 a[16:19], v[108:111], v[80:83], a[16:19]
    v_mfma_f32_16x16x32_bf16 a[20:23], v[112:115], v[80:83], a[20:23]
    v_mfma_f32_16x16x32_bf16 a[24:27], v[116:119], v[80:83], a[24:27]
    v_mfma_f32_16x16x32_bf16 a[28:31], v[120:123], v[80:83], a[28:31]
    v_mfma_f32_16x16x32_bf16 a[32:35], v[108:111], v[84:87], a[32:35]
    v_mfma_f32_16x16x32_bf16 a[36:39], v[112:115], v[84:87], a[36:39]
    v_mfma_f32_16x16x32_bf16 a[40:43], v[116:119], v[84:87], a[40:43]
    v_mfma_f32_16x16x32_bf16 a[44:47], v[120:123], v[84:87], a[44:47]
    v_mfma_f32_16x16x32_bf16 a[48:51], v[108:111], v[88:91], a[48:51]
    v_mfma_f32_16x16x32_bf16 a[52:55], v[112:115], v[88:91], a[52:55]
    v_mfma_f32_16x16x32_bf16 a[56:59], v[116:119], v[88:91], a[56:59]
    v_mfma_f32_16x16x32_bf16 a[60:63], v[120:123], v[88:91], a[60:63]
    s_waitcnt lgkmcnt(0)
    s_barrier
    ds_read_b128 v[60:63], v20 offset:0
    ds_read_b128 v[64:67], v20 offset:2304
    ds_read_b128 v[68:71], v20 offset:4608
    ds_read_b128 v[72:75], v20 offset:6912
    ds_read_b64_tr_b16 v[92:93], v22 offset:0
    ds_read_b64_tr_b16 v[94:95], v22 offset:1152
    ds_read_b64_tr_b16 v[96:97], v22 offset:32
    ds_read_b64_tr_b16 v[98:99], v22 offset:1184
    ds_read_b64_tr_b16 v[100:101], v22 offset:64
    ds_read_b64_tr_b16 v[102:103], v22 offset:1216
    ds_read_b64_tr_b16 v[104:105], v22 offset:96
    ds_read_b64_tr_b16 v[106:107], v22 offset:1248
    ds_read_b128 v[76:79], v20 offset:64
    ds_read_b128 v[80:83], v20 offset:2368
    ds_read_b128 v[84:87], v20 offset:4672
    ds_read_b128 v[88:91], v20 offset:6976
    ds_read_b64_tr_b16 v[108:109], v22 offset:9216
    ds_read_b64_tr_b16 v[110:111], v22 offset:10368
    ds_read_b64_tr_b16 v[112:113], v22 offset:9248
    ds_read_b64_tr_b16 v[114:115], v22 offset:10400
    ds_read_b64_tr_b16 v[116:117], v22 offset:9280
    ds_read_b64_tr_b16 v[118:119], v22 offset:10432
    ds_read_b64_tr_b16 v[120:121], v22 offset:9312
    ds_read_b64_tr_b16 v[122:123], v22 offset:10464
    s_waitcnt lgkmcnt(12)
    v_mfma_f32_16x16x32_bf16 a[0:3], v[92:95], v[60:63], a[0:3]
    v_mfma_f32_16x16x32_bf16 a[4:7], v[96:99], v[60:63], a[4:7]
    v_mfma_f32_16x16x32_bf16 a[8:11], v[100:103], v[60:63], a[8:11]
    v_mfma_f32_16x16x32_bf16 a[12:15], v[104:107], v[60:63], a[12:15]
    v_mfma_f32_16x16x32_bf16 a[16:19], v[92:95], v[64:67], a[16:19]
    v_mfma_f32_16x16x32_bf16 a[20:23], v[96:99], v[64:67], a[20:23]
    v_mfma_f32_16x16x32_bf16 a[24:27], v[100:103], v[64:67], a[24:27]
    v_mfma_f32_16x16x32_bf16 a[28:31], v[104:107], v[64:67], a[28:31]
    v_mfma_f32_16x16x32_bf16 a[32:35], v[92:95], v[68:71], a[32:35]
    v_mfma_f32_16x16x32_bf16 a[36:39], v[96:99], v[68:71], a[36:39]
    v_mfma_f32_16x16x32_bf16 a[40:43], v[100:103], v[68:71], a[40:43]
    v_mfma_f32_16x16x32_bf16 a[44:47], v[104:107], v[68:71], a[44:47]
    v_mfma_f32_16x16x32_bf16 a[48:51], v[92:95], v[72:75], a[48:51]
    v_mfma_f32_16x16x32_bf16 a[52:55], v[96:99], v[72:75], a[52:55]
    v_mfma_f32_16x16x32_bf16 a[56:59], v[100:103], v[72:75], a[56:59]
    v_mfma_f32_16x16x32_bf16 a[60:63], v[104:107], v[72:75], a[60:63]
    s_waitcnt lgkmcnt(0)
    s_waitcnt vmcnt(0)
    ds_write_b128 v17, v[28:31] offset:0
    ds_write_b128 v17, v[32:35] offset:4608
    ds_write_b128 v17, v[36:39] offset:9216
    ds_write_b128 v17, v[40:43] offset:13824
    ds_write_b128 v19, v[44:47] offset:0
    ds_write_b128 v19, v[48:51] offset:4608
    ds_write_b128 v19, v[52:55] offset:9216
    ds_write_b128 v19, v[56:59] offset:13824
    s_add_u32 s30, s30, 128
    s_add_u32 s31, s31, s29
    buffer_load_dwordx4 v[28:31], v8, s[8:11], s30 offen
    buffer_load_dwordx4 v[32:35], v9, s[8:11], s30 offen
    buffer_load_dwordx4 v[36:39], v10, s[8:11], s30 offen
    buffer_load_dwordx4 v[40:43], v11, s[8:11], s30 offen
    buffer_load_dwordx4 v[44:47], v12, s[12:15], s31 offen
    buffer_load_dwordx4 v[48:51], v13, s[12:15], s31 offen
    buffer_load_dwordx4 v[52:55], v14, s[12:15], s31 offen
    buffer_load_dwordx4 v[56:59], v15, s[12:15], s31 offen
    v_mfma_f32_16x16x32_bf16 a[0:3], v[108:111], v[76:79], a[0:3]
    v_mfma_f32_16x16x32_bf16 a[4:7], v[112:115], v[76:79], a[4:7]
    v_mfma_f32_16x16x32_bf16 a[8:11], v[116:119], v[76:79], a[8:11]
    v_mfma_f32_16x16x32_bf16 a[12:15], v[120:123], v[76:79], a[12:15]
    v_mfma_f32_16x16x32_bf16 a[16:19], v[108:111], v[80:83], a[16:19]
    v_mfma_f32_16x16x32_bf16 a[20:23], v[112:115], v[80:83], a[20:23]
    v_mfma_f32_16x16x32_bf16 a[24:27], v[116:119], v[80:83], a[24:27]
    v_mfma_f32_16x16x32_bf16 a[28:31], v[120:123], v[80:83], a[28:31]
    v_mfma_f32_16x16x32_bf16 a[32:35], v[108:111], v[84:87], a[32:35]
    v_mfma_f32_16x16x32_bf16 a[36:39], v[112:115], v[84:87], a[36:39]
    v_mfma_f32_16x16x32_bf16 a[40:43], v[116:119], v[84:87], a[40:43]
    v_mfma_f32_16x16x32_bf16 a[44:47], v[120:123], v[84:87], a[44:47]
    v_mfma_f32_16x16x32_bf16 a[48:51], v[108:111], v[88:91], a[48:51]
    v_mfma_f32_16x16x32_bf16 a[52:55], v[112:115], v[88:91], a[52:55]
    v_mfma_f32_16x16x32_bf16 a[56:59], v[116:119], v[88:91], a[56:59]
    v_mfma_f32_16x16x32_bf16 a[60:63], v[120:123], v[88:91], a[60:63]
    s_waitcnt lgkmcnt(0)
    s_barrier
    ds_read_b128 v[60:63], v21 offset:0
    ds_read_b128 v[64:67], v21 offset:2304
    ds_read_b128 v[68:71], v21 offset:4608
    ds_read_b128 v[72:75], v21 offset:6912
    ds_read_b64_tr_b16 v[92:93], v23 offset:0
    ds_read_b64_tr_b16 v[94:95], v23 offset:1152
    ds_read_b64_tr_b16 v[96:97], v23 offset:32
    ds_read_b64_tr_b16 v[98:99], v23 offset:1184
    ds_read_b64_tr_b16 v[100:101], v23 offset:64
    ds_read_b64_tr_b16 v[102:103], v23 offset:1216
    ds_read_b64_tr_b16 v[104:105], v23 offset:96
    ds_read_b64_tr_b16 v[106:107], v23 offset:1248
    ds_read_b128 v[76:79], v21 offset:64
    ds_read_b128 v[80:83], v21 offset:2368
    ds_read_b128 v[84:87], v21 offset:4672
    ds_read_b128 v[88:91], v21 offset:6976
    ds_read_b64_tr_b16 v[108:109], v23 offset:9216
    ds_read_b64_tr_b16 v[110:111], v23 offset:10368
    ds_read_b64_tr_b16 v[112:113], v23 offset:9248
    ds_read_b64_tr_b16 v[114:115], v23 offset:10400
    ds_read_b64_tr_b16 v[116:117], v23 offset:9280
    ds_read_b64_tr_b16 v[118:119], v23 offset:10432
    ds_read_b64_tr_b16 v[120:121], v23 offset:9312
    ds_read_b64_tr_b16 v[122:123], v23 offset:10464
    s_waitcnt lgkmcnt(12)
    v_mfma_f32_16x16x32_bf16 a[0:3], v[92:95], v[60:63], a[0:3]
    v_mfma_f32_16x16x32_bf16 a[4:7], v[96:99], v[60:63], a[4:7]
    v_mfma_f32_16x16x32_bf16 a[8:11], v[100:103], v[60:63], a[8:11]
    v_mfma_f32_16x16x32_bf16 a[12:15], v[104:107], v[60:63], a[12:15]
    v_mfma_f32_16x16x32_bf16 a[16:19], v[92:95], v[64:67], a[16:19]
    v_mfma_f32_16x16x32_bf16 a[20:23], v[96:99], v[64:67], a[20:23]
    v_mfma_f32_16x16x32_bf16 a[24:27], v[100:103], v[64:67], a[24:27]
    v_mfma_f32_16x16x32_bf16 a[28:31], v[104:107], v[64:67], a[28:31]
    v_mfma_f32_16x16x32_bf16 a[32:35], v[92:95], v[68:71], a[32:35]
    v_mfma_f32_16x16x32_bf16 a[36:39], v[96:99], v[68:71], a[36:39]
    v_mfma_f32_16x16x32_bf16 a[40:43], v[100:103], v[68:71], a[40:43]
    v_mfma_f32_16x16x32_bf16 a[44:47], v[104:107], v[68:71], a[44:47]
    v_mfma_f32_16x16x32_bf16 a[48:51], v[92:95], v[72:75], a[48:51]
    v_mfma_f32_16x16x32_bf16 a[52:55], v[96:99], v[72:75], a[52:55]
    v_mfma_f32_16x16x32_bf16 a[56:59], v[100:103], v[72:75], a[56:59]
    v_mfma_f32_16x16x32_bf16 a[60:63], v[104:107], v[72:75], a[60:63]
    s_waitcnt lgkmcnt(0)
    s_waitcnt vmcnt(0)
    ds_write_b128 v16, v[28:31] offset:0
    ds_write_b128 v16, v[32:35] offset:4608
    ds_write_b128 v16, v[36:39] offset:9216
    ds_write_b128 v16, v[40:43] offset:13824
    ds_write_b128 v18, v[44:47] offset:0
    ds_write_b128 v18, v[48:51] offset:4608
    ds_write_b128 v18, v[52:55] offset:9216
    ds_write_b128 v18, v[56:59] offset:13824
    s_add_u32 s30, s30, 128
    s_add_u32 s31, s31, s29
    buffer_load_dwordx4 v[28:31], v8, s[8:11], s30 offen
    buffer_load_dwordx4 v[32:35], v9, s[8:11], s30 offen
    buffer_load_dwordx4 v[36:39], v10, s[8:11], s30 offen
    buffer_load_dwordx4 v[40:43], v11, s[8:11], s30 offen
    buffer_load_dwordx4 v[44:47], v12, s[12:15], s31 offen
    buffer_load_dwordx4 v[48:51], v13, s[12:15], s31 offen
    buffer_load_dwordx4 v[52:55], v14, s[12:15], s31 offen
    buffer_load_dwordx4 v[56:59], v15, s[12:15], s31 offen
    v_mfma_f32_16x16x32_bf16 a[0:3], v[108:111], v[76:79], a[0:3]
    v_mfma_f32_16x16x32_bf16 a[4:7], v[112:115], v[76:79], a[4:7]
    v_mfma_f32_16x16x32_bf16 a[8:11], v[116:119], v[76:79], a[8:11]
    v_mfma_f32_16x16x32_bf16 a[12:15], v[120:123], v[76:79], a[12:15]
    v_mfma_f32_16x16x32_bf16 a[16:19], v[108:111], v[80:83], a[16:19]
    v_mfma_f32_16x16x32_bf16 a[20:23], v[112:115], v[80:83], a[20:23]
    v_mfma_f32_16x16x32_bf16 a[24:27], v[116:119], v[80:83], a[24:27]
    v_mfma_f32_16x16x32_bf16 a[28:31], v[120:123], v[80:83], a[28:31]
    v_mfma_f32_16x16x32_bf16 a[32:35], v[108:111], v[84:87], a[32:35]
    v_mfma_f32_16x16x32_bf16 a[36:39], v[112:115], v[84:87], a[36:39]
    v_mfma_f32_16x16x32_bf16 a[40:43], v[116:119], v[84:87], a[40:43]
    v_mfma_f32_16x16x32_bf16 a[44:47], v[120:123], v[84:87], a[44:47]
    v_mfma_f32_16x16x32_bf16 a[48:51], v[108:111], v[88:91], a[48:51]
    v_mfma_f32_16x16x32_bf16 a[52:55], v[112:115], v[88:91], a[52:55]
    v_mfma_f32_16x16x32_bf16 a[56:59], v[116:119], v[88:91], a[56:59]
    v_mfma_f32_16x16x32_bf16 a[60:63], v[120:123], v[88:91], a[60:63]
    s_waitcnt lgkmcnt(0)
    s_barrier
    ds_read_b128 v[60:63], v20 offset:0
    ds_read_b128 v[64:67], v20 offset:2304
    ds_read_b128 v[68:71], v20 offset:4608
    ds_read_b128 v[72:75], v20 offset:6912
    ds_read_b64_tr_b16 v[92:93], v22 offset:0
    ds_read_b64_tr_b16 v[94:95], v22 offset:1152
    ds_read_b64_tr_b16 v[96:97], v22 offset:32
    ds_read_b64_tr_b16 v[98:99], v22 offset:1184
    ds_read_b64_tr_b16 v[100:101], v22 offset:64
    ds_read_b64_tr_b16 v[102:103], v22 offset:1216
    ds_read_b64_tr_b16 v[104:105], v22 offset:96
    ds_read_b64_tr_b16 v[106:107], v22 offset:1248
    ds_read_b128 v[76:79], v20 offset:64
    ds_read_b128 v[80:83], v20 offset:2368
    ds_read_b128 v[84:87], v20 offset:4672
    ds_read_b128 v[88:91], v20 offset:6976
    ds_read_b64_tr_b16 v[108:109], v22 offset:9216
    ds_read_b64_tr_b16 v[110:111], v22 offset:10368
    ds_read_b64_tr_b16 v[112:113], v22 offset:9248
    ds_read_b64_tr_b16 v[114:115], v22 offset:10400
    ds_read_b64_tr_b16 v[116:117], v22 offset:9280
    ds_read_b64_tr_b16 v[118:119], v22 offset:10432
    ds_read_b64_tr_b16 v[120:121], v22 offset:9312
    ds_read_b64_tr_b16 v[122:123], v22 offset:10464
    s_waitcnt lgkmcnt(12)
    v_mfma_f32_16x16x32_bf16 a[0:3], v[92:95], v[60:63], a[0:3]
    v_mfma_f32_16x16x32_bf16 a[4:7], v[96:99], v[60:63], a[4:7]
    v_mfma_f32_16x16x32_bf16 a[8:11], v[100:103], v[60:63], a[8:11]
    v_mfma_f32_16x16x32_bf16 a[12:15], v[104:107], v[60:63], a[12:15]
    v_mfma_f32_16x16x32_bf16 a[16:19], v[92:95], v[64:67], a[16:19]
    v_mfma_f32_16x16x32_bf16 a[20:23], v[96:99], v[64:67], a[20:23]
    v_mfma_f32_16x16x32_bf16 a[24:27], v[100:103], v[64:67], a[24:27]
    v_mfma_f32_16x16x32_bf16 a[28:31], v[104:107], v[64:67], a[28:31]
    v_mfma_f32_16x16x32_bf16 a[32:35], v[92:95], v[68:71], a[32:35]
    v_mfma_f32_16x16x32_bf16 a[36:39], v[96:99], v[68:71], a[36:39]
    v_mfma_f32_16x16x32_bf16 a[40:43], v[100:103], v[68:71], a[40:43]
    v_mfma_f32_16x16x32_bf16 a[44:47], v[104:107], v[68:71], a[44:47]
    v_mfma_f32_16x16x32_bf16 a[48:51], v[92:95], v[72:75], a[48:51]
    v_mfma_f32_16x16x32_bf16 a[52:55], v[96:99], v[72:75], a[52:55]
    v_mfma_f32_16x16x32_bf16 a[56:59], v[100:103], v[72:75], a[56:59]
    v_mfma_f32_16x16x32_bf16 a[60:63], v[104:107], v[72:75], a[60:63]
    s_waitcnt lgkmcnt(0)
    s_waitcnt vmcnt(0)
    ds_write_b128 v17, v[28:31] offset:0
    ds_write_b128 v17, v[32:35] offset:4608
    ds_write_b128 v17, v[36:39] offset:9216
    ds_write_b128 v17, v[40:43] offset:13824
    ds_write_b128 v19, v[44:47] offset:0
    ds_write_b128 v19, v[48:51] offset:4608
    ds_write_b128 v19, v[52:55] offset:9216
    ds_write_b128 v19, v[56:59] offset:13824
    s_add_u32 s30, s30, 128
    s_add_u32 s31, s31, s29
    buffer_load_dwordx4 v[28:31], v8, s[8:11], s30 offen
    buffer_load_dwordx4 v[32:35], v9, s[8:11], s30 offen
    buffer_load_dwordx4 v[36:39], v10, s[8:11], s30 offen
    buffer_load_dwordx4 v[40:43], v11, s[8:11], s30 offen
    buffer_load_dwordx4 v[44:47], v12, s[12:15], s31 offen
    buffer_load_dwordx4 v[48:51], v13, s[12:15], s31 offen
    buffer_load_dwordx4 v[52:55], v14, s[12:15], s31 offen
    buffer_load_dwordx4 v[56:59], v15, s[12:15], s31 offen
    v_mfma_f32_16x16x32_bf16 a[0:3], v[108:111], v[76:79], a[0:3]
    v_mfma_f32_16x16x32_bf16 a[4:7], v[112:115], v[76:79], a[4:7]
    v_mfma_f32_16x16x32_bf16 a[8:11], v[116:119], v[76:79], a[8:11]
    v_mfma_f32_16x16x32_bf16 a[12:15], v[120:123], v[76:79], a[12:15]
    v_mfma_f32_16x16x32_bf16 a[16:19], v[108:111], v[80:83], a[16:19]
    v_mfma_f32_16x16x32_bf16 a[20:23], v[112:115], v[80:83], a[20:23]
    v_mfma_f32_16x16x32_bf16 a[24:27], v[116:119], v[80:83], a[24:27]
    v_mfma_f32_16x16x32_bf16 a[28:31], v[120:123], v[80:83], a[28:31]
    v_mfma_f32_16x16x32_bf16 a[32:35], v[108:111], v[84:87], a[32:35]
    v_mfma_f32_16x16x32_bf16 a[36:39], v[112:115], v[84:87], a[36:39]
    v_mfma_f32_16x16x32_bf16 a[40:43], v[116:119], v[84:87], a[40:43]
    v_mfma_f32_16x16x32_bf16 a[44:47], v[120:123], v[84:87], a[44:47]
    v_mfma_f32_16x16x32_bf16 a[48:51], v[108:111], v[88:91], a[48:51]
    v_mfma_f32_16x16x32_bf16 a[52:55], v[112:115], v[88:91], a[52:55]
    v_mfma_f32_16x16x32_bf16 a[56:59], v[116:119], v[88:91], a[56:59]
    v_mfma_f32_16x16x32_bf16 a[60:63], v[120:123], v[88:91], a[60:63]
    s_waitcnt lgkmcnt(0)
    s_barrier
    ds_read_b128 v[60:63], v21 offset:0
    ds_read_b128 v[64:67], v21 offset:2304
    ds_read_b128 v[68:71], v21 offset:4608
    ds_read_b128 v[72:75], v21 offset:6912
    ds_read_b64_tr_b16 v[92:93], v23 offset:0
    ds_read_b64_tr_b16 v[94:95], v23 offset:1152
    ds_read_b64_tr_b16 v[96:97], v23 offset:32
    ds_read_b64_tr_b16 v[98:99], v23 offset:1184
    ds_read_b64_tr_b16 v[100:101], v23 offset:64
    ds_read_b64_tr_b16 v[102:103], v23 offset:1216
    ds_read_b64_tr_b16 v[104:105], v23 offset:96
    ds_read_b64_tr_b16 v[106:107], v23 offset:1248
    ds_read_b128 v[76:79], v21 offset:64
    ds_read_b128 v[80:83], v21 offset:2368
    ds_read_b128 v[84:87], v21 offset:4672
    ds_read_b128 v[88:91], v21 offset:6976
    ds_read_b64_tr_b16 v[108:109], v23 offset:9216
    ds_read_b64_tr_b16 v[110:111], v23 offset:10368
    ds_read_b64_tr_b16 v[112:113], v23 offset:9248
    ds_read_b64_tr_b16 v[114:115], v23 offset:10400
    ds_read_b64_tr_b16 v[116:117], v23 offset:9280
    ds_read_b64_tr_b16 v[118:119], v23 offset:10432
    ds_read_b64_tr_b16 v[120:121], v23 offset:9312
    ds_read_b64_tr_b16 v[122:123], v23 offset:10464
    s_waitcnt lgkmcnt(12)
    v_mfma_f32_16x16x32_bf16 a[0:3], v[92:95], v[60:63], a[0:3]
    v_mfma_f32_16x16x32_bf16 a[4:7], v[96:99], v[60:63], a[4:7]
    v_mfma_f32_16x16x32_bf16 a[8:11], v[100:103], v[60:63], a[8:11]
    v_mfma_f32_16x16x32_bf16 a[12:15], v[104:107], v[60:63], a[12:15]
    v_mfma_f32_16x16x32_bf16 a[16:19], v[92:95], v[64:67], a[16:19]
    v_mfma_f32_16x16x32_bf16 a[20:23], v[96:99], v[64:67], a[20:23]
    v_mfma_f32_16x16x32_bf16 a[24:27], v[100:103], v[64:67], a[24:27]
    v_mfma_f32_16x16x32_bf16 a[28:31], v[104:107], v[64:67], a[28:31]
    v_mfma_f32_16x16x32_bf16 a[32:35], v[92:95], v[68:71], a[32:35]
    v_mfma_f32_16x16x32_bf16 a[36:39], v[96:99], v[68:71], a[36:39]
    v_mfma_f32_16x16x32_bf16 a[40:43], v[100:103], v[68:71], a[40:43]
    v_mfma_f32_16x16x32_bf16 a[44:47], v[104:107], v[68:71], a[44:47]
    v_mfma_f32_16x16x32_bf16 a[48:51], v[92:95], v[72:75], a[48:51]
    v_mfma_f32_16x16x32_bf16 a[52:55], v[96:99], v[72:75], a[52:55]
    v_mfma_f32_16x16x32_bf16 a[56:59], v[100:103], v[72:75], a[56:59]
    v_mfma_f32_16x16x32_bf16 a[60:63], v[104:107], v[72:75], a[60:63]
    s_waitcnt lgkmcnt(0)
    s_waitcnt vmcnt(0)
    ds_write_b128 v16, v[28:31] offset:0
    ds_write_b128 v16, v[32:35] offset:4608
    ds_write_b128 v16, v[36:39] offset:9216
    ds_write_b128 v16, v[40:43] offset:13824
    ds_write_b128 v18, v[44:47] offset:0
    ds_write_b128 v18, v[48:51] offset:4608
    ds_write_b128 v18, v[52:55] offset:9216
    ds_write_b128 v18, v[56:59] offset:13824
    v_mfma_f32_16x16x32_bf16 a[0:3], v[108:111], v[76:79], a[0:3]
    v_mfma_f32_16x16x32_bf16 a[4:7], v[112:115], v[76:79], a[4:7]
    v_mfma_f32_16x16x32_bf16 a[8:11], v[116:119], v[76:79], a[8:11]
    v_mfma_f32_16x16x32_bf16 a[12:15], v[120:123], v[76:79], a[12:15]
    v_mfma_f32_16x16x32_bf16 a[16:19], v[108:111], v[80:83], a[16:19]
    v_mfma_f32_16x16x32_bf16 a[20:23], v[112:115], v[80:83], a[20:23]
    v_mfma_f32_16x16x32_bf16 a[24:27], v[116:119], v[80:83], a[24:27]
    v_mfma_f32_16x16x32_bf16 a[28:31], v[120:123], v[80:83], a[28:31]
    v_mfma_f32_16x16x32_bf16 a[32:35], v[108:111], v[84:87], a[32:35]
    v_mfma_f32_16x16x32_bf16 a[36:39], v[112:115], v[84:87], a[36:39]
    v_mfma_f32_16x16x32_bf16 a[40:43], v[116:119], v[84:87], a[40:43]
    v_mfma_f32_16x16x32_bf16 a[44:47], v[120:123], v[84:87], a[44:47]
    v_mfma_f32_16x16x32_bf16 a[48:51], v[108:111], v[88:91], a[48:51]
    v_mfma_f32_16x16x32_bf16 a[52:55], v[112:115], v[88:91], a[52:55]
    v_mfma_f32_16x16x32_bf16 a[56:59], v[116:119], v[88:91], a[56:59]
    v_mfma_f32_16x16x32_bf16 a[60:63], v[120:123], v[88:91], a[60:63]
    s_waitcnt lgkmcnt(0)
    s_barrier
    ds_read_b128 v[60:63], v20 offset:0
    ds_read_b128 v[64:67], v20 offset:2304
    ds_read_b128 v[68:71], v20 offset:4608
    ds_read_b128 v[72:75], v20 offset:6912
    ds_read_b64_tr_b16 v[92:93], v22 offset:0
    ds_read_b64_tr_b16 v[94:95], v22 offset:1152
    ds_read_b64_tr_b16 v[96:97], v22 offset:32
    ds_read_b64_tr_b16 v[98:99], v22 offset:1184
    ds_read_b64_tr_b16 v[100:101], v22 offset:64
    ds_read_b64_tr_b16 v[102:103], v22 offset:1216
    ds_read_b64_tr_b16 v[104:105], v22 offset:96
    ds_read_b64_tr_b16 v[106:107], v22 offset:1248
    ds_read_b128 v[76:79], v20 offset:64
    ds_read_b128 v[80:83], v20 offset:2368
    ds_read_b128 v[84:87], v20 offset:4672
    ds_read_b128 v[88:91], v20 offset:6976
    ds_read_b64_tr_b16 v[108:109], v22 offset:9216
    ds_read_b64_tr_b16 v[110:111], v22 offset:10368
    ds_read_b64_tr_b16 v[112:113], v22 offset:9248
    ds_read_b64_tr_b16 v[114:115], v22 offset:10400
    ds_read_b64_tr_b16 v[116:117], v22 offset:9280
    ds_read_b64_tr_b16 v[118:119], v22 offset:10432
    ds_read_b64_tr_b16 v[120:121], v22 offset:9312
    ds_read_b64_tr_b16 v[122:123], v22 offset:10464
    s_waitcnt lgkmcnt(12)
    v_mfma_f32_16x16x32_bf16 a[0:3], v[92:95], v[60:63], a[0:3]
    v_mfma_f32_16x16x32_bf16 a[4:7], v[96:99], v[60:63], a[4:7]
    v_mfma_f32_16x16x32_bf16 a[8:11], v[100:103], v[60:63], a[8:11]
    v_mfma_f32_16x16x32_bf16 a[12:15], v[104:107], v[60:63], a[12:15]
    v_mfma_f32_16x16x32_bf16 a[16:19], v[92:95], v[64:67], a[16:19]
    v_mfma_f32_16x16x32_bf16 a[20:23], v[96:99], v[64:67], a[20:23]
    v_mfma_f32_16x16x32_bf16 a[24:27], v[100:103], v[64:67], a[24:27]
    v_mfma_f32_16x16x32_bf16 a[28:31], v[104:107], v[64:67], a[28:31]
    v_mfma_f32_16x16x32_bf16 a[32:35], v[92:95], v[68:71], a[32:35]
    v_mfma_f32_16x16x32_bf16 a[36:39], v[96:99], v[68:71], a[36:39]
    v_mfma_f32_16x16x32_bf16 a[40:43], v[100:103], v[68:71], a[40:43]
    v_mfma_f32_16x16x32_bf16 a[44:47], v[104:107], v[68:71], a[44:47]
    v_mfma_f32_16x16x32_bf16 a[48:51], v[92:95], v[72:75], a[48:51]
    v_mfma_f32_16x16x32_bf16 a[52:55], v[96:99], v[72:75], a[52:55]
    v_mfma_f32_16x16x32_bf16 a[56:59], v[100:103], v[72:75], a[56:59]
    v_mfma_f32_16x16x32_bf16 a[60:63], v[104:107], v[72:75], a[60:63]
    s_waitcnt lgkmcnt(0)
    v_mfma_f32_16x16x32_bf16 a[0:3], v[108:111], v[76:79], a[0:3]
    v_mfma_f32_16x16x32_bf16 a[4:7], v[112:115], v[76:79], a[4:7]
    v_mfma_f32_16x16x32_bf16 a[8:11], v[116:119], v[76:79], a[8:11]
    v_mfma_f32_16x16x32_bf16 a[12:15], v[120:123], v[76:79], a[12:15]
    v_mfma_f32_16x16x32_bf16 a[16:19], v[108:111], v[80:83], a[16:19]
    v_mfma_f32_16x16x32_bf16 a[20:23], v[112:115], v[80:83], a[20:23]
    v_mfma_f32_16x16x32_bf16 a[24:27], v[116:119], v[80:83], a[24:27]
    v_mfma_f32_16x16x32_bf16 a[28:31], v[120:123], v[80:83], a[28:31]
    v_mfma_f32_16x16x32_bf16 a[32:35], v[108:111], v[84:87], a[32:35]
    v_mfma_f32_16x16x32_bf16 a[36:39], v[112:115], v[84:87], a[36:39]
    v_mfma_f32_16x16x32_bf16 a[40:43], v[116:119], v[84:87], a[40:43]
    v_mfma_f32_16x16x32_bf16 a[44:47], v[120:123], v[84:87], a[44:47]
    v_mfma_f32_16x16x32_bf16 a[48:51], v[108:111], v[88:91], a[48:51]
    v_mfma_f32_16x16x32_bf16 a[52:55], v[112:115], v[88:91], a[52:55]
    v_mfma_f32_16x16x32_bf16 a[56:59], v[116:119], v[88:91], a[56:59]
    v_mfma_f32_16x16x32_bf16 a[60:63], v[120:123], v[88:91], a[60:63]
    s_cmp_eq_u32 s34, 1
    s_nop 6
    s_cbranch_scc1 Lf0_51
    v_lshrrev_b32 v24, 7, v0
    v_mul_u32_u24 v24, 64, v24
    v_and_b32 v25, 15, v0
    v_add_u32 v24, v24, v25
    s_mul_i32 s27, s5, 128
    v_add_u32 v24, s27, v24
    v_mul_lo_u32 v24, v24, s23
    v_bfe_u32 v25, v0, 6, 1
    v_mul_u32_u24 v25, 64, v25
    v_bfe_u32 v26, v0, 4, 2
    v_lshl_add_u32 v25, v26, 2, v25
    v_add_u32 v25, s25, v25
    v_lshl_add_u32 v24, v25, 1, v24
    v_add_u32 v24, s22, v24
    s_lshl_b32 s27, s23, 4
    v_accvgpr_read_b32 v60, a0
    v_accvgpr_read_b32 v61, a1
    v_accvgpr_read_b32 v62, a2
    v_accvgpr_read_b32 v63, a3
    v_cvt_pk_bf16_f32 v64, v60, v61
    v_cvt_pk_bf16_f32 v65, v62, v63
    buffer_store_dwordx2 v[64:65], v24, s[16:19], 0 offen offset:0 sc1
    v_accvgpr_read_b32 v68, a4
    v_accvgpr_read_b32 v69, a5
    v_accvgpr_read_b32 v70, a6
    v_accvgpr_read_b32 v71, a7
    v_cvt_pk_bf16_f32 v72, v68, v69
    v_cvt_pk_bf16_f32 v73, v70, v71
    buffer_store_dwordx2 v[72:73], v24, s[16:19], 0 offen offset:32 sc1
    v_accvgpr_read_b32 v76, a8
    v_accvgpr_read_b32 v77, a9
    v_accvgpr_read_b32 v78, a10
    v_accvgpr_read_b32 v79, a11
    v_cvt_pk_bf16_f32 v80, v76, v77
    v_cvt_pk_bf16_f32 v81, v78, v79
    buffer_store_dwordx2 v[80:81], v24, s[16:19], 0 offen offset:64 sc1
    v_accvgpr_read_b32 v84, a12
    v_accvgpr_read_b32 v85, a13
    v_accvgpr_read_b32 v86, a14
    v_accvgpr_read_b32 v87, a15
    v_cvt_pk_bf16_f32 v88, v84, v85
    v_cvt_pk_bf16_f32 v89, v86, v87
    buffer_store_dwordx2 v[88:89], v24, s[16:19], 0 offen offset:96 sc1
    v_add_u32 v24, s27, v24
    v_accvgpr_read_b32 v60, a16
    v_accvgpr_read_b32 v61, a17
    v_accvgpr_read_b32 v62, a18
    v_accvgpr_read_b32 v63, a19
    v_cvt_pk_bf16_f32 v64, v60, v61
    v_cvt_pk_bf16_f32 v65, v62, v63
    buffer_store_dwordx2 v[64:65], v24, s[16:19], 0 offen offset:0 sc1
    v_accvgpr_read_b32 v68, a20
    v_accvgpr_read_b32 v69, a21
    v_accvgpr_read_b32 v70, a22
    v_accvgpr_read_b32 v71, a23
    v_cvt_pk_bf16_f32 v72, v68, v69
    v_cvt_pk_bf16_f32 v73, v70, v71
    buffer_store_dwordx2 v[72:73], v24, s[16:19], 0 offen offset:32 sc1
    v_accvgpr_read_b32 v76, a24
    v_accvgpr_read_b32 v77, a25
    v_accvgpr_read_b32 v78, a26
    v_accvgpr_read_b32 v79, a27
    v_cvt_pk_bf16_f32 v80, v76, v77
    v_cvt_pk_bf16_f32 v81, v78, v79
    buffer_store_dwordx2 v[80:81], v24, s[16:19], 0 offen offset:64 sc1
    v_accvgpr_read_b32 v84, a28
    v_accvgpr_read_b32 v85, a29
    v_accvgpr_read_b32 v86, a30
    v_accvgpr_read_b32 v87, a31
    v_cvt_pk_bf16_f32 v88, v84, v85
    v_cvt_pk_bf16_f32 v89, v86, v87
    buffer_store_dwordx2 v[88:89], v24, s[16:19], 0 offen offset:96 sc1
    v_add_u32 v24, s27, v24
    v_accvgpr_read_b32 v60, a32
    v_accvgpr_read_b32 v61, a33
    v_accvgpr_read_b32 v62, a34
    v_accvgpr_read_b32 v63, a35
    v_cvt_pk_bf16_f32 v64, v60, v61
    v_cvt_pk_bf16_f32 v65, v62, v63
    buffer_store_dwordx2 v[64:65], v24, s[16:19], 0 offen offset:0 sc1
    v_accvgpr_read_b32 v68, a36
    v_accvgpr_read_b32 v69, a37
    v_accvgpr_read_b32 v70, a38
    v_accvgpr_read_b32 v71, a39
    v_cvt_pk_bf16_f32 v72, v68, v69
    v_cvt_pk_bf16_f32 v73, v70, v71
    buffer_store_dwordx2 v[72:73], v24, s[16:19], 0 offen offset:32 sc1
    v_accvgpr_read_b32 v76, a40
    v_accvgpr_read_b32 v77, a41
    v_accvgpr_read_b32 v78, a42
    v_accvgpr_read_b32 v79, a43
    v_cvt_pk_bf16_f32 v80, v76, v77
    v_cvt_pk_bf16_f32 v81, v78, v79
    buffer_store_dwordx2 v[80:81], v24, s[16:19], 0 offen offset:64 sc1
    v_accvgpr_read_b32 v84, a44
    v_accvgpr_read_b32 v85, a45
    v_accvgpr_read_b32 v86, a46
    v_accvgpr_read_b32 v87, a47
    v_cvt_pk_bf16_f32 v88, v84, v85
    v_cvt_pk_bf16_f32 v89, v86, v87
    buffer_store_dwordx2 v[88:89], v24, s[16:19], 0 offen offset:96 sc1
    v_add_u32 v24, s27, v24
    v_accvgpr_read_b32 v60, a48
    v_accvgpr_read_b32 v61, a49
    v_accvgpr_read_b32 v62, a50
    v_accvgpr_read_b32 v63, a51
    v_cvt_pk_bf16_f32 v64, v60, v61
    v_cvt_pk_bf16_f32 v65, v62, v63
    buffer_store_dwordx2 v[64:65], v24, s[16:19], 0 offen offset:0 sc1
    v_accvgpr_read_b32 v68, a52
    v_accvgpr_read_b32 v69, a53
    v_accvgpr_read_b32 v70, a54
    v_accvgpr_read_b32 v71, a55
    v_cvt_pk_bf16_f32 v72, v68, v69
    v_cvt_pk_bf16_f32 v73, v70, v71
    buffer_store_dwordx2 v[72:73], v24, s[16:19], 0 offen offset:32 sc1
    v_accvgpr_read_b32 v76, a56
    v_accvgpr_read_b32 v77, a57
    v_accvgpr_read_b32 v78, a58
    v_accvgpr_read_b32 v79, a59
    v_cvt_pk_bf16_f32 v80, v76, v77
    v_cvt_pk_bf16_f32 v81, v78, v79
    buffer_store_dwordx2 v[80:81], v24, s[16:19], 0 offen offset:64 sc1
    v_accvgpr_read_b32 v84, a60
    v_accvgpr_read_b32 v85, a61
    v_accvgpr_read_b32 v86, a62
    v_accvgpr_read_b32 v87, a63
    v_cvt_pk_bf16_f32 v88, v84, v85
    v_cvt_pk_bf16_f32 v89, v86, v87
    buffer_store_dwordx2 v[88:89], v24, s[16:19], 0 offen offset:96 sc1
    s_nop 0
    s_branch Lpf_44
Lf0_51:
    v_lshrrev_b32 v24, 7, v0
    v_mul_u32_u24 v24, 524288, v24
    v_bfe_u32 v25, v0, 6, 1
    v_mul_u32_u24 v25, 2048, v25
    v_add_u32 v24, v24, v25
    v_and_b32 v25, 63, v0
    v_lshl_add_u32 v24, v25, 4, v24
    s_mul_i32 s27, s5, 1048576
    s_lshl_b32 s28, s25, 5
    s_add_u32 s27, s27, s28
    s_add_u32 s27, s27, s22
    v_add_u32 v24, s27, v24
    v_accvgpr_read_b32 v60, a0
    v_accvgpr_read_b32 v61, a1
    v_accvgpr_read_b32 v62, a2
    v_accvgpr_read_b32 v63, a3
    v_accvgpr_read_b32 v64, a4
    v_accvgpr_read_b32 v65, a5
    v_accvgpr_read_b32 v66, a6
    v_accvgpr_read_b32 v67, a7
    v_cvt_pk_bf16_f32 v68, v60, v61
    v_cvt_pk_bf16_f32 v69, v62, v63
    v_cvt_pk_bf16_f32 v70, v64, v65
    v_cvt_pk_bf16_f32 v71, v66, v67
    buffer_store_dwordx4 v[68:71], v24, s[16:19], 0 offen offset:0 sc1
    v_accvgpr_read_b32 v72, a8
    v_accvgpr_read_b32 v73, a9
    v_accvgpr_read_b32 v74, a10
    v_accvgpr_read_b32 v75, a11
    v_accvgpr_read_b32 v76, a12
    v_accvgpr_read_b32 v77, a13
    v_accvgpr_read_b32 v78, a14
    v_accvgpr_read_b32 v79, a15
    v_cvt_pk_bf16_f32 v80, v72, v73
    v_cvt_pk_bf16_f32 v81, v74, v75
    v_cvt_pk_bf16_f32 v82, v76, v77
    v_cvt_pk_bf16_f32 v83, v78, v79
    buffer_store_dwordx4 v[80:83], v24, s[16:19], 0 offen offset:1024 sc1
    v_add_u32 v24, 131072, v24
    v_accvgpr_read_b32 v84, a16
    v_accvgpr_read_b32 v85, a17
    v_accvgpr_read_b32 v86, a18
    v_accvgpr_read_b32 v87, a19
    v_accvgpr_read_b32 v88, a20
    v_accvgpr_read_b32 v89, a21
    v_accvgpr_read_b32 v90, a22
    v_accvgpr_read_b32 v91, a23
    v_cvt_pk_bf16_f32 v92, v84, v85
    v_cvt_pk_bf16_f32 v93, v86, v87
    v_cvt_pk_bf16_f32 v94, v88, v89
    v_cvt_pk_bf16_f32 v95, v90, v91
    buffer_store_dwordx4 v[92:95], v24, s[16:19], 0 offen offset:0 sc1
    v_accvgpr_read_b32 v60, a24
    v_accvgpr_read_b32 v61, a25
    v_accvgpr_read_b32 v62, a26
    v_accvgpr_read_b32 v63, a27
    v_accvgpr_read_b32 v64, a28
    v_accvgpr_read_b32 v65, a29
    v_accvgpr_read_b32 v66, a30
    v_accvgpr_read_b32 v67, a31
    v_cvt_pk_bf16_f32 v68, v60, v61
    v_cvt_pk_bf16_f32 v69, v62, v63
    v_cvt_pk_bf16_f32 v70, v64, v65
    v_cvt_pk_bf16_f32 v71, v66, v67
    buffer_store_dwordx4 v[68:71], v24, s[16:19], 0 offen offset:1024 sc1
    v_add_u32 v24, 131072, v24
    v_accvgpr_read_b32 v72, a32
    v_accvgpr_read_b32 v73, a33
    v_accvgpr_read_b32 v74, a34
    v_accvgpr_read_b32 v75, a35
    v_accvgpr_read_b32 v76, a36
    v_accvgpr_read_b32 v77, a37
    v_accvgpr_read_b32 v78, a38
    v_accvgpr_read_b32 v79, a39
    v_cvt_pk_bf16_f32 v80, v72, v73
    v_cvt_pk_bf16_f32 v81, v74, v75
    v_cvt_pk_bf16_f32 v82, v76, v77
    v_cvt_pk_bf16_f32 v83, v78, v79
    buffer_store_dwordx4 v[80:83], v24, s[16:19], 0 offen offset:0 sc1
    v_accvgpr_read_b32 v84, a40
    v_accvgpr_read_b32 v85, a41
    v_accvgpr_read_b32 v86, a42
    v_accvgpr_read_b32 v87, a43
    v_accvgpr_read_b32 v88, a44
    v_accvgpr_read_b32 v89, a45
    v_accvgpr_read_b32 v90, a46
    v_accvgpr_read_b32 v91, a47
    v_cvt_pk_bf16_f32 v92, v84, v85
    v_cvt_pk_bf16_f32 v93, v86, v87
    v_cvt_pk_bf16_f32 v94, v88, v89
    v_cvt_pk_bf16_f32 v95, v90, v91
    buffer_store_dwordx4 v[92:95], v24, s[16:19], 0 offen offset:1024 sc1
    v_add_u32 v24, 131072, v24
    v_accvgpr_read_b32 v60, a48
    v_accvgpr_read_b32 v61, a49
    v_accvgpr_read_b32 v62, a50
    v_accvgpr_read_b32 v63, a51
    v_accvgpr_read_b32 v64, a52
    v_accvgpr_read_b32 v65, a53
    v_accvgpr_read_b32 v66, a54
    v_accvgpr_read_b32 v67, a55
    v_cvt_pk_bf16_f32 v68, v60, v61
    v_cvt_pk_bf16_f32 v69, v62, v63
    v_cvt_pk_bf16_f32 v70, v64, v65
    v_cvt_pk_bf16_f32 v71, v66, v67
    buffer_store_dwordx4 v[68:71], v24, s[16:19], 0 offen offset:0 sc1
    v_accvgpr_read_b32 v72, a56
    v_accvgpr_read_b32 v73, a57
    v_accvgpr_read_b32 v74, a58
    v_accvgpr_read_b32 v75, a59
    v_accvgpr_read_b32 v76, a60
    v_accvgpr_read_b32 v77, a61
    v_accvgpr_read_b32 v78, a62
    v_accvgpr_read_b32 v79, a63
    v_cvt_pk_bf16_f32 v80, v72, v73
    v_cvt_pk_bf16_f32 v81, v74, v75
    v_cvt_pk_bf16_f32 v82, v76, v77
    v_cvt_pk_bf16_f32 v83, v78, v79
    buffer_store_dwordx4 v[80:83], v24, s[16:19], 0 offen offset:1024 sc1
    s_nop 1
    s_branch Lpf_44
Lv1_50:
    buffer_load_dwordx4 v[28:31], v8, s[8:11], s30 offen
    buffer_load_dwordx4 v[32:35], v9, s[8:11], s30 offen
    buffer_load_dwordx4 v[36:39], v10, s[8:11], s30 offen
    buffer_load_dwordx4 v[40:43], v11, s[8:11], s30 offen
    buffer_load_dwordx4 v[44:47], v12, s[12:15], s31 offen
    buffer_load_dwordx4 v[48:51], v13, s[12:15], s31 offen
    buffer_load_dwordx4 v[52:55], v14, s[12:15], s31 offen
    buffer_load_dwordx4 v[56:59], v15, s[12:15], s31 offen
    s_waitcnt vmcnt(0)
    ds_write_b128 v16, v[28:31] offset:0
    ds_write_b128 v16, v[32:35] offset:4608
    ds_write_b128 v16, v[36:39] offset:9216
    ds_write_b128 v16, v[40:43] offset:13824
    ds_write_b128 v18, v[44:47] offset:0
    ds_write_b128 v18, v[48:51] offset:4608
    ds_write_b128 v18, v[52:55] offset:9216
    ds_write_b128 v18, v[56:59] offset:13824
    s_add_u32 s30, s30, 128
    s_add_u32 s31, s31, s29
    buffer_load_dwordx4 v[28:31], v8, s[8:11], s30 offen
    buffer_load_dwordx4 v[32:35], v9, s[8:11], s30 offen
    buffer_load_dwordx4 v[36:39], v10, s[8:11], s30 offen
    buffer_load_dwordx4 v[40:43], v11, s[8:11], s30 offen
    buffer_load_dwordx4 v[44:47], v12, s[12:15], s31 offen
    buffer_load_dwordx4 v[48:51], v13, s[12:15], s31 offen
    buffer_load_dwordx4 v[52:55], v14, s[12:15], s31 offen
    buffer_load_dwordx4 v[56:59], v15, s[12:15], s31 offen
    s_waitcnt lgkmcnt(0)
    s_barrier
    ds_read_b128 v[60:63], v20 offset:0
    ds_read_b128 v[64:67], v20 offset:2304
    ds_read_b128 v[68:71], v20 offset:4608
    ds_read_b128 v[72:75], v20 offset:6912
    ds_read_b64_tr_b16 v[92:93], v22 offset:0
    ds_read_b64_tr_b16 v[94:95], v22 offset:1152
    ds_read_b64_tr_b16 v[96:97], v22 offset:32
    ds_read_b64_tr_b16 v[98:99], v22 offset:1184
    ds_read_b64_tr_b16 v[100:101], v22 offset:64
    ds_read_b64_tr_b16 v[102:103], v22 offset:1216
    ds_read_b64_tr_b16 v[104:105], v22 offset:96
    ds_read_b64_tr_b16 v[106:107], v22 offset:1248
    ds_read_b128 v[76:79], v20 offset:64
    ds_read_b128 v[80:83], v20 offset:2368
    ds_read_b128 v[84:87], v20 offset:4672
    ds_read_b128 v[88:91], v20 offset:6976
    ds_read_b64_tr_b16 v[108:109], v22 offset:9216
    ds_read_b64_tr_b16 v[110:111], v22 offset:10368
    ds_read_b64_tr_b16 v[112:113], v22 offset:9248
    ds_read_b64_tr_b16 v[114:115], v22 offset:10400
    ds_read_b64_tr_b16 v[116:117], v22 offset:9280
    ds_read_b64_tr_b16 v[118:119], v22 offset:10432
    ds_read_b64_tr_b16 v[120:121], v22 offset:9312
    ds_read_b64_tr_b16 v[122:123], v22 offset:10464
    s_waitcnt lgkmcnt(12)
    v_mfma_f32_16x16x32_bf16 a[0:3], v[60:63], v[92:95], a[0:3]
    v_mfma_f32_16x16x32_bf16 a[4:7], v[60:63], v[96:99], a[4:7]
    v_mfma_f32_16x16x32_bf16 a[8:11], v[60:63], v[100:103], a[8:11]
    v_mfma_f32_16x16x32_bf16 a[12:15], v[60:63], v[104:107], a[12:15]
    v_mfma_f32_16x16x32_bf16 a[16:19], v[64:67], v[92:95], a[16:19]
    v_mfma_f32_16x16x32_bf16 a[20:23], v[64:67], v[96:99], a[20:23]
    v_mfma_f32_16x16x32_bf16 a[24:27], v[64:67], v[100:103], a[24:27]
    v_mfma_f32_16x16x32_bf16 a[28:31], v[64:67], v[104:107], a[28:31]
    v_mfma_f32_16x16x32_bf16 a[32:35], v[68:71], v[92:95], a[32:35]
    v_mfma_f32_16x16x32_bf16 a[36:39], v[68:71], v[96:99], a[36:39]
    v_mfma_f32_16x16x32_bf16 a[40:43], v[68:71], v[100:103], a[40:43]
    v_mfma_f32_16x16x32_bf16 a[44:47], v[68:71], v[104:107], a[44:47]
    v_mfma_f32_16x16x32_bf16 a[48:51], v[72:75], v[92:95], a[48:51]
    v_mfma_f32_16x16x32_bf16 a[52:55], v[72:75], v[96:99], a[52:55]
    v_mfma_f32_16x16x32_bf16 a[56:59], v[72:75], v[100:103], a[56:59]
    v_mfma_f32_16x16x32_bf16 a[60:63], v[72:75], v[104:107], a[60:63]
    s_waitcnt lgkmcnt(0)
    s_waitcnt vmcnt(0)
    ds_write_b128 v17, v[28:31] offset:0
    ds_write_b128 v17, v[32:35] offset:4608
    ds_write_b128 v17, v[36:39] offset:9216
    ds_write_b128 v17, v[40:43] offset:13824
    ds_write_b128 v19, v[44:47] offset:0
    ds_write_b128 v19, v[48:51] offset:4608
    ds_write_b128 v19, v[52:55] offset:9216
    ds_write_b128 v19, v[56:59] offset:13824
    s_add_u32 s30, s30, 128
    s_add_u32 s31, s31, s29
    buffer_load_dwordx4 v[28:31], v8, s[8:11], s30 offen
    buffer_load_dwordx4 v[32:35], v9, s[8:11], s30 offen
    buffer_load_dwordx4 v[36:39], v10, s[8:11], s30 offen
    buffer_load_dwordx4 v[40:43], v11, s[8:11], s30 offen
    buffer_load_dwordx4 v[44:47], v12, s[12:15], s31 offen
    buffer_load_dwordx4 v[48:51], v13, s[12:15], s31 offen
    buffer_load_dwordx4 v[52:55], v14, s[12:15], s31 offen
    buffer_load_dwordx4 v[56:59], v15, s[12:15], s31 offen
    v_mfma_f32_16x16x32_bf16 a[0:3], v[76:79], v[108:111], a[0:3]
    v_mfma_f32_16x16x32_bf16 a[4:7], v[76:79], v[112:115], a[4:7]
    v_mfma_f32_16x16x32_bf16 a[8:11], v[76:79], v[116:119], a[8:11]
    v_mfma_f32_16x16x32_bf16 a[12:15], v[76:79], v[120:123], a[12:15]
    v_mfma_f32_16x16x32_bf16 a[16:19], v[80:83], v[108:111], a[16:19]
    v_mfma_f32_16x16x32_bf16 a[20:23], v[80:83], v[112:115], a[20:23]
    v_mfma_f32_16x16x32_bf16 a[24:27], v[80:83], v[116:119], a[24:27]
    v_mfma_f32_16x16x32_bf16 a[28:31], v[80:83], v[120:123], a[28:31]
    v_mfma_f32_16x16x32_bf16 a[32:35], v[84:87], v[108:111], a[32:35]
    v_mfma_f32_16x16x32_bf16 a[36:39], v[84:87], v[112:115], a[36:39]
    v_mfma_f32_16x16x32_bf16 a[40:43], v[84:87], v[116:119], a[40:43]
    v_mfma_f32_16x16x32_bf16 a[44:47], v[84:87], v[120:123], a[44:47]
    v_mfma_f32_16x16x32_bf16 a[48:51], v[88:91], v[108:111], a[48:51]
    v_mfma_f32_16x16x32_bf16 a[52:55], v[88:91], v[112:115], a[52:55]
    v_mfma_f32_16x16x32_bf16 a[56:59], v[88:91], v[116:119], a[56:59]
    v_mfma_f32_16x16x32_bf16 a[60:63], v[88:91], v[120:123], a[60:63]
    s_waitcnt lgkmcnt(0)
    s_barrier
    ds_read_b128 v[60:63], v21 offset:0
    ds_read_b128 v[64:67], v21 offset:2304
    ds_read_b128 v[68:71], v21 offset:4608
    ds_read_b128 v[72:75], v21 offset:6912
    ds_read_b64_tr_b16 v[92:93], v23 offset:0
    ds_read_b64_tr_b16 v[94:95], v23 offset:1152
    ds_read_b64_tr_b16 v[96:97], v23 offset:32
    ds_read_b64_tr_b16 v[98:99], v23 offset:1184
    ds_read_b64_tr_b16 v[100:101], v23 offset:64
    ds_read_b64_tr_b16 v[102:103], v23 offset:1216
    ds_read_b64_tr_b16 v[104:105], v23 offset:96
    ds_read_b64_tr_b16 v[106:107], v23 offset:1248
    ds_read_b128 v[76:79], v21 offset:64
    ds_read_b128 v[80:83], v21 offset:2368
    ds_read_b128 v[84:87], v21 offset:4672
    ds_read_b128 v[88:91], v21 offset:6976
    ds_read_b64_tr_b16 v[108:109], v23 offset:9216
    ds_read_b64_tr_b16 v[110:111], v23 offset:10368
    ds_read_b64_tr_b16 v[112:113], v23 offset:9248
    ds_read_b64_tr_b16 v[114:115], v23 offset:10400
    ds_read_b64_tr_b16 v[116:117], v23 offset:9280
    ds_read_b64_tr_b16 v[118:119], v23 offset:10432
    ds_read_b64_tr_b16 v[120:121], v23 offset:9312
    ds_read_b64_tr_b16 v[122:123], v23 offset:10464
    s_waitcnt lgkmcnt(12)
    v_mfma_f32_16x16x32_bf16 a[0:3], v[60:63], v[92:95], a[0:3]
    v_mfma_f32_16x16x32_bf16 a[4:7], v[60:63], v[96:99], a[4:7]
    v_mfma_f32_16x16x32_bf16 a[8:11], v[60:63], v[100:103], a[8:11]
    v_mfma_f32_16x16x32_bf16 a[12:15], v[60:63], v[104:107], a[12:15]
    v_mfma_f32_16x16x32_bf16 a[16:19], v[64:67], v[92:95], a[16:19]
    v_mfma_f32_16x16x32_bf16 a[20:23], v[64:67], v[96:99], a[20:23]
    v_mfma_f32_16x16x32_bf16 a[24:27], v[64:67], v[100:103], a[24:27]
    v_mfma_f32_16x16x32_bf16 a[28:31], v[64:67], v[104:107], a[28:31]
    v_mfma_f32_16x16x32_bf16 a[32:35], v[68:71], v[92:95], a[32:35]
    v_mfma_f32_16x16x32_bf16 a[36:39], v[68:71], v[96:99], a[36:39]
    v_mfma_f32_16x16x32_bf16 a[40:43], v[68:71], v[100:103], a[40:43]
    v_mfma_f32_16x16x32_bf16 a[44:47], v[68:71], v[104:107], a[44:47]
    v_mfma_f32_16x16x32_bf16 a[48:51], v[72:75], v[92:95], a[48:51]
    v_mfma_f32_16x16x32_bf16 a[52:55], v[72:75], v[96:99], a[52:55]
    v_mfma_f32_16x16x32_bf16 a[56:59], v[72:75], v[100:103], a[56:59]
    v_mfma_f32_16x16x32_bf16 a[60:63], v[72:75], v[104:107], a[60:63]
    s_waitcnt lgkmcnt(0)
    s_waitcnt vmcnt(0)
    ds_write_b128 v16, v[28:31] offset:0
    ds_write_b128 v16, v[32:35] offset:4608
    ds_write_b128 v16, v[36:39] offset:9216
    ds_write_b128 v16, v[40:43] offset:13824
    ds_write_b128 v18, v[44:47] offset:0
    ds_write_b128 v18, v[48:51] offset:4608
    ds_write_b128 v18, v[52:55] offset:9216
    ds_write_b128 v18, v[56:59] offset:13824
    s_add_u32 s30, s30, 128
    s_add_u32 s31, s31, s29
    buffer_load_dwordx4 v[28:31], v8, s[8:11], s30 offen
    buffer_load_dwordx4 v[32:35], v9, s[8:11], s30 offen
    buffer_load_dwordx4 v[36:39], v10, s[8:11], s30 offen
    buffer_load_dwordx4 v[40:43], v11, s[8:11], s30 offen
    buffer_load_dwordx4 v[44:47], v12, s[12:15], s31 offen
    buffer_load_dwordx4 v[48:51], v13, s[12:15], s31 offen
    buffer_load_dwordx4 v[52:55], v14, s[12:15], s31 offen
    buffer_load_dwordx4 v[56:59], v15, s[12:15], s31 offen
    v_mfma_f32_16x16x32_bf16 a[0:3], v[76:79], v[108:111], a[0:3]
    v_mfma_f32_16x16x32_bf16 a[4:7], v[76:79], v[112:115], a[4:7]
    v_mfma_f32_16x16x32_bf16 a[8:11], v[76:79], v[116:119], a[8:11]
    v_mfma_f32_16x16x32_bf16 a[12:15], v[76:79], v[120:123], a[12:15]
    v_mfma_f32_16x16x32_bf16 a[16:19], v[80:83], v[108:111], a[16:19]
    v_mfma_f32_16x16x32_bf16 a[20:23], v[80:83], v[112:115], a[20:23]
    v_mfma_f32_16x16x32_bf16 a[24:27], v[80:83], v[116:119], a[24:27]
    v_mfma_f32_16x16x32_bf16 a[28:31], v[80:83], v[120:123], a[28:31]
    v_mfma_f32_16x16x32_bf16 a[32:35], v[84:87], v[108:111], a[32:35]
    v_mfma_f32_16x16x32_bf16 a[36:39], v[84:87], v[112:115], a[36:39]
    v_mfma_f32_16x16x32_bf16 a[40:43], v[84:87], v[116:119], a[40:43]
    v_mfma_f32_16x16x32_bf16 a[44:47], v[84:87], v[120:123], a[44:47]
    v_mfma_f32_16x16x32_bf16 a[48:51], v[88:91], v[108:111], a[48:51]
    v_mfma_f32_16x16x32_bf16 a[52:55], v[88:91], v[112:115], a[52:55]
    v_mfma_f32_16x16x32_bf16 a[56:59], v[88:91], v[116:119], a[56:59]
    v_mfma_f32_16x16x32_bf16 a[60:63], v[88:91], v[120:123], a[60:63]
    s_waitcnt lgkmcnt(0)
    s_barrier
    ds_read_b128 v[60:63], v20 offset:0
    ds_read_b128 v[64:67], v20 offset:2304
    ds_read_b128 v[68:71], v20 offset:4608
    ds_read_b128 v[72:75], v20 offset:6912
    ds_read_b64_tr_b16 v[92:93], v22 offset:0
    ds_read_b64_tr_b16 v[94:95], v22 offset:1152
    ds_read_b64_tr_b16 v[96:97], v22 offset:32
    ds_read_b64_tr_b16 v[98:99], v22 offset:1184
    ds_read_b64_tr_b16 v[100:101], v22 offset:64
    ds_read_b64_tr_b16 v[102:103], v22 offset:1216
    ds_read_b64_tr_b16 v[104:105], v22 offset:96
    ds_read_b64_tr_b16 v[106:107], v22 offset:1248
    ds_read_b128 v[76:79], v20 offset:64
    ds_read_b128 v[80:83], v20 offset:2368
    ds_read_b128 v[84:87], v20 offset:4672
    ds_read_b128 v[88:91], v20 offset:6976
    ds_read_b64_tr_b16 v[108:109], v22 offset:9216
    ds_read_b64_tr_b16 v[110:111], v22 offset:10368
    ds_read_b64_tr_b16 v[112:113], v22 offset:9248
    ds_read_b64_tr_b16 v[114:115], v22 offset:10400
    ds_read_b64_tr_b16 v[116:117], v22 offset:9280
    ds_read_b64_tr_b16 v[118:119], v22 offset:10432
    ds_read_b64_tr_b16 v[120:121], v22 offset:9312
    ds_read_b64_tr_b16 v[122:123], v22 offset:10464
    s_waitcnt lgkmcnt(12)
    v_mfma_f32_16x16x32_bf16 a[0:3], v[60:63], v[92:95], a[0:3]
    v_mfma_f32_16x16x32_bf16 a[4:7], v[60:63], v[96:99], a[4:7]
    v_mfma_f32_16x16x32_bf16 a[8:11], v[60:63], v[100:103], a[8:11]
    v_mfma_f32_16x16x32_bf16 a[12:15], v[60:63], v[104:107], a[12:15]
    v_mfma_f32_16x16x32_bf16 a[16:19], v[64:67], v[92:95], a[16:19]
    v_mfma_f32_16x16x32_bf16 a[20:23], v[64:67], v[96:99], a[20:23]
    v_mfma_f32_16x16x32_bf16 a[24:27], v[64:67], v[100:103], a[24:27]
    v_mfma_f32_16x16x32_bf16 a[28:31], v[64:67], v[104:107], a[28:31]
    v_mfma_f32_16x16x32_bf16 a[32:35], v[68:71], v[92:95], a[32:35]
    v_mfma_f32_16x16x32_bf16 a[36:39], v[68:71], v[96:99], a[36:39]
    v_mfma_f32_16x16x32_bf16 a[40:43], v[68:71], v[100:103], a[40:43]
    v_mfma_f32_16x16x32_bf16 a[44:47], v[68:71], v[104:107], a[44:47]
    v_mfma_f32_16x16x32_bf16 a[48:51], v[72:75], v[92:95], a[48:51]
    v_mfma_f32_16x16x32_bf16 a[52:55], v[72:75], v[96:99], a[52:55]
    v_mfma_f32_16x16x32_bf16 a[56:59], v[72:75], v[100:103], a[56:59]
    v_mfma_f32_16x16x32_bf16 a[60:63], v[72:75], v[104:107], a[60:63]
    s_waitcnt lgkmcnt(0)
    s_waitcnt vmcnt(0)
    ds_write_b128 v17, v[28:31] offset:0
    ds_write_b128 v17, v[32:35] offset:4608
    ds_write_b128 v17, v[36:39] offset:9216
    ds_write_b128 v17, v[40:43] offset:13824
    ds_write_b128 v19, v[44:47] offset:0
    ds_write_b128 v19, v[48:51] offset:4608
    ds_write_b128 v19, v[52:55] offset:9216
    ds_write_b128 v19, v[56:59] offset:13824
    s_add_u32 s30, s30, 128
    s_add_u32 s31, s31, s29
    buffer_load_dwordx4 v[28:31], v8, s[8:11], s30 offen
    buffer_load_dwordx4 v[32:35], v9, s[8:11], s30 offen
    buffer_load_dwordx4 v[36:39], v10, s[8:11], s30 offen
    buffer_load_dwordx4 v[40:43], v11, s[8:11], s30 offen
    buffer_load_dwordx4 v[44:47], v12, s[12:15], s31 offen
    buffer_load_dwordx4 v[48:51], v13, s[12:15], s31 offen
    buffer_load_dwordx4 v[52:55], v14, s[12:15], s31 offen
    buffer_load_dwordx4 v[56:59], v15, s[12:15], s31 offen
    v_mfma_f32_16x16x32_bf16 a[0:3], v[76:79], v[108:111], a[0:3]
    v_mfma_f32_16x16x32_bf16 a[4:7], v[76:79], v[112:115], a[4:7]
    v_mfma_f32_16x16x32_bf16 a[8:11], v[76:79], v[116:119], a[8:11]
    v_mfma_f32_16x16x32_bf16 a[12:15], v[76:79], v[120:123], a[12:15]
    v_mfma_f32_16x16x32_bf16 a[16:19], v[80:83], v[108:111], a[16:19]
    v_mfma_f32_16x16x32_bf16 a[20:23], v[80:83], v[112:115], a[20:23]
    v_mfma_f32_16x16x32_bf16 a[24:27], v[80:83], v[116:119], a[24:27]
    v_mfma_f32_16x16x32_bf16 a[28:31], v[80:83], v[120:123], a[28:31]
    v_mfma_f32_16x16x32_bf16 a[32:35], v[84:87], v[108:111], a[32:35]
    v_mfma_f32_16x16x32_bf16 a[36:39], v[84:87], v[112:115], a[36:39]
    v_mfma_f32_16x16x32_bf16 a[40:43], v[84:87], v[116:119], a[40:43]
    v_mfma_f32_16x16x32_bf16 a[44:47], v[84:87], v[120:123], a[44:47]
    v_mfma_f32_16x16x32_bf16 a[48:51], v[88:91], v[108:111], a[48:51]
    v_mfma_f32_16x16x32_bf16 a[52:55], v[88:91], v[112:115], a[52:55]
    v_mfma_f32_16x16x32_bf16 a[56:59], v[88:91], v[116:119], a[56:59]
    v_mfma_f32_16x16x32_bf16 a[60:63], v[88:91], v[120:123], a[60:63]
    s_waitcnt lgkmcnt(0)
    s_barrier
    ds_read_b128 v[60:63], v21 offset:0
    ds_read_b128 v[64:67], v21 offset:2304
    ds_read_b128 v[68:71], v21 offset:4608
    ds_read_b128 v[72:75], v21 offset:6912
    ds_read_b64_tr_b16 v[92:93], v23 offset:0
    ds_read_b64_tr_b16 v[94:95], v23 offset:1152
    ds_read_b64_tr_b16 v[96:97], v23 offset:32
    ds_read_b64_tr_b16 v[98:99], v23 offset:1184
    ds_read_b64_tr_b16 v[100:101], v23 offset:64
    ds_read_b64_tr_b16 v[102:103], v23 offset:1216
    ds_read_b64_tr_b16 v[104:105], v23 offset:96
    ds_read_b64_tr_b16 v[106:107], v23 offset:1248
    ds_read_b128 v[76:79], v21 offset:64
    ds_read_b128 v[80:83], v21 offset:2368
    ds_read_b128 v[84:87], v21 offset:4672
    ds_read_b128 v[88:91], v21 offset:6976
    ds_read_b64_tr_b16 v[108:109], v23 offset:9216
    ds_read_b64_tr_b16 v[110:111], v23 offset:10368
    ds_read_b64_tr_b16 v[112:113], v23 offset:9248
    ds_read_b64_tr_b16 v[114:115], v23 offset:10400
    ds_read_b64_tr_b16 v[116:117], v23 offset:9280
    ds_read_b64_tr_b16 v[118:119], v23 offset:10432
    ds_read_b64_tr_b16 v[120:121], v23 offset:9312
    ds_read_b64_tr_b16 v[122:123], v23 offset:10464
    s_waitcnt lgkmcnt(12)
    v_mfma_f32_16x16x32_bf16 a[0:3], v[60:63], v[92:95], a[0:3]
    v_mfma_f32_16x16x32_bf16 a[4:7], v[60:63], v[96:99], a[4:7]
    v_mfma_f32_16x16x32_bf16 a[8:11], v[60:63], v[100:103], a[8:11]
    v_mfma_f32_16x16x32_bf16 a[12:15], v[60:63], v[104:107], a[12:15]
    v_mfma_f32_16x16x32_bf16 a[16:19], v[64:67], v[92:95], a[16:19]
    v_mfma_f32_16x16x32_bf16 a[20:23], v[64:67], v[96:99], a[20:23]
    v_mfma_f32_16x16x32_bf16 a[24:27], v[64:67], v[100:103], a[24:27]
    v_mfma_f32_16x16x32_bf16 a[28:31], v[64:67], v[104:107], a[28:31]
    v_mfma_f32_16x16x32_bf16 a[32:35], v[68:71], v[92:95], a[32:35]
    v_mfma_f32_16x16x32_bf16 a[36:39], v[68:71], v[96:99], a[36:39]
    v_mfma_f32_16x16x32_bf16 a[40:43], v[68:71], v[100:103], a[40:43]
    v_mfma_f32_16x16x32_bf16 a[44:47], v[68:71], v[104:107], a[44:47]
    v_mfma_f32_16x16x32_bf16 a[48:51], v[72:75], v[92:95], a[48:51]
    v_mfma_f32_16x16x32_bf16 a[52:55], v[72:75], v[96:99], a[52:55]
    v_mfma_f32_16x16x32_bf16 a[56:59], v[72:75], v[100:103], a[56:59]
    v_mfma_f32_16x16x32_bf16 a[60:63], v[72:75], v[104:107], a[60:63]
    s_waitcnt lgkmcnt(0)
    s_waitcnt vmcnt(0)
    ds_write_b128 v16, v[28:31] offset:0
    ds_write_b128 v16, v[32:35] offset:4608
    ds_write_b128 v16, v[36:39] offset:9216
    ds_write_b128 v16, v[40:43] offset:13824
    ds_write_b128 v18, v[44:47] offset:0
    ds_write_b128 v18, v[48:51] offset:4608
    ds_write_b128 v18, v[52:55] offset:9216
    ds_write_b128 v18, v[56:59] offset:13824
    s_add_u32 s30, s30, 128
    s_add_u32 s31, s31, s29
    buffer_load_dwordx4 v[28:31], v8, s[8:11], s30 offen
    buffer_load_dwordx4 v[32:35], v9, s[8:11], s30 offen
    buffer_load_dwordx4 v[36:39], v10, s[8:11], s30 offen
    buffer_load_dwordx4 v[40:43], v11, s[8:11], s30 offen
    buffer_load_dwordx4 v[44:47], v12, s[12:15], s31 offen
    buffer_load_dwordx4 v[48:51], v13, s[12:15], s31 offen
    buffer_load_dwordx4 v[52:55], v14, s[12:15], s31 offen
    buffer_load_dwordx4 v[56:59], v15, s[12:15], s31 offen
    v_mfma_f32_16x16x32_bf16 a[0:3], v[76:79], v[108:111], a[0:3]
    v_mfma_f32_16x16x32_bf16 a[4:7], v[76:79], v[112:115], a[4:7]
    v_mfma_f32_16x16x32_bf16 a[8:11], v[76:79], v[116:119], a[8:11]
    v_mfma_f32_16x16x32_bf16 a[12:15], v[76:79], v[120:123], a[12:15]
    v_mfma_f32_16x16x32_bf16 a[16:19], v[80:83], v[108:111], a[16:19]
    v_mfma_f32_16x16x32_bf16 a[20:23], v[80:83], v[112:115], a[20:23]
    v_mfma_f32_16x16x32_bf16 a[24:27], v[80:83], v[116:119], a[24:27]
    v_mfma_f32_16x16x32_bf16 a[28:31], v[80:83], v[120:123], a[28:31]
    v_mfma_f32_16x16x32_bf16 a[32:35], v[84:87], v[108:111], a[32:35]
    v_mfma_f32_16x16x32_bf16 a[36:39], v[84:87], v[112:115], a[36:39]
    v_mfma_f32_16x16x32_bf16 a[40:43], v[84:87], v[116:119], a[40:43]
    v_mfma_f32_16x16x32_bf16 a[44:47], v[84:87], v[120:123], a[44:47]
    v_mfma_f32_16x16x32_bf16 a[48:51], v[88:91], v[108:111], a[48:51]
    v_mfma_f32_16x16x32_bf16 a[52:55], v[88:91], v[112:115], a[52:55]
    v_mfma_f32_16x16x32_bf16 a[56:59], v[88:91], v[116:119], a[56:59]
    v_mfma_f32_16x16x32_bf16 a[60:63], v[88:91], v[120:123], a[60:63]
    s_waitcnt lgkmcnt(0)
    s_barrier
    ds_read_b128 v[60:63], v20 offset:0
    ds_read_b128 v[64:67], v20 offset:2304
    ds_read_b128 v[68:71], v20 offset:4608
    ds_read_b128 v[72:75], v20 offset:6912
    ds_read_b64_tr_b16 v[92:93], v22 offset:0
    ds_read_b64_tr_b16 v[94:95], v22 offset:1152
    ds_read_b64_tr_b16 v[96:97], v22 offset:32
    ds_read_b64_tr_b16 v[98:99], v22 offset:1184
    ds_read_b64_tr_b16 v[100:101], v22 offset:64
    ds_read_b64_tr_b16 v[102:103], v22 offset:1216
    ds_read_b64_tr_b16 v[104:105], v22 offset:96
    ds_read_b64_tr_b16 v[106:107], v22 offset:1248
    ds_read_b128 v[76:79], v20 offset:64
    ds_read_b128 v[80:83], v20 offset:2368
    ds_read_b128 v[84:87], v20 offset:4672
    ds_read_b128 v[88:91], v20 offset:6976
    ds_read_b64_tr_b16 v[108:109], v22 offset:9216
    ds_read_b64_tr_b16 v[110:111], v22 offset:10368
    ds_read_b64_tr_b16 v[112:113], v22 offset:9248
    ds_read_b64_tr_b16 v[114:115], v22 offset:10400
    ds_read_b64_tr_b16 v[116:117], v22 offset:9280
    ds_read_b64_tr_b16 v[118:119], v22 offset:10432
    ds_read_b64_tr_b16 v[120:121], v22 offset:9312
    ds_read_b64_tr_b16 v[122:123], v22 offset:10464
    s_waitcnt lgkmcnt(12)
    v_mfma_f32_16x16x32_bf16 a[0:3], v[60:63], v[92:95], a[0:3]
    v_mfma_f32_16x16x32_bf16 a[4:7], v[60:63], v[96:99], a[4:7]
    v_mfma_f32_16x16x32_bf16 a[8:11], v[60:63], v[100:103], a[8:11]
    v_mfma_f32_16x16x32_bf16 a[12:15], v[60:63], v[104:107], a[12:15]
    v_mfma_f32_16x16x32_bf16 a[16:19], v[64:67], v[92:95], a[16:19]
    v_mfma_f32_16x16x32_bf16 a[20:23], v[64:67], v[96:99], a[20:23]
    v_mfma_f32_16x16x32_bf16 a[24:27], v[64:67], v[100:103], a[24:27]
    v_mfma_f32_16x16x32_bf16 a[28:31], v[64:67], v[104:107], a[28:31]
    v_mfma_f32_16x16x32_bf16 a[32:35], v[68:71], v[92:95], a[32:35]
    v_mfma_f32_16x16x32_bf16 a[36:39], v[68:71], v[96:99], a[36:39]
    v_mfma_f32_16x16x32_bf16 a[40:43], v[68:71], v[100:103], a[40:43]
    v_mfma_f32_16x16x32_bf16 a[44:47], v[68:71], v[104:107], a[44:47]
    v_mfma_f32_16x16x32_bf16 a[48:51], v[72:75], v[92:95], a[48:51]
    v_mfma_f32_16x16x32_bf16 a[52:55], v[72:75], v[96:99], a[52:55]
    v_mfma_f32_16x16x32_bf16 a[56:59], v[72:75], v[100:103], a[56:59]
    v_mfma_f32_16x16x32_bf16 a[60:63], v[72:75], v[104:107], a[60:63]
    s_waitcnt lgkmcnt(0)
    s_waitcnt vmcnt(0)
    ds_write_b128 v17, v[28:31] offset:0
    ds_write_b128 v17, v[32:35] offset:4608
    ds_write_b128 v17, v[36:39] offset:9216
    ds_write_b128 v17, v[40:43] offset:13824
    ds_write_b128 v19, v[44:47] offset:0
    ds_write_b128 v19, v[48:51] offset:4608
    ds_write_b128 v19, v[52:55] offset:9216
    ds_write_b128 v19, v[56:59] offset:13824
    s_add_u32 s30, s30, 128
    s_add_u32 s31, s31, s29
    buffer_load_dwordx4 v[28:31], v8, s[8:11], s30 offen
    buffer_load_dwordx4 v[32:35], v9, s[8:11], s30 offen
    buffer_load_dwordx4 v[36:39], v10, s[8:11], s30 offen
    buffer_load_dwordx4 v[40:43], v11, s[8:11], s30 offen
    buffer_load_dwordx4 v[44:47], v12, s[12:15], s31 offen
    buffer_load_dwordx4 v[48:51], v13, s[12:15], s31 offen
    buffer_load_dwordx4 v[52:55], v14, s[12:15], s31 offen
    buffer_load_dwordx4 v[56:59], v15, s[12:15], s31 offen
    v_mfma_f32_16x16x32_bf16 a[0:3], v[76:79], v[108:111], a[0:3]
    v_mfma_f32_16x16x32_bf16 a[4:7], v[76:79], v[112:115], a[4:7]
    v_mfma_f32_16x16x32_bf16 a[8:11], v[76:79], v[116:119], a[8:11]
    v_mfma_f32_16x16x32_bf16 a[12:15], v[76:79], v[120:123], a[12:15]
    v_mfma_f32_16x16x32_bf16 a[16:19], v[80:83], v[108:111], a[16:19]
    v_mfma_f32_16x16x32_bf16 a[20:23], v[80:83], v[112:115], a[20:23]
    v_mfma_f32_16x16x32_bf16 a[24:27], v[80:83], v[116:119], a[24:27]
    v_mfma_f32_16x16x32_bf16 a[28:31], v[80:83], v[120:123], a[28:31]
    v_mfma_f32_16x16x32_bf16 a[32:35], v[84:87], v[108:111], a[32:35]
    v_mfma_f32_16x16x32_bf16 a[36:39], v[84:87], v[112:115], a[36:39]
    v_mfma_f32_16x16x32_bf16 a[40:43], v[84:87], v[116:119], a[40:43]
    v_mfma_f32_16x16x32_bf16 a[44:47], v[84:87], v[120:123], a[44:47]
    v_mfma_f32_16x16x32_bf16 a[48:51], v[88:91], v[108:111], a[48:51]
    v_mfma_f32_16x16x32_bf16 a[52:55], v[88:91], v[112:115], a[52:55]
    v_mfma_f32_16x16x32_bf16 a[56:59], v[88:91], v[116:119], a[56:59]
    v_mfma_f32_16x16x32_bf16 a[60:63], v[88:91], v[120:123], a[60:63]
    s_waitcnt lgkmcnt(0)
    s_barrier
    ds_read_b128 v[60:63], v21 offset:0
    ds_read_b128 v[64:67], v21 offset:2304
    ds_read_b128 v[68:71], v21 offset:4608
    ds_read_b128 v[72:75], v21 offset:6912
    ds_read_b64_tr_b16 v[92:93], v23 offset:0
    ds_read_b64_tr_b16 v[94:95], v23 offset:1152
    ds_read_b64_tr_b16 v[96:97], v23 offset:32
    ds_read_b64_tr_b16 v[98:99], v23 offset:1184
    ds_read_b64_tr_b16 v[100:101], v23 offset:64
    ds_read_b64_tr_b16 v[102:103], v23 offset:1216
    ds_read_b64_tr_b16 v[104:105], v23 offset:96
    ds_read_b64_tr_b16 v[106:107], v23 offset:1248
    ds_read_b128 v[76:79], v21 offset:64
    ds_read_b128 v[80:83], v21 offset:2368
    ds_read_b128 v[84:87], v21 offset:4672
    ds_read_b128 v[88:91], v21 offset:6976
    ds_read_b64_tr_b16 v[108:109], v23 offset:9216
    ds_read_b64_tr_b16 v[110:111], v23 offset:10368
    ds_read_b64_tr_b16 v[112:113], v23 offset:9248
    ds_read_b64_tr_b16 v[114:115], v23 offset:10400
    ds_read_b64_tr_b16 v[116:117], v23 offset:9280
    ds_read_b64_tr_b16 v[118:119], v23 offset:10432
    ds_read_b64_tr_b16 v[120:121], v23 offset:9312
    ds_read_b64_tr_b16 v[122:123], v23 offset:10464
    s_waitcnt lgkmcnt(12)
    v_mfma_f32_16x16x32_bf16 a[0:3], v[60:63], v[92:95], a[0:3]
    v_mfma_f32_16x16x32_bf16 a[4:7], v[60:63], v[96:99], a[4:7]
    v_mfma_f32_16x16x32_bf16 a[8:11], v[60:63], v[100:103], a[8:11]
    v_mfma_f32_16x16x32_bf16 a[12:15], v[60:63], v[104:107], a[12:15]
    v_mfma_f32_16x16x32_bf16 a[16:19], v[64:67], v[92:95], a[16:19]
    v_mfma_f32_16x16x32_bf16 a[20:23], v[64:67], v[96:99], a[20:23]
    v_mfma_f32_16x16x32_bf16 a[24:27], v[64:67], v[100:103], a[24:27]
    v_mfma_f32_16x16x32_bf16 a[28:31], v[64:67], v[104:107], a[28:31]
    v_mfma_f32_16x16x32_bf16 a[32:35], v[68:71], v[92:95], a[32:35]
    v_mfma_f32_16x16x32_bf16 a[36:39], v[68:71], v[96:99], a[36:39]
    v_mfma_f32_16x16x32_bf16 a[40:43], v[68:71], v[100:103], a[40:43]
    v_mfma_f32_16x16x32_bf16 a[44:47], v[68:71], v[104:107], a[44:47]
    v_mfma_f32_16x16x32_bf16 a[48:51], v[72:75], v[92:95], a[48:51]
    v_mfma_f32_16x16x32_bf16 a[52:55], v[72:75], v[96:99], a[52:55]
    v_mfma_f32_16x16x32_bf16 a[56:59], v[72:75], v[100:103], a[56:59]
    v_mfma_f32_16x16x32_bf16 a[60:63], v[72:75], v[104:107], a[60:63]
    s_waitcnt lgkmcnt(0)
    s_waitcnt vmcnt(0)
    ds_write_b128 v16, v[28:31] offset:0
    ds_write_b128 v16, v[32:35] offset:4608
    ds_write_b128 v16, v[36:39] offset:9216
    ds_write_b128 v16, v[40:43] offset:13824
    ds_write_b128 v18, v[44:47] offset:0
    ds_write_b128 v18, v[48:51] offset:4608
    ds_write_b128 v18, v[52:55] offset:9216
    ds_write_b128 v18, v[56:59] offset:13824
    s_add_u32 s30, s30, 128
    s_add_u32 s31, s31, s29
    buffer_load_dwordx4 v[28:31], v8, s[8:11], s30 offen
    buffer_load_dwordx4 v[32:35], v9, s[8:11], s30 offen
    buffer_load_dwordx4 v[36:39], v10, s[8:11], s30 offen
    buffer_load_dwordx4 v[40:43], v11, s[8:11], s30 offen
    buffer_load_dwordx4 v[44:47], v12, s[12:15], s31 offen
    buffer_load_dwordx4 v[48:51], v13, s[12:15], s31 offen
    buffer_load_dwordx4 v[52:55], v14, s[12:15], s31 offen
    buffer_load_dwordx4 v[56:59], v15, s[12:15], s31 offen
    v_mfma_f32_16x16x32_bf16 a[0:3], v[76:79], v[108:111], a[0:3]
    v_mfma_f32_16x16x32_bf16 a[4:7], v[76:79], v[112:115], a[4:7]
    v_mfma_f32_16x16x32_bf16 a[8:11], v[76:79], v[116:119], a[8:11]
    v_mfma_f32_16x16x32_bf16 a[12:15], v[76:79], v[120:123], a[12:15]
    v_mfma_f32_16x16x32_bf16 a[16:19], v[80:83], v[108:111], a[16:19]
    v_mfma_f32_16x16x32_bf16 a[20:23], v[80:83], v[112:115], a[20:23]
    v_mfma_f32_16x16x32_bf16 a[24:27], v[80:83], v[116:119], a[24:27]
    v_mfma_f32_16x16x32_bf16 a[28:31], v[80:83], v[120:123], a[28:31]
    v_mfma_f32_16x16x32_bf16 a[32:35], v[84:87], v[108:111], a[32:35]
    v_mfma_f32_16x16x32_bf16 a[36:39], v[84:87], v[112:115], a[36:39]
    v_mfma_f32_16x16x32_bf16 a[40:43], v[84:87], v[116:119], a[40:43]
    v_mfma_f32_16x16x32_bf16 a[44:47], v[84:87], v[120:123], a[44:47]
    v_mfma_f32_16x16x32_bf16 a[48:51], v[88:91], v[108:111], a[48:51]
    v_mfma_f32_16x16x32_bf16 a[52:55], v[88:91], v[112:115], a[52:55]
    v_mfma_f32_16x16x32_bf16 a[56:59], v[88:91], v[116:119], a[56:59]
    v_mfma_f32_16x16x32_bf16 a[60:63], v[88:91], v[120:123], a[60:63]
    s_waitcnt lgkmcnt(0)
    s_barrier
    ds_read_b128 v[60:63], v20 offset:0
    ds_read_b128 v[64:67], v20 offset:2304
    ds_read_b128 v[68:71], v20 offset:4608
    ds_read_b128 v[72:75], v20 offset:6912
    ds_read_b64_tr_b16 v[92:93], v22 offset:0
    ds_read_b64_tr_b16 v[94:95], v22 offset:1152
    ds_read_b64_tr_b16 v[96:97], v22 offset:32
    ds_read_b64_tr_b16 v[98:99], v22 offset:1184
    ds_read_b64_tr_b16 v[100:101], v22 offset:64
    ds_read_b64_tr_b16 v[102:103], v22 offset:1216
    ds_read_b64_tr_b16 v[104:105], v22 offset:96
    ds_read_b64_tr_b16 v[106:107], v22 offset:1248
    ds_read_b128 v[76:79], v20 offset:64
    ds_read_b128 v[80:83], v20 offset:2368
    ds_read_b128 v[84:87], v20 offset:4672
    ds_read_b128 v[88:91], v20 offset:6976
    ds_read_b64_tr_b16 v[108:109], v22 offset:9216
    ds_read_b64_tr_b16 v[110:111], v22 offset:10368
    ds_read_b64_tr_b16 v[112:113], v22 offset:9248
    ds_read_b64_tr_b16 v[114:115], v22 offset:10400
    ds_read_b64_tr_b16 v[116:117], v22 offset:9280
    ds_read_b64_tr_b16 v[118:119], v22 offset:10432
    ds_read_b64_tr_b16 v[120:121], v22 offset:9312
    ds_read_b64_tr_b16 v[122:123], v22 offset:10464
    s_waitcnt lgkmcnt(12)
    v_mfma_f32_16x16x32_bf16 a[0:3], v[60:63], v[92:95], a[0:3]
    v_mfma_f32_16x16x32_bf16 a[4:7], v[60:63], v[96:99], a[4:7]
    v_mfma_f32_16x16x32_bf16 a[8:11], v[60:63], v[100:103], a[8:11]
    v_mfma_f32_16x16x32_bf16 a[12:15], v[60:63], v[104:107], a[12:15]
    v_mfma_f32_16x16x32_bf16 a[16:19], v[64:67], v[92:95], a[16:19]
    v_mfma_f32_16x16x32_bf16 a[20:23], v[64:67], v[96:99], a[20:23]
    v_mfma_f32_16x16x32_bf16 a[24:27], v[64:67], v[100:103], a[24:27]
    v_mfma_f32_16x16x32_bf16 a[28:31], v[64:67], v[104:107], a[28:31]
    v_mfma_f32_16x16x32_bf16 a[32:35], v[68:71], v[92:95], a[32:35]
    v_mfma_f32_16x16x32_bf16 a[36:39], v[68:71], v[96:99], a[36:39]
    v_mfma_f32_16x16x32_bf16 a[40:43], v[68:71], v[100:103], a[40:43]
    v_mfma_f32_16x16x32_bf16 a[44:47], v[68:71], v[104:107], a[44:47]
    v_mfma_f32_16x16x32_bf16 a[48:51], v[72:75], v[92:95], a[48:51]
    v_mfma_f32_16x16x32_bf16 a[52:55], v[72:75], v[96:99], a[52:55]
    v_mfma_f32_16x16x32_bf16 a[56:59], v[72:75], v[100:103], a[56:59]
    v_mfma_f32_16x16x32_bf16 a[60:63], v[72:75], v[104:107], a[60:63]
    s_waitcnt lgkmcnt(0)
    s_waitcnt vmcnt(0)
    ds_write_b128 v17, v[28:31] offset:0
    ds_write_b128 v17, v[32:35] offset:4608
    ds_write_b128 v17, v[36:39] offset:9216
    ds_write_b128 v17, v[40:43] offset:13824
    ds_write_b128 v19, v[44:47] offset:0
    ds_write_b128 v19, v[48:51] offset:4608
    ds_write_b128 v19, v[52:55] offset:9216
    ds_write_b128 v19, v[56:59] offset:13824
    s_add_u32 s30, s30, 128
    s_add_u32 s31, s31, s29
    buffer_load_dwordx4 v[28:31], v8, s[8:11], s30 offen
    buffer_load_dwordx4 v[32:35], v9, s[8:11], s30 offen
    buffer_load_dwordx4 v[36:39], v10, s[8:11], s30 offen
    buffer_load_dwordx4 v[40:43], v11, s[8:11], s30 offen
    buffer_load_dwordx4 v[44:47], v12, s[12:15], s31 offen
    buffer_load_dwordx4 v[48:51], v13, s[12:15], s31 offen
    buffer_load_dwordx4 v[52:55], v14, s[12:15], s31 offen
    buffer_load_dwordx4 v[56:59], v15, s[12:15], s31 offen
    v_mfma_f32_16x16x32_bf16 a[0:3], v[76:79], v[108:111], a[0:3]
    v_mfma_f32_16x16x32_bf16 a[4:7], v[76:79], v[112:115], a[4:7]
    v_mfma_f32_16x16x32_bf16 a[8:11], v[76:79], v[116:119], a[8:11]
    v_mfma_f32_16x16x32_bf16 a[12:15], v[76:79], v[120:123], a[12:15]
    v_mfma_f32_16x16x32_bf16 a[16:19], v[80:83], v[108:111], a[16:19]
    v_mfma_f32_16x16x32_bf16 a[20:23], v[80:83], v[112:115], a[20:23]
    v_mfma_f32_16x16x32_bf16 a[24:27], v[80:83], v[116:119], a[24:27]
    v_mfma_f32_16x16x32_bf16 a[28:31], v[80:83], v[120:123], a[28:31]
    v_mfma_f32_16x16x32_bf16 a[32:35], v[84:87], v[108:111], a[32:35]
    v_mfma_f32_16x16x32_bf16 a[36:39], v[84:87], v[112:115], a[36:39]
    v_mfma_f32_16x16x32_bf16 a[40:43], v[84:87], v[116:119], a[40:43]
    v_mfma_f32_16x16x32_bf16 a[44:47], v[84:87], v[120:123], a[44:47]
    v_mfma_f32_16x16x32_bf16 a[48:51], v[88:91], v[108:111], a[48:51]
    v_mfma_f32_16x16x32_bf16 a[52:55], v[88:91], v[112:115], a[52:55]
    v_mfma_f32_16x16x32_bf16 a[56:59], v[88:91], v[116:119], a[56:59]
    v_mfma_f32_16x16x32_bf16 a[60:63], v[88:91], v[120:123], a[60:63]
    s_waitcnt lgkmcnt(0)
    s_barrier
    ds_read_b128 v[60:63], v21 offset:0
    ds_read_b128 v[64:67], v21 offset:2304
    ds_read_b128 v[68:71], v21 offset:4608
    ds_read_b128 v[72:75], v21 offset:6912
    ds_read_b64_tr_b16 v[92:93], v23 offset:0
    ds_read_b64_tr_b16 v[94:95], v23 offset:1152
    ds_read_b64_tr_b16 v[96:97], v23 offset:32
    ds_read_b64_tr_b16 v[98:99], v23 offset:1184
    ds_read_b64_tr_b16 v[100:101], v23 offset:64
    ds_read_b64_tr_b16 v[102:103], v23 offset:1216
    ds_read_b64_tr_b16 v[104:105], v23 offset:96
    ds_read_b64_tr_b16 v[106:107], v23 offset:1248
    ds_read_b128 v[76:79], v21 offset:64
    ds_read_b128 v[80:83], v21 offset:2368
    ds_read_b128 v[84:87], v21 offset:4672
    ds_read_b128 v[88:91], v21 offset:6976
    ds_read_b64_tr_b16 v[108:109], v23 offset:9216
    ds_read_b64_tr_b16 v[110:111], v23 offset:10368
    ds_read_b64_tr_b16 v[112:113], v23 offset:9248
    ds_read_b64_tr_b16 v[114:115], v23 offset:10400
    ds_read_b64_tr_b16 v[116:117], v23 offset:9280
    ds_read_b64_tr_b16 v[118:119], v23 offset:10432
    ds_read_b64_tr_b16 v[120:121], v23 offset:9312
    ds_read_b64_tr_b16 v[122:123], v23 offset:10464
    s_waitcnt lgkmcnt(12)
    v_mfma_f32_16x16x32_bf16 a[0:3], v[60:63], v[92:95], a[0:3]
    v_mfma_f32_16x16x32_bf16 a[4:7], v[60:63], v[96:99], a[4:7]
    v_mfma_f32_16x16x32_bf16 a[8:11], v[60:63], v[100:103], a[8:11]
    v_mfma_f32_16x16x32_bf16 a[12:15], v[60:63], v[104:107], a[12:15]
    v_mfma_f32_16x16x32_bf16 a[16:19], v[64:67], v[92:95], a[16:19]
    v_mfma_f32_16x16x32_bf16 a[20:23], v[64:67], v[96:99], a[20:23]
    v_mfma_f32_16x16x32_bf16 a[24:27], v[64:67], v[100:103], a[24:27]
    v_mfma_f32_16x16x32_bf16 a[28:31], v[64:67], v[104:107], a[28:31]
    v_mfma_f32_16x16x32_bf16 a[32:35], v[68:71], v[92:95], a[32:35]
    v_mfma_f32_16x16x32_bf16 a[36:39], v[68:71], v[96:99], a[36:39]
    v_mfma_f32_16x16x32_bf16 a[40:43], v[68:71], v[100:103], a[40:43]
    v_mfma_f32_16x16x32_bf16 a[44:47], v[68:71], v[104:107], a[44:47]
    v_mfma_f32_16x16x32_bf16 a[48:51], v[72:75], v[92:95], a[48:51]
    v_mfma_f32_16x16x32_bf16 a[52:55], v[72:75], v[96:99], a[52:55]
    v_mfma_f32_16x16x32_bf16 a[56:59], v[72:75], v[100:103], a[56:59]
    v_mfma_f32_16x16x32_bf16 a[60:63], v[72:75], v[104:107], a[60:63]
    s_waitcnt lgkmcnt(0)
    s_waitcnt vmcnt(0)
    ds_write_b128 v16, v[28:31] offset:0
    ds_write_b128 v16, v[32:35] offset:4608
    ds_write_b128 v16, v[36:39] offset:9216
    ds_write_b128 v16, v[40:43] offset:13824
    ds_write_b128 v18, v[44:47] offset:0
    ds_write_b128 v18, v[48:51] offset:4608
    ds_write_b128 v18, v[52:55] offset:9216
    ds_write_b128 v18, v[56:59] offset:13824
    v_mfma_f32_16x16x32_bf16 a[0:3], v[76:79], v[108:111], a[0:3]
    v_mfma_f32_16x16x32_bf16 a[4:7], v[76:79], v[112:115], a[4:7]
    v_mfma_f32_16x16x32_bf16 a[8:11], v[76:79], v[116:119], a[8:11]
    v_mfma_f32_16x16x32_bf16 a[12:15], v[76:79], v[120:123], a[12:15]
    v_mfma_f32_16x16x32_bf16 a[16:19], v[80:83], v[108:111], a[16:19]
    v_mfma_f32_16x16x32_bf16 a[20:23], v[80:83], v[112:115], a[20:23]
    v_mfma_f32_16x16x32_bf16 a[24:27], v[80:83], v[116:119], a[24:27]
    v_mfma_f32_16x16x32_bf16 a[28:31], v[80:83], v[120:123], a[28:31]
    v_mfma_f32_16x16x32_bf16 a[32:35], v[84:87], v[108:111], a[32:35]
    v_mfma_f32_16x16x32_bf16 a[36:39], v[84:87], v[112:115], a[36:39]
    v_mfma_f32_16x16x32_bf16 a[40:43], v[84:87], v[116:119], a[40:43]
    v_mfma_f32_16x16x32_bf16 a[44:47], v[84:87], v[120:123], a[44:47]
    v_mfma_f32_16x16x32_bf16 a[48:51], v[88:91], v[108:111], a[48:51]
    v_mfma_f32_16x16x32_bf16 a[52:55], v[88:91], v[112:115], a[52:55]
    v_mfma_f32_16x16x32_bf16 a[56:59], v[88:91], v[116:119], a[56:59]
    v_mfma_f32_16x16x32_bf16 a[60:63], v[88:91], v[120:123], a[60:63]
    s_waitcnt lgkmcnt(0)
    s_barrier
    ds_read_b128 v[60:63], v20 offset:0
    ds_read_b128 v[64:67], v20 offset:2304
    ds_read_b128 v[68:71], v20 offset:4608
    ds_read_b128 v[72:75], v20 offset:6912
    ds_read_b64_tr_b16 v[92:93], v22 offset:0
    ds_read_b64_tr_b16 v[94:95], v22 offset:1152
    ds_read_b64_tr_b16 v[96:97], v22 offset:32
    ds_read_b64_tr_b16 v[98:99], v22 offset:1184
    ds_read_b64_tr_b16 v[100:101], v22 offset:64
    ds_read_b64_tr_b16 v[102:103], v22 offset:1216
    ds_read_b64_tr_b16 v[104:105], v22 offset:96
    ds_read_b64_tr_b16 v[106:107], v22 offset:1248
    ds_read_b128 v[76:79], v20 offset:64
    ds_read_b128 v[80:83], v20 offset:2368
    ds_read_b128 v[84:87], v20 offset:4672
    ds_read_b128 v[88:91], v20 offset:6976
    ds_read_b64_tr_b16 v[108:109], v22 offset:9216
    ds_read_b64_tr_b16 v[110:111], v22 offset:10368
    ds_read_b64_tr_b16 v[112:113], v22 offset:9248
    ds_read_b64_tr_b16 v[114:115], v22 offset:10400
    ds_read_b64_tr_b16 v[116:117], v22 offset:9280
    ds_read_b64_tr_b16 v[118:119], v22 offset:10432
    ds_read_b64_tr_b16 v[120:121], v22 offset:9312
    ds_read_b64_tr_b16 v[122:123], v22 offset:10464
    s_waitcnt lgkmcnt(12)
    v_mfma_f32_16x16x32_bf16 a[0:3], v[60:63], v[92:95], a[0:3]
    v_mfma_f32_16x16x32_bf16 a[4:7], v[60:63], v[96:99], a[4:7]
    v_mfma_f32_16x16x32_bf16 a[8:11], v[60:63], v[100:103], a[8:11]
    v_mfma_f32_16x16x32_bf16 a[12:15], v[60:63], v[104:107], a[12:15]
    v_mfma_f32_16x16x32_bf16 a[16:19], v[64:67], v[92:95], a[16:19]
    v_mfma_f32_16x16x32_bf16 a[20:23], v[64:67], v[96:99], a[20:23]
    v_mfma_f32_16x16x32_bf16 a[24:27], v[64:67], v[100:103], a[24:27]
    v_mfma_f32_16x16x32_bf16 a[28:31], v[64:67], v[104:107], a[28:31]
    v_mfma_f32_16x16x32_bf16 a[32:35], v[68:71], v[92:95], a[32:35]
    v_mfma_f32_16x16x32_bf16 a[36:39], v[68:71], v[96:99], a[36:39]
    v_mfma_f32_16x16x32_bf16 a[40:43], v[68:71], v[100:103], a[40:43]
    v_mfma_f32_16x16x32_bf16 a[44:47], v[68:71], v[104:107], a[44:47]
    v_mfma_f32_16x16x32_bf16 a[48:51], v[72:75], v[92:95], a[48:51]
    v_mfma_f32_16x16x32_bf16 a[52:55], v[72:75], v[96:99], a[52:55]
    v_mfma_f32_16x16x32_bf16 a[56:59], v[72:75], v[100:103], a[56:59]
    v_mfma_f32_16x16x32_bf16 a[60:63], v[72:75], v[104:107], a[60:63]
    s_waitcnt lgkmcnt(0)
    v_mfma_f32_16x16x32_bf16 a[0:3], v[76:79], v[108:111], a[0:3]
    v_mfma_f32_16x16x32_bf16 a[4:7], v[76:79], v[112:115], a[4:7]
    v_mfma_f32_16x16x32_bf16 a[8:11], v[76:79], v[116:119], a[8:11]
    v_mfma_f32_16x16x32_bf16 a[12:15], v[76:79], v[120:123], a[12:15]
    v_mfma_f32_16x16x32_bf16 a[16:19], v[80:83], v[108:111], a[16:19]
    v_mfma_f32_16x16x32_bf16 a[20:23], v[80:83], v[112:115], a[20:23]
    v_mfma_f32_16x16x32_bf16 a[24:27], v[80:83], v[116:119], a[24:27]
    v_mfma_f32_16x16x32_bf16 a[28:31], v[80:83], v[120:123], a[28:31]
    v_mfma_f32_16x16x32_bf16 a[32:35], v[84:87], v[108:111], a[32:35]
    v_mfma_f32_16x16x32_bf16 a[36:39], v[84:87], v[112:115], a[36:39]
    v_mfma_f32_16x16x32_bf16 a[40:43], v[84:87], v[116:119], a[40:43]
    v_mfma_f32_16x16x32_bf16 a[44:47], v[84:87], v[120:123], a[44:47]
    v_mfma_f32_16x16x32_bf16 a[48:51], v[88:91], v[108:111], a[48:51]
    v_mfma_f32_16x16x32_bf16 a[52:55], v[88:91], v[112:115], a[52:55]
    v_mfma_f32_16x16x32_bf16 a[56:59], v[88:91], v[116:119], a[56:59]
    v_mfma_f32_16x16x32_bf16 a[60:63], v[88:91], v[120:123], a[60:63]
    s_cmp_eq_u32 s34, 1
    s_nop 6
    s_cbranch_scc1 Lf1_52
    v_bfe_u32 v25, v0, 6, 1
    v_mul_u32_u24 v25, 64, v25
    v_add_u32 v25, s25, v25
    s_nop 0
    v_readfirstlane_b32 s27, v25
    s_cmp_ge_u32 s27, s26
    s_nop 3
    s_cbranch_scc1 Lpf_44
    v_and_b32 v26, 15, v0
    v_add_u32 v25, v25, v26
    v_lshlrev_b32 v24, 12, v25
    v_lshrrev_b32 v25, 7, v0
    v_mul_u32_u24 v25, 64, v25
    v_bfe_u32 v26, v0, 4, 2
    v_lshl_add_u32 v25, v26, 2, v25
    s_mul_i32 s27, s5, 128
    v_add_u32 v25, s27, v25
    v_lshl_add_u32 v24, v25, 1, v24
    v_add_u32 v24, s22, v24
    s_mov_b32 s27, 65536
    v_accvgpr_read_b32 v60, a0
    v_accvgpr_read_b32 v61, a1
    v_accvgpr_read_b32 v62, a2
    v_accvgpr_read_b32 v63, a3
    v_cvt_pk_bf16_f32 v64, v60, v61
    v_cvt_pk_bf16_f32 v65, v62, v63
    buffer_store_dwordx2 v[64:65], v24, s[16:19], 0 offen offset:0 sc1
    v_accvgpr_read_b32 v68, a16
    v_accvgpr_read_b32 v69, a17
    v_accvgpr_read_b32 v70, a18
    v_accvgpr_read_b32 v71, a19
    v_cvt_pk_bf16_f32 v72, v68, v69
    v_cvt_pk_bf16_f32 v73, v70, v71
    buffer_store_dwordx2 v[72:73], v24, s[16:19], 0 offen offset:32 sc1
    v_accvgpr_read_b32 v76, a32
    v_accvgpr_read_b32 v77, a33
    v_accvgpr_read_b32 v78, a34
    v_accvgpr_read_b32 v79, a35
    v_cvt_pk_bf16_f32 v80, v76, v77
    v_cvt_pk_bf16_f32 v81, v78, v79
    buffer_store_dwordx2 v[80:81], v24, s[16:19], 0 offen offset:64 sc1
    v_accvgpr_read_b32 v84, a48
    v_accvgpr_read_b32 v85, a49
    v_accvgpr_read_b32 v86, a50
    v_accvgpr_read_b32 v87, a51
    v_cvt_pk_bf16_f32 v88, v84, v85
    v_cvt_pk_bf16_f32 v89, v86, v87
    buffer_store_dwordx2 v[88:89], v24, s[16:19], 0 offen offset:96 sc1
    v_add_u32 v24, s27, v24
    v_accvgpr_read_b32 v60, a4
    v_accvgpr_read_b32 v61, a5
    v_accvgpr_read_b32 v62, a6
    v_accvgpr_read_b32 v63, a7
    v_cvt_pk_bf16_f32 v64, v60, v61
    v_cvt_pk_bf16_f32 v65, v62, v63
    buffer_store_dwordx2 v[64:65], v24, s[16:19], 0 offen offset:0 sc1
    v_accvgpr_read_b32 v68, a20
    v_accvgpr_read_b32 v69, a21
    v_accvgpr_read_b32 v70, a22
    v_accvgpr_read_b32 v71, a23
    v_cvt_pk_bf16_f32 v72, v68, v69
    v_cvt_pk_bf16_f32 v73, v70, v71
    buffer_store_dwordx2 v[72:73], v24, s[16:19], 0 offen offset:32 sc1
    v_accvgpr_read_b32 v76, a36
    v_accvgpr_read_b32 v77, a37
    v_accvgpr_read_b32 v78, a38
    v_accvgpr_read_b32 v79, a39
    v_cvt_pk_bf16_f32 v80, v76, v77
    v_cvt_pk_bf16_f32 v81, v78, v79
    buffer_store_dwordx2 v[80:81], v24, s[16:19], 0 offen offset:64 sc1
    v_accvgpr_read_b32 v84, a52
    v_accvgpr_read_b32 v85, a53
    v_accvgpr_read_b32 v86, a54
    v_accvgpr_read_b32 v87, a55
    v_cvt_pk_bf16_f32 v88, v84, v85
    v_cvt_pk_bf16_f32 v89, v86, v87
    buffer_store_dwordx2 v[88:89], v24, s[16:19], 0 offen offset:96 sc1
    v_add_u32 v24, s27, v24
    v_accvgpr_read_b32 v60, a8
    v_accvgpr_read_b32 v61, a9
    v_accvgpr_read_b32 v62, a10
    v_accvgpr_read_b32 v63, a11
    v_cvt_pk_bf16_f32 v64, v60, v61
    v_cvt_pk_bf16_f32 v65, v62, v63
    buffer_store_dwordx2 v[64:65], v24, s[16:19], 0 offen offset:0 sc1
    v_accvgpr_read_b32 v68, a24
    v_accvgpr_read_b32 v69, a25
    v_accvgpr_read_b32 v70, a26
    v_accvgpr_read_b32 v71, a27
    v_cvt_pk_bf16_f32 v72, v68, v69
    v_cvt_pk_bf16_f32 v73, v70, v71
    buffer_store_dwordx2 v[72:73], v24, s[16:19], 0 offen offset:32 sc1
    v_accvgpr_read_b32 v76, a40
    v_accvgpr_read_b32 v77, a41
    v_accvgpr_read_b32 v78, a42
    v_accvgpr_read_b32 v79, a43
    v_cvt_pk_bf16_f32 v80, v76, v77
    v_cvt_pk_bf16_f32 v81, v78, v79
    buffer_store_dwordx2 v[80:81], v24, s[16:19], 0 offen offset:64 sc1
    v_accvgpr_read_b32 v84, a56
    v_accvgpr_read_b32 v85, a57
    v_accvgpr_read_b32 v86, a58
    v_accvgpr_read_b32 v87, a59
    v_cvt_pk_bf16_f32 v88, v84, v85
    v_cvt_pk_bf16_f32 v89, v86, v87
    buffer_store_dwordx2 v[88:89], v24, s[16:19], 0 offen offset:96 sc1
    v_add_u32 v24, s27, v24
    v_accvgpr_read_b32 v60, a12
    v_accvgpr_read_b32 v61, a13
    v_accvgpr_read_b32 v62, a14
    v_accvgpr_read_b32 v63, a15
    v_cvt_pk_bf16_f32 v64, v60, v61
    v_cvt_pk_bf16_f32 v65, v62, v63
    buffer_store_dwordx2 v[64:65], v24, s[16:19], 0 offen offset:0 sc1
    v_accvgpr_read_b32 v68, a28
    v_accvgpr_read_b32 v69, a29
    v_accvgpr_read_b32 v70, a30
    v_accvgpr_read_b32 v71, a31
    v_cvt_pk_bf16_f32 v72, v68, v69
    v_cvt_pk_bf16_f32 v73, v70, v71
    buffer_store_dwordx2 v[72:73], v24, s[16:19], 0 offen offset:32 sc1
    v_accvgpr_read_b32 v76, a44
    v_accvgpr_read_b32 v77, a45
    v_accvgpr_read_b32 v78, a46
    v_accvgpr_read_b32 v79, a47
    v_cvt_pk_bf16_f32 v80, v76, v77
    v_cvt_pk_bf16_f32 v81, v78, v79
    buffer_store_dwordx2 v[80:81], v24, s[16:19], 0 offen offset:64 sc1
    v_accvgpr_read_b32 v84, a60
    v_accvgpr_read_b32 v85, a61
    v_accvgpr_read_b32 v86, a62
    v_accvgpr_read_b32 v87, a63
    v_cvt_pk_bf16_f32 v88, v84, v85
    v_cvt_pk_bf16_f32 v89, v86, v87
    buffer_store_dwordx2 v[88:89], v24, s[16:19], 0 offen offset:96 sc1
    s_nop 0
    s_branch Lpf_44
Lf1_52:
    v_lshrrev_b32 v24, 7, v0
    v_mul_u32_u24 v24, 524288, v24
    v_bfe_u32 v25, v0, 6, 1
    v_mul_u32_u24 v25, 4096, v25
    v_add_u32 v24, v24, v25
    v_and_b32 v25, 63, v0
    v_lshl_add_u32 v24, v25, 4, v24
    s_mul_i32 s27, s5, 1048576
    s_lshl_b32 s28, s25, 6
    s_add_u32 s27, s27, s28
    s_add_u32 s27, s27, s22
    v_add_u32 v24, s27, v24
    v_accvgpr_read_b32 v60, a0
    v_accvgpr_read_b32 v61, a1
    v_accvgpr_read_b32 v62, a2
    v_accvgpr_read_b32 v63, a3
    v_accvgpr_read_b32 v64, a16
    v_accvgpr_read_b32 v65, a17
    v_accvgpr_read_b32 v66, a18
    v_accvgpr_read_b32 v67, a19
    v_cvt_pk_bf16_f32 v68, v60, v61
    v_cvt_pk_bf16_f32 v69, v62, v63
    v_cvt_pk_bf16_f32 v70, v64, v65
    v_cvt_pk_bf16_f32 v71, v66, v67
    buffer_store_dwordx4 v[68:71], v24, s[16:19], 0 offen offset:0 sc1
    v_accvgpr_read_b32 v72, a4
    v_accvgpr_read_b32 v73, a5
    v_accvgpr_read_b32 v74, a6
    v_accvgpr_read_b32 v75, a7
    v_accvgpr_read_b32 v76, a20
    v_accvgpr_read_b32 v77, a21
    v_accvgpr_read_b32 v78, a22
    v_accvgpr_read_b32 v79, a23
    v_cvt_pk_bf16_f32 v80, v72, v73
    v_cvt_pk_bf16_f32 v81, v74, v75
    v_cvt_pk_bf16_f32 v82, v76, v77
    v_cvt_pk_bf16_f32 v83, v78, v79
    buffer_store_dwordx4 v[80:83], v24, s[16:19], 0 offen offset:1024 sc1
    v_accvgpr_read_b32 v84, a8
    v_accvgpr_read_b32 v85, a9
    v_accvgpr_read_b32 v86, a10
    v_accvgpr_read_b32 v87, a11
    v_accvgpr_read_b32 v88, a24
    v_accvgpr_read_b32 v89, a25
    v_accvgpr_read_b32 v90, a26
    v_accvgpr_read_b32 v91, a27
    v_cvt_pk_bf16_f32 v92, v84, v85
    v_cvt_pk_bf16_f32 v93, v86, v87
    v_cvt_pk_bf16_f32 v94, v88, v89
    v_cvt_pk_bf16_f32 v95, v90, v91
    buffer_store_dwordx4 v[92:95], v24, s[16:19], 0 offen offset:2048 sc1
    v_accvgpr_read_b32 v60, a12
    v_accvgpr_read_b32 v61, a13
    v_accvgpr_read_b32 v62, a14
    v_accvgpr_read_b32 v63, a15
    v_accvgpr_read_b32 v64, a28
    v_accvgpr_read_b32 v65, a29
    v_accvgpr_read_b32 v66, a30
    v_accvgpr_read_b32 v67, a31
    v_cvt_pk_bf16_f32 v68, v60, v61
    v_cvt_pk_bf16_f32 v69, v62, v63
    v_cvt_pk_bf16_f32 v70, v64, v65
    v_cvt_pk_bf16_f32 v71, v66, v67
    buffer_store_dwordx4 v[68:71], v24, s[16:19], 0 offen offset:3072 sc1
    v_add_u32 v24, 262144, v24
    v_accvgpr_read_b32 v72, a32
    v_accvgpr_read_b32 v73, a33
    v_accvgpr_read_b32 v74, a34
    v_accvgpr_read_b32 v75, a35
    v_accvgpr_read_b32 v76, a48
    v_accvgpr_read_b32 v77, a49
    v_accvgpr_read_b32 v78, a50
    v_accvgpr_read_b32 v79, a51
    v_cvt_pk_bf16_f32 v80, v72, v73
    v_cvt_pk_bf16_f32 v81, v74, v75
    v_cvt_pk_bf16_f32 v82, v76, v77
    v_cvt_pk_bf16_f32 v83, v78, v79
    buffer_store_dwordx4 v[80:83], v24, s[16:19], 0 offen offset:0 sc1
    v_accvgpr_read_b32 v84, a36
    v_accvgpr_read_b32 v85, a37
    v_accvgpr_read_b32 v86, a38
    v_accvgpr_read_b32 v87, a39
    v_accvgpr_read_b32 v88, a52
    v_accvgpr_read_b32 v89, a53
    v_accvgpr_read_b32 v90, a54
    v_accvgpr_read_b32 v91, a55
    v_cvt_pk_bf16_f32 v92, v84, v85
    v_cvt_pk_bf16_f32 v93, v86, v87
    v_cvt_pk_bf16_f32 v94, v88, v89
    v_cvt_pk_bf16_f32 v95, v90, v91
    buffer_store_dwordx4 v[92:95], v24, s[16:19], 0 offen offset:1024 sc1
    v_accvgpr_read_b32 v60, a40
    v_accvgpr_read_b32 v61, a41
    v_accvgpr_read_b32 v62, a42
    v_accvgpr_read_b32 v63, a43
    v_accvgpr_read_b32 v64, a56
    v_accvgpr_read_b32 v65, a57
    v_accvgpr_read_b32 v66, a58
    v_accvgpr_read_b32 v67, a59
    v_cvt_pk_bf16_f32 v68, v60, v61
    v_cvt_pk_bf16_f32 v69, v62, v63
    v_cvt_pk_bf16_f32 v70, v64, v65
    v_cvt_pk_bf16_f32 v71, v66, v67
    buffer_store_dwordx4 v[68:71], v24, s[16:19], 0 offen offset:2048 sc1
    v_accvgpr_read_b32 v72, a44
    v_accvgpr_read_b32 v73, a45
    v_accvgpr_read_b32 v74, a46
    v_accvgpr_read_b32 v75, a47
    v_accvgpr_read_b32 v76, a60
    v_accvgpr_read_b32 v77, a61
    v_accvgpr_read_b32 v78, a62
    v_accvgpr_read_b32 v79, a63
    v_cvt_pk_bf16_f32 v80, v72, v73
    v_cvt_pk_bf16_f32 v81, v74, v75
    v_cvt_pk_bf16_f32 v82, v76, v77
    v_cvt_pk_bf16_f32 v83, v78, v79
    buffer_store_dwordx4 v[80:83], v24, s[16:19], 0 offen offset:3072 sc1
    s_nop 1
Lpf_44:
    s_lshl_b32 s20, s36, 7
    s_sub_u32 s21, s37, 32
    s_cmp_lt_u32 s21, 64
    s_cselect_b32 s21, 0, 2048
    s_add_u32 s20, s20, s21
    s_add_u32 s20, s20, 98566400
    s_waitcnt vmcnt(0)
    s_barrier
    s_cmp_lg_u32 s100, 0
    s_cbranch_scc1 Lsig_53
    v_mov_b32 v1, s20
    v_mov_b32 v2, 1
    s_mov_b64 exec, 1
    buffer_atomic_add v2, v1, s[16:19], 0 offen
    s_mov_b64 exec, -1
Lsig_53:
    s_branch Lnext_33
Lt_38:
    s_sub_u32 s5, s101, 1760
    s_cmp_ge_u32 s5, 128
    s_cbranch_scc1 LpB_54
    s_mov_b32 s8, s74
    s_and_b32 s9, s75, 0xffff
    s_mov_b32 s10, 4718592
    s_mov_b32 s11, 0x00020000
    s_mul_i32 s20, s5, 36864
    s_branch Lpc_55
LpB_54:
    s_mov_b32 s8, s82
    s_and_b32 s9, s83, 0xffff
    s_mov_b32 s10, 663552
    s_mov_b32 s11, 0x00020000
    s_sub_u32 s20, s5, 128
    s_mul_i32 s20, s20, 36864
Lpc_55:
    v_lshlrev_b32 v1, 4, v0
    buffer_load_dwordx4 v[16:19], v1, s[8:11], s20 offen
    s_add_u32 s20, s20, 4096
    buffer_load_dwordx4 v[20:23], v1, s[8:11], s20 offen
    s_add_u32 s20, s20, 4096
    buffer_load_dwordx4 v[24:27], v1, s[8:11], s20 offen
    s_add_u32 s20, s20, 4096
    buffer_load_dwordx4 v[28:31], v1, s[8:11], s20 offen
    s_add_u32 s20, s20, 4096
    buffer_load_dwordx4 v[32:35], v1, s[8:11], s20 offen
    s_add_u32 s20, s20, 4096
    buffer_load_dwordx4 v[36:39], v1, s[8:11], s20 offen
    s_add_u32 s20, s20, 4096
    buffer_load_dwordx4 v[40:43], v1, s[8:11], s20 offen
    s_add_u32 s20, s20, 4096
    buffer_load_dwordx4 v[44:47], v1, s[8:11], s20 offen
    s_add_u32 s20, s20, 4096
    buffer_load_dwordx4 v[48:51], v1, s[8:11], s20 offen
    s_add_u32 s20, s20, 4096
    s_waitcnt vmcnt(8)
    ds_write_b128 v1, v[16:19] offset:0
    s_waitcnt vmcnt(7)
    ds_write_b128 v1, v[20:23] offset:4096
    s_waitcnt vmcnt(6)
    ds_write_b128 v1, v[24:27] offset:8192
    s_waitcnt vmcnt(5)
    ds_write_b128 v1, v[28:31] offset:12288
    s_waitcnt vmcnt(4)
    ds_write_b128 v1, v[32:35] offset:16384
    s_waitcnt vmcnt(3)
    ds_write_b128 v1, v[36:39] offset:20480
    s_waitcnt vmcnt(2)
    ds_write_b128 v1, v[40:43] offset:24576
    s_waitcnt vmcnt(1)
    ds_write_b128 v1, v[44:47] offset:28672
    s_waitcnt vmcnt(0)
    ds_write_b128 v1, v[48:51] offset:32768
    s_waitcnt lgkmcnt(0)
    s_barrier
    v_bfe_u32 v2, v0, 4, 2
    v_bfe_u32 v3, v0, 2, 2
    v_lshl_add_u32 v4, v2, 2, v3
    v_lshl_add_u32 v5, v2, 3, v3
    s_cmp_lt_u32 s5, 128
    s_cselect_b64 s[6:7], -1, 0
    v_cndmask_b32 v4, v5, v4, s[6:7]
    v_mul_u32_u24 v4, 1152, v4
    v_and_b32 v5, 3, v0
    v_lshl_add_u32 v4, v5, 3, v4
    s_mul_i32 s21, s100, 288
    v_add_u32 v4, s21, v4
    s_cselect_b32 s21, 16, 4
    s_mul_i32 s21, s21, 1152
    v_add_u32 v5, s21, v4
    ds_read_b64_tr_b16 v[16:17], v4 offset:0
    ds_read_b64_tr_b16 v[18:19], v5 offset:0
    ds_read_b64_tr_b16 v[20:21], v4 offset:32
    ds_read_b64_tr_b16 v[22:23], v5 offset:32
    ds_read_b64_tr_b16 v[24:25], v4 offset:64
    ds_read_b64_tr_b16 v[26:27], v5 offset:64
    ds_read_b64_tr_b16 v[28:29], v4 offset:96
    ds_read_b64_tr_b16 v[30:31], v5 offset:96
    ds_read_b64_tr_b16 v[32:33], v4 offset:128
    ds_read_b64_tr_b16 v[34:35], v5 offset:128
    ds_read_b64_tr_b16 v[36:37], v4 offset:160
    ds_read_b64_tr_b16 v[38:39], v5 offset:160
    ds_read_b64_tr_b16 v[40:41], v4 offset:192
    ds_read_b64_tr_b16 v[42:43], v5 offset:192
    ds_read_b64_tr_b16 v[44:45], v4 offset:224
    ds_read_b64_tr_b16 v[46:47], v5 offset:224
    ds_read_b64_tr_b16 v[48:49], v4 offset:256
    ds_read_b64_tr_b16 v[50:51], v5 offset:256
    v_and_b32 v6, 63, v0
    v_lshlrev_b32 v6, 4, v6
    s_mul_i32 s20, s5, 36864
    s_mul_i32 s21, s100, 9216
    s_add_u32 s20, s20, s21
    s_add_u32 s20, s20, 100663296
    s_waitcnt lgkmcnt(0)
    buffer_store_dwordx4 v[16:19], v6, s[16:19], s20 offen sc1
    s_add_u32 s20, s20, 1024
    buffer_store_dwordx4 v[20:23], v6, s[16:19], s20 offen sc1
    s_add_u32 s20, s20, 1024
    buffer_store_dwordx4 v[24:27], v6, s[16:19], s20 offen sc1
    s_add_u32 s20, s20, 1024
    buffer_store_dwordx4 v[28:31], v6, s[16:19], s20 offen sc1
    s_add_u32 s20, s20, 1024
    buffer_store_dwordx4 v[32:35], v6, s[16:19], s20 offen sc1
    s_add_u32 s20, s20, 1024
    buffer_store_dwordx4 v[36:39], v6, s[16:19], s20 offen sc1
    s_add_u32 s20, s20, 1024
    buffer_store_dwordx4 v[40:43], v6, s[16:19], s20 offen sc1
    s_add_u32 s20, s20, 1024
    buffer_store_dwordx4 v[44:47], v6, s[16:19], s20 offen sc1
    s_add_u32 s20, s20, 1024
    buffer_store_dwordx4 v[48:51], v6, s[16:19], s20 offen sc1
    s_add_u32 s20, s20, 1024
    s_mov_b32 s20, 98566272
    s_waitcnt vmcnt(0)
    s_barrier
    s_cmp_lg_u32 s100, 0
    s_cbranch_scc1 Lsig_56
    v_mov_b32 v1, s20
    v_mov_b32 v2, 1
    s_mov_b64 exec, 1
    buffer_atomic_add v2, v1, s[16:19], 0 offen
    s_mov_b64 exec, -1
Lsig_56:
    s_branch Lnext_33
Lt_39:
    s_sub_u32 s5, s101, 1906
    s_lshr_b32 s20, s5, 3
    s_and_b32 s21, s5, 7
    s_lshl_b32 s21, s21, 2
    s_add_u32 s21, s21, s100
    s_lshr_b32 s22, s20, 3
    s_sub_i32 s22, s22, 0
    s_max_i32 s22, s22, 0
    s_lshl_b32 s22, s22, 7
    s_add_u32 s22, s22, 98568448
    s_lshr_b32 s23, s20, 3
    s_sub_i32 s23, s23, 1
    s_max_i32 s23, s23, 0
    s_lshl_b32 s23, s23, 7
    s_add_u32 s23, s23, 98568448
    s_lshr_b32 s24, s20, 3
    s_sub_i32 s24, s24, 2
    s_max_i32 s24, s24, 0
    s_lshl_b32 s24, s24, 7
    s_add_u32 s24, s24, 98568448
    s_cmp_lg_u32 s100, 0
    s_cbranch_scc1 Lwd_58
    s_mov_b32 s6, 0
    v_mov_b32 v1, s22
    v_writelane_b32 v1, s23, 1
    v_writelane_b32 v1, s24, 2
    s_mov_b64 exec, 7
    s_nop 0
Lw_57:
    buffer_load_dword v2, v1, s[16:19], 0 offen sc1
    s_waitcnt vmcnt(0)
    s_mov_b32 s7, 1
    v_readlane_b32 s4, v2, 0
    s_cmp_ge_u32 s4, 46
    s_cselect_b32 s7, s7, 0
    v_readlane_b32 s4, v2, 1
    s_cmp_ge_u32 s4, 46
    s_cselect_b32 s7, s7, 0
    v_readlane_b32 s4, v2, 2
    s_cmp_ge_u32 s4, 46
    s_cselect_b32 s7, s7, 0
    s_cmp_eq_u32 s7, 1
    s_nop 1
    s_cbranch_scc1 Lwd_58
    s_sleep 16
    s_add_u32 s6, s6, 1
    s_cmp_lt_u32 s6, 131072
    s_cbranch_scc1 Lw_57
Lwd_58:
    s_mov_b64 exec, -1
    s_barrier
    s_add_u32 s8, s90, 67108864
    s_addc_u32 s9, s91, 0
    s_and_b32 s9, s9, 0xffff
    s_mov_b32 s10, 4718592
    s_mov_b32 s11, 0x00020000
    v_and_b32 v1, 63, v0
    v_and_b32 v3, 15, v1
    v_lshrrev_b32 v4, 4, v1
    v_mul_u32_u24 v5, 2304, v3
    v_lshlrev_b32 v7, 4, v4
    v_min_u32 v7, 20, v7
    v_add_u32 v5, v5, v7
    s_mul_i32 s22, s21, 36
    v_add_u32 v5, s22, v5
    s_mul_i32 s23, s20, 36864
    buffer_load_dwordx4 v[8:11], v5, s[8:11], s23 offen
    s_add_i32 s26, s20, -16
    s_max_i32 s26, s26, 0
    s_mul_i32 s26, s26, 36864
    s_add_u32 s26, s26, 1152
    buffer_load_dwordx4 v[16:19], v5, s[8:11], s26 offen
    s_add_i32 s26, s20, -15
    s_max_i32 s26, s26, 0
    s_mul_i32 s26, s26, 36864
    s_add_u32 s26, s26, 1152
    buffer_load_dwordx4 v[20:23], v5, s[8:11], s26 offen
    s_add_i32 s26, s20, -14
    s_max_i32 s26, s26, 0
    s_mul_i32 s26, s26, 36864
    s_add_u32 s26, s26, 1152
    buffer_load_dwordx4 v[24:27], v5, s[8:11], s26 offen
    s_add_i32 s26, s20, -13
    s_max_i32 s26, s26, 0
    s_mul_i32 s26, s26, 36864
    s_add_u32 s26, s26, 1152
    buffer_load_dwordx4 v[28:31], v5, s[8:11], s26 offen
    s_add_i32 s26, s20, -12
    s_max_i32 s26, s26, 0
    s_mul_i32 s26, s26, 36864
    s_add_u32 s26, s26, 1152
    buffer_load_dwordx4 v[32:35], v5, s[8:11], s26 offen
    s_add_i32 s26, s20, -11
    s_max_i32 s26, s26, 0
    s_mul_i32 s26, s26, 36864
    s_add_u32 s26, s26, 1152
    buffer_load_dwordx4 v[36:39], v5, s[8:11], s26 offen
    s_add_i32 s26, s20, -10
    s_max_i32 s26, s26, 0
    s_mul_i32 s26, s26, 36864
    s_add_u32 s26, s26, 1152
    buffer_load_dwordx4 v[40:43], v5, s[8:11], s26 offen
    s_add_i32 s26, s20, -9
    s_max_i32 s26, s26, 0
    s_mul_i32 s26, s26, 36864
    s_add_u32 s26, s26, 1152
    buffer_load_dwordx4 v[44:47], v5, s[8:11], s26 offen
    s_add_i32 s26, s20, -8
    s_max_i32 s26, s26, 0
    s_mul_i32 s26, s26, 36864
    s_add_u32 s26, s26, 1152
    buffer_load_dwordx4 v[48:51], v5, s[8:11], s26 offen
    s_add_i32 s26, s20, -7
    s_max_i32 s26, s26, 0
    s_mul_i32 s26, s26, 36864
    s_add_u32 s26, s26, 1152
    buffer_load_dwordx4 v[52:55], v5, s[8:11], s26 offen
    s_add_i32 s26, s20, -6
    s_max_i32 s26, s26, 0
    s_mul_i32 s26, s26, 36864
    s_add_u32 s26, s26, 1152
    buffer_load_dwordx4 v[56:59], v5, s[8:11], s26 offen
    s_add_i32 s26, s20, -5
    s_max_i32 s26, s26, 0
    s_mul_i32 s26, s26, 36864
    s_add_u32 s26, s26, 1152
    buffer_load_dwordx4 v[60:63], v5, s[8:11], s26 offen
    s_add_i32 s26, s20, -4
    s_max_i32 s26, s26, 0
    s_mul_i32 s26, s26, 36864
    s_add_u32 s26, s26, 1152
    buffer_load_dwordx4 v[64:67], v5, s[8:11], s26 offen
    s_add_i32 s26, s20, -3
    s_max_i32 s26, s26, 0
    s_mul_i32 s26, s26, 36864
    s_add_u32 s26, s26, 1152
    buffer_load_dwordx4 v[68:71], v5, s[8:11], s26 offen
    s_add_i32 s26, s20, -2
    s_max_i32 s26, s26, 0
    s_mul_i32 s26, s26, 36864
    s_add_u32 s26, s26, 1152
    buffer_load_dwordx4 v[72:75], v5, s[8:11], s26 offen
    s_add_i32 s26, s20, -1
    s_max_i32 s26, s26, 0
    s_mul_i32 s26, s26, 36864
    s_add_u32 s26, s26, 1152
    buffer_load_dwordx4 v[76:79], v5, s[8:11], s26 offen
    s_add_i32 s26, s20, 0
    s_max_i32 s26, s26, 0
    s_mul_i32 s26, s26, 36864
    s_add_u32 s26, s26, 1152
    buffer_load_dwordx4 v[80:83], v5, s[8:11], s26 offen
    s_mul_i32 s22, s21, 18
    v_add_u32 v6, s22, v3
    v_lshlrev_b32 v6, 12, v6
    v_lshl_add_u32 v6, v4, 3, v6
    s_add_i32 s26, s20, -16
    s_max_i32 s26, s26, 0
    s_lshl_b32 s26, s26, 5
    s_add_u32 s26, s26, 75497472
    s_add_u32 s27, s26, 65536
    buffer_load_dwordx2 v[160:161], v6, s[16:19], s26 offen
    buffer_load_dwordx2 v[196:197], v6, s[16:19], s27 offen
    s_add_i32 s26, s20, -15
    s_max_i32 s26, s26, 0
    s_lshl_b32 s26, s26, 5
    s_add_u32 s26, s26, 75497472
    s_add_u32 s27, s26, 65536
    buffer_load_dwordx2 v[162:163], v6, s[16:19], s26 offen
    buffer_load_dwordx2 v[198:199], v6, s[16:19], s27 offen
    s_add_i32 s26, s20, -14
    s_max_i32 s26, s26, 0
    s_lshl_b32 s26, s26, 5
    s_add_u32 s26, s26, 75497472
    s_add_u32 s27, s26, 65536
    buffer_load_dwordx2 v[164:165], v6, s[16:19], s26 offen
    buffer_load_dwordx2 v[200:201], v6, s[16:19], s27 offen
    s_add_i32 s26, s20, -13
    s_max_i32 s26, s26, 0
    s_lshl_b32 s26, s26, 5
    s_add_u32 s26, s26, 75497472
    s_add_u32 s27, s26, 65536
    buffer_load_dwordx2 v[166:167], v6, s[16:19], s26 offen
    buffer_load_dwordx2 v[202:203], v6, s[16:19], s27 offen
    s_add_i32 s26, s20, -12
    s_max_i32 s26, s26, 0
    s_lshl_b32 s26, s26, 5
    s_add_u32 s26, s26, 75497472
    s_add_u32 s27, s26, 65536
    buffer_load_dwordx2 v[168:169], v6, s[16:19], s26 offen
    buffer_load_dwordx2 v[204:205], v6, s[16:19], s27 offen
    s_add_i32 s26, s20, -11
    s_max_i32 s26, s26, 0
    s_lshl_b32 s26, s26, 5
    s_add_u32 s26, s26, 75497472
    s_add_u32 s27, s26, 65536
    buffer_load_dwordx2 v[170:171], v6, s[16:19], s26 offen
    buffer_load_dwordx2 v[206:207], v6, s[16:19], s27 offen
    s_add_i32 s26, s20, -10
    s_max_i32 s26, s26, 0
    s_lshl_b32 s26, s26, 5
    s_add_u32 s26, s26, 75497472
    s_add_u32 s27, s26, 65536
    buffer_load_dwordx2 v[172:173], v6, s[16:19], s26 offen
    buffer_load_dwordx2 v[208:209], v6, s[16:19], s27 offen
    s_add_i32 s26, s20, -9
    s_max_i32 s26, s26, 0
    s_lshl_b32 s26, s26, 5
    s_add_u32 s26, s26, 75497472
    s_add_u32 s27, s26, 65536
    buffer_load_dwordx2 v[174:175], v6, s[16:19], s26 offen
    buffer_load_dwordx2 v[210:211], v6, s[16:19], s27 offen
    s_add_i32 s26, s20, -8
    s_max_i32 s26, s26, 0
    s_lshl_b32 s26, s26, 5
    s_add_u32 s26, s26, 75497472
    s_add_u32 s27, s26, 65536
    buffer_load_dwordx2 v[176:177], v6, s[16:19], s26 offen
    buffer_load_dwordx2 v[212:213], v6, s[16:19], s27 offen
    s_add_i32 s26, s20, -7
    s_max_i32 s26, s26, 0
    s_lshl_b32 s26, s26, 5
    s_add_u32 s26, s26, 75497472
    s_add_u32 s27, s26, 65536
    buffer_load_dwordx2 v[178:179], v6, s[16:19], s26 offen
    buffer_load_dwordx2 v[214:215], v6, s[16:19], s27 offen
    s_add_i32 s26, s20, -6
    s_max_i32 s26, s26, 0
    s_lshl_b32 s26, s26, 5
    s_add_u32 s26, s26, 75497472
    s_add_u32 s27, s26, 65536
    buffer_load_dwordx2 v[180:181], v6, s[16:19], s26 offen
    buffer_load_dwordx2 v[216:217], v6, s[16:19], s27 offen
    s_add_i32 s26, s20, -5
    s_max_i32 s26, s26, 0
    s_lshl_b32 s26, s26, 5
    s_add_u32 s26, s26, 75497472
    s_add_u32 s27, s26, 65536
    buffer_load_dwordx2 v[182:183], v6, s[16:19], s26 offen
    buffer_load_dwordx2 v[218:219], v6, s[16:19], s27 offen
    s_add_i32 s26, s20, -4
    s_max_i32 s26, s26, 0
    s_lshl_b32 s26, s26, 5
    s_add_u32 s26, s26, 75497472
    s_add_u32 s27, s26, 65536
    buffer_load_dwordx2 v[184:185], v6, s[16:19], s26 offen
    buffer_load_dwordx2 v[220:221], v6, s[16:19], s27 offen
    s_add_i32 s26, s20, -3
    s_max_i32 s26, s26, 0
    s_lshl_b32 s26, s26, 5
    s_add_u32 s26, s26, 75497472
    s_add_u32 s27, s26, 65536
    buffer_load_dwordx2 v[186:187], v6, s[16:19], s26 offen
    buffer_load_dwordx2 v[222:223], v6, s[16:19], s27 offen
    s_add_i32 s26, s20, -2
    s_max_i32 s26, s26, 0
    s_lshl_b32 s26, s26, 5
    s_add_u32 s26, s26, 75497472
    s_add_u32 s27, s26, 65536
    buffer_load_dwordx2 v[188:189], v6, s[16:19], s26 offen
    buffer_load_dwordx2 v[224:225], v6, s[16:19], s27 offen
    s_add_i32 s26, s20, -1
    s_max_i32 s26, s26, 0
    s_lshl_b32 s26, s26, 5
    s_add_u32 s26, s26, 75497472
    s_add_u32 s27, s26, 65536
    buffer_load_dwordx2 v[190:191], v6, s[16:19], s26 offen
    buffer_load_dwordx2 v[226:227], v6, s[16:19], s27 offen
    s_add_i32 s26, s20, 0
    s_max_i32 s26, s26, 0
    s_lshl_b32 s26, s26, 5
    s_add_u32 s26, s26, 75497472
    s_add_u32 s27, s26, 65536
    buffer_load_dwordx2 v[192:193], v6, s[16:19], s26 offen
    buffer_load_dwordx2 v[228:229], v6, s[16:19], s27 offen
    s_add_i32 s26, s20, 0
    s_max_i32 s26, s26, 0
    s_lshl_b32 s26, s26, 5
    s_add_u32 s26, s26, 75497472
    s_add_u32 s27, s26, 65536
    buffer_load_dwordx2 v[194:195], v6, s[16:19], s26 offen
    buffer_load_dwordx2 v[230:231], v6, s[16:19], s27 offen
    s_waitcnt vmcnt(53)
    v_cmp_gt_u32 vcc, 3, v4
    s_nop 1
    v_cndmask_b32 v11, 0, v11, vcc
    v_cmp_gt_u32 vcc, 2, v4
    s_nop 1
    v_cndmask_b32 v8, 0, v8, vcc
    v_cndmask_b32 v9, 0, v9, vcc
    v_cndmask_b32 v10, 0, v10, vcc
    s_waitcnt vmcnt(52)
    s_nop 0
    v_mfma_f32_16x16x32_bf16 v[88:91], v[16:19], v[8:11], 0
    s_waitcnt vmcnt(51)
    v_mfma_f32_16x16x32_bf16 v[92:95], v[20:23], v[8:11], 0
    s_waitcnt vmcnt(50)
    v_mfma_f32_16x16x32_bf16 v[96:99], v[24:27], v[8:11], 0
    s_waitcnt vmcnt(49)
    v_mfma_f32_16x16x32_bf16 v[100:103], v[28:31], v[8:11], 0
    s_waitcnt vmcnt(48)
    v_mfma_f32_16x16x32_bf16 v[104:107], v[32:35], v[8:11], 0
    s_waitcnt vmcnt(47)
    v_mfma_f32_16x16x32_bf16 v[108:111], v[36:39], v[8:11], 0
    s_waitcnt vmcnt(46)
    v_mfma_f32_16x16x32_bf16 v[112:115], v[40:43], v[8:11], 0
    s_waitcnt vmcnt(45)
    v_mfma_f32_16x16x32_bf16 v[116:119], v[44:47], v[8:11], 0
    s_waitcnt vmcnt(44)
    v_mfma_f32_16x16x32_bf16 v[120:123], v[48:51], v[8:11], 0
    s_waitcnt vmcnt(43)
    v_mfma_f32_16x16x32_bf16 v[124:127], v[52:55], v[8:11], 0
    s_waitcnt vmcnt(42)
    v_mfma_f32_16x16x32_bf16 v[128:131], v[56:59], v[8:11], 0
    s_waitcnt vmcnt(41)
    v_mfma_f32_16x16x32_bf16 v[132:135], v[60:63], v[8:11], 0
    s_waitcnt vmcnt(40)
    v_mfma_f32_16x16x32_bf16 v[136:139], v[64:67], v[8:11], 0
    s_waitcnt vmcnt(39)
    v_mfma_f32_16x16x32_bf16 v[140:143], v[68:71], v[8:11], 0
    s_waitcnt vmcnt(38)
    v_mfma_f32_16x16x32_bf16 v[144:147], v[72:75], v[8:11], 0
    s_waitcnt vmcnt(37)
    v_mfma_f32_16x16x32_bf16 v[148:151], v[76:79], v[8:11], 0
    s_waitcnt vmcnt(36)
    v_mfma_f32_16x16x32_bf16 v[152:155], v[80:83], v[8:11], 0
    v_cvt_pk_bf16_f32 v7, v88, v89
    v_lshlrev_b32 v88, 16, v7
    v_and_b32 v89, 0xffff0000, v7
    v_cvt_pk_bf16_f32 v7, v90, v91
    v_lshlrev_b32 v90, 16, v7
    v_and_b32 v91, 0xffff0000, v7
    v_cvt_pk_bf16_f32 v7, v92, v93
    v_lshlrev_b32 v92, 16, v7
    v_and_b32 v93, 0xffff0000, v7
    v_cvt_pk_bf16_f32 v7, v94, v95
    v_lshlrev_b32 v94, 16, v7
    v_and_b32 v95, 0xffff0000, v7
    v_cvt_pk_bf16_f32 v7, v96, v97
    v_lshlrev_b32 v96, 16, v7
    v_and_b32 v97, 0xffff0000, v7
    v_cvt_pk_bf16_f32 v7, v98, v99
    v_lshlrev_b32 v98, 16, v7
    v_and_b32 v99, 0xffff0000, v7
    v_cvt_pk_bf16_f32 v7, v100, v101
    v_lshlrev_b32 v100, 16, v7
    v_and_b32 v101, 0xffff0000, v7
    v_cvt_pk_bf16_f32 v7, v102, v103
    v_lshlrev_b32 v102, 16, v7
    v_and_b32 v103, 0xffff0000, v7
    v_cvt_pk_bf16_f32 v7, v104, v105
    v_lshlrev_b32 v104, 16, v7
    v_and_b32 v105, 0xffff0000, v7
    v_cvt_pk_bf16_f32 v7, v106, v107
    v_lshlrev_b32 v106, 16, v7
    v_and_b32 v107, 0xffff0000, v7
    v_cvt_pk_bf16_f32 v7, v108, v109
    v_lshlrev_b32 v108, 16, v7
    v_and_b32 v109, 0xffff0000, v7
    v_cvt_pk_bf16_f32 v7, v110, v111
    v_lshlrev_b32 v110, 16, v7
    v_and_b32 v111, 0xffff0000, v7
    v_cvt_pk_bf16_f32 v7, v112, v113
    v_lshlrev_b32 v112, 16, v7
    v_and_b32 v113, 0xffff0000, v7
    v_cvt_pk_bf16_f32 v7, v114, v115
    v_lshlrev_b32 v114, 16, v7
    v_and_b32 v115, 0xffff0000, v7
    v_cvt_pk_bf16_f32 v7, v116, v117
    v_lshlrev_b32 v116, 16, v7
    v_and_b32 v117, 0xffff0000, v7
    v_cvt_pk_bf16_f32 v7, v118, v119
    v_lshlrev_b32 v118, 16, v7
    v_and_b32 v119, 0xffff0000, v7
    v_cvt_pk_bf16_f32 v7, v120, v121
    v_lshlrev_b32 v120, 16, v7
    v_and_b32 v121, 0xffff0000, v7
    v_cvt_pk_bf16_f32 v7, v122, v123
    v_lshlrev_b32 v122, 16, v7
    v_and_b32 v123, 0xffff0000, v7
    v_cvt_pk_bf16_f32 v7, v124, v125
    v_lshlrev_b32 v124, 16, v7
    v_and_b32 v125, 0xffff0000, v7
    v_cvt_pk_bf16_f32 v7, v126, v127
    v_lshlrev_b32 v126, 16, v7
    v_and_b32 v127, 0xffff0000, v7
    v_cvt_pk_bf16_f32 v7, v128, v129
    v_lshlrev_b32 v128, 16, v7
    v_and_b32 v129, 0xffff0000, v7
    v_cvt_pk_bf16_f32 v7, v130, v131
    v_lshlrev_b32 v130, 16, v7
    v_and_b32 v131, 0xffff0000, v7
    v_cvt_pk_bf16_f32 v7, v132, v133
    v_lshlrev_b32 v132, 16, v7
    v_and_b32 v133, 0xffff0000, v7
    v_cvt_pk_bf16_f32 v7, v134, v135
    v_lshlrev_b32 v134, 16, v7
    v_and_b32 v135, 0xffff0000, v7
    v_cvt_pk_bf16_f32 v7, v136, v137
    v_lshlrev_b32 v136, 16, v7
    v_and_b32 v137, 0xffff0000, v7
    v_cvt_pk_bf16_f32 v7, v138, v139
    v_lshlrev_b32 v138, 16, v7
    v_and_b32 v139, 0xffff0000, v7
    v_cvt_pk_bf16_f32 v7, v140, v141
    v_lshlrev_b32 v140, 16, v7
    v_and_b32 v141, 0xffff0000, v7
    v_cvt_pk_bf16_f32 v7, v142, v143
    v_lshlrev_b32 v142, 16, v7
    v_and_b32 v143, 0xffff0000, v7
    v_cvt_pk_bf16_f32 v7, v144, v145
    v_lshlrev_b32 v144, 16, v7
    v_and_b32 v145, 0xffff0000, v7
    v_cvt_pk_bf16_f32 v7, v146, v147
    v_lshlrev_b32 v146, 16, v7
    v_and_b32 v147, 0xffff0000, v7
    v_cvt_pk_bf16_f32 v7, v148, v149
    v_lshlrev_b32 v148, 16, v7
    v_and_b32 v149, 0xffff0000, v7
    v_cvt_pk_bf16_f32 v7, v150, v151
    v_lshlrev_b32 v150, 16, v7
    v_and_b32 v151, 0xffff0000, v7
    v_cvt_pk_bf16_f32 v7, v152, v153
    v_lshlrev_b32 v152, 16, v7
    v_and_b32 v153, 0xffff0000, v7
    v_cvt_pk_bf16_f32 v7, v154, v155
    v_lshlrev_b32 v154, 16, v7
    v_and_b32 v155, 0xffff0000, v7
    s_mov_b32 s30, 0x3e715bef
    v_mul_f32 v88, s30, v88
    v_mul_f32 v89, s30, v89
    v_mul_f32 v90, s30, v90
    v_mul_f32 v91, s30, v91
    v_mul_f32 v92, s30, v92
    v_mul_f32 v93, s30, v93
    v_mul_f32 v94, s30, v94
    v_mul_f32 v95, s30, v95
    v_mul_f32 v96, s30, v96
    v_mul_f32 v97, s30, v97
    v_mul_f32 v98, s30, v98
    v_mul_f32 v99, s30, v99
    v_mul_f32 v100, s30, v100
    v_mul_f32 v101, s30, v101
    v_mul_f32 v102, s30, v102
    v_mul_f32 v103, s30, v103
    v_mul_f32 v104, s30, v104
    v_mul_f32 v105, s30, v105
    v_mul_f32 v106, s30, v106
    v_mul_f32 v107, s30, v107
    v_mul_f32 v108, s30, v108
    v_mul_f32 v109, s30, v109
    v_mul_f32 v110, s30, v110
    v_mul_f32 v111, s30, v111
    v_mul_f32 v112, s30, v112
    v_mul_f32 v113, s30, v113
    v_mul_f32 v114, s30, v114
    v_mul_f32 v115, s30, v115
    v_mul_f32 v116, s30, v116
    v_mul_f32 v117, s30, v117
    v_mul_f32 v118, s30, v118
    v_mul_f32 v119, s30, v119
    v_mul_f32 v120, s30, v120
    v_mul_f32 v121, s30, v121
    v_mul_f32 v122, s30, v122
    v_mul_f32 v123, s30, v123
    v_mul_f32 v124, s30, v124
    v_mul_f32 v125, s30, v125
    v_mul_f32 v126, s30, v126
    v_mul_f32 v127, s30, v127
    v_mul_f32 v128, s30, v128
    v_mul_f32 v129, s30, v129
    v_mul_f32 v130, s30, v130
    v_mul_f32 v131, s30, v131
    v_mul_f32 v132, s30, v132
    v_mul_f32 v133, s30, v133
    v_mul_f32 v134, s30, v134
    v_mul_f32 v135, s30, v135
    v_mul_f32 v136, s30, v136
    v_mul_f32 v137, s30, v137
    v_mul_f32 v138, s30, v138
    v_mul_f32 v139, s30, v139
    v_mul_f32 v140, s30, v140
    v_mul_f32 v141, s30, v141
    v_mul_f32 v142, s30, v142
    v_mul_f32 v143, s30, v143
    v_mul_f32 v144, s30, v144
    v_mul_f32 v145, s30, v145
    v_mul_f32 v146, s30, v146
    v_mul_f32 v147, s30, v147
    v_mul_f32 v148, s30, v148
    v_mul_f32 v149, s30, v149
    v_mul_f32 v150, s30, v150
    v_mul_f32 v151, s30, v151
    v_mul_f32 v152, s30, v152
    v_mul_f32 v153, s30, v153
    v_mul_f32 v154, s30, v154
    v_mul_f32 v155, s30, v155
    v_cvt_pk_bf16_f32 v7, v88, v89
    v_lshlrev_b32 v88, 16, v7
    v_and_b32 v89, 0xffff0000, v7
    v_cvt_pk_bf16_f32 v7, v90, v91
    v_lshlrev_b32 v90, 16, v7
    v_and_b32 v91, 0xffff0000, v7
    v_cvt_pk_bf16_f32 v7, v92, v93
    v_lshlrev_b32 v92, 16, v7
    v_and_b32 v93, 0xffff0000, v7
    v_cvt_pk_bf16_f32 v7, v94, v95
    v_lshlrev_b32 v94, 16, v7
    v_and_b32 v95, 0xffff0000, v7
    v_cvt_pk_bf16_f32 v7, v96, v97
    v_lshlrev_b32 v96, 16, v7
    v_and_b32 v97, 0xffff0000, v7
    v_cvt_pk_bf16_f32 v7, v98, v99
    v_lshlrev_b32 v98, 16, v7
    v_and_b32 v99, 0xffff0000, v7
    v_cvt_pk_bf16_f32 v7, v100, v101
    v_lshlrev_b32 v100, 16, v7
    v_and_b32 v101, 0xffff0000, v7
    v_cvt_pk_bf16_f32 v7, v102, v103
    v_lshlrev_b32 v102, 16, v7
    v_and_b32 v103, 0xffff0000, v7
    v_cvt_pk_bf16_f32 v7, v104, v105
    v_lshlrev_b32 v104, 16, v7
    v_and_b32 v105, 0xffff0000, v7
    v_cvt_pk_bf16_f32 v7, v106, v107
    v_lshlrev_b32 v106, 16, v7
    v_and_b32 v107, 0xffff0000, v7
    v_cvt_pk_bf16_f32 v7, v108, v109
    v_lshlrev_b32 v108, 16, v7
    v_and_b32 v109, 0xffff0000, v7
    v_cvt_pk_bf16_f32 v7, v110, v111
    v_lshlrev_b32 v110, 16, v7
    v_and_b32 v111, 0xffff0000, v7
    v_cvt_pk_bf16_f32 v7, v112, v113
    v_lshlrev_b32 v112, 16, v7
    v_and_b32 v113, 0xffff0000, v7
    v_cvt_pk_bf16_f32 v7, v114, v115
    v_lshlrev_b32 v114, 16, v7
    v_and_b32 v115, 0xffff0000, v7
    v_cvt_pk_bf16_f32 v7, v116, v117
    v_lshlrev_b32 v116, 16, v7
    v_and_b32 v117, 0xffff0000, v7
    v_cvt_pk_bf16_f32 v7, v118, v119
    v_lshlrev_b32 v118, 16, v7
    v_and_b32 v119, 0xffff0000, v7
    v_cvt_pk_bf16_f32 v7, v120, v121
    v_lshlrev_b32 v120, 16, v7
    v_and_b32 v121, 0xffff0000, v7
    v_cvt_pk_bf16_f32 v7, v122, v123
    v_lshlrev_b32 v122, 16, v7
    v_and_b32 v123, 0xffff0000, v7
    v_cvt_pk_bf16_f32 v7, v124, v125
    v_lshlrev_b32 v124, 16, v7
    v_and_b32 v125, 0xffff0000, v7
    v_cvt_pk_bf16_f32 v7, v126, v127
    v_lshlrev_b32 v126, 16, v7
    v_and_b32 v127, 0xffff0000, v7
    v_cvt_pk_bf16_f32 v7, v128, v129
    v_lshlrev_b32 v128, 16, v7
    v_and_b32 v129, 0xffff0000, v7
    v_cvt_pk_bf16_f32 v7, v130, v131
    v_lshlrev_b32 v130, 16, v7
    v_and_b32 v131, 0xffff0000, v7
    v_cvt_pk_bf16_f32 v7, v132, v133
    v_lshlrev_b32 v132, 16, v7
    v_and_b32 v133, 0xffff0000, v7
    v_cvt_pk_bf16_f32 v7, v134, v135
    v_lshlrev_b32 v134, 16, v7
    v_and_b32 v135, 0xffff0000, v7
    v_cvt_pk_bf16_f32 v7, v136, v137
    v_lshlrev_b32 v136, 16, v7
    v_and_b32 v137, 0xffff0000, v7
    v_cvt_pk_bf16_f32 v7, v138, v139
    v_lshlrev_b32 v138, 16, v7
    v_and_b32 v139, 0xffff0000, v7
    v_cvt_pk_bf16_f32 v7, v140, v141
    v_lshlrev_b32 v140, 16, v7
    v_and_b32 v141, 0xffff0000, v7
    v_cvt_pk_bf16_f32 v7, v142, v143
    v_lshlrev_b32 v142, 16, v7
    v_and_b32 v143, 0xffff0000, v7
    v_cvt_pk_bf16_f32 v7, v144, v145
    v_lshlrev_b32 v144, 16, v7
    v_and_b32 v145, 0xffff0000, v7
    v_cvt_pk_bf16_f32 v7, v146, v147
    v_lshlrev_b32 v146, 16, v7
    v_and_b32 v147, 0xffff0000, v7
    v_cvt_pk_bf16_f32 v7, v148, v149
    v_lshlrev_b32 v148, 16, v7
    v_and_b32 v149, 0xffff0000, v7
    v_cvt_pk_bf16_f32 v7, v150, v151
    v_lshlrev_b32 v150, 16, v7
    v_and_b32 v151, 0xffff0000, v7
    v_cvt_pk_bf16_f32 v7, v152, v153
    v_lshlrev_b32 v152, 16, v7
    v_and_b32 v153, 0xffff0000, v7
    v_cvt_pk_bf16_f32 v7, v154, v155
    v_lshlrev_b32 v154, 16, v7
    v_and_b32 v155, 0xffff0000, v7
    v_mov_b32 v12, 0xf149f2ca
    v_lshlrev_b32 v13, 2, v4
    v_add_u32 v14, 0, v13
    v_cmp_le_u32 vcc, v14, v3
    s_nop 1
    v_cndmask_b32 v152, v12, v152, vcc
    v_cndmask_b32 v88, v88, v12, vcc
    v_add_u32 v14, 1, v13
    v_cmp_le_u32 vcc, v14, v3
    s_nop 1
    v_cndmask_b32 v153, v12, v153, vcc
    v_cndmask_b32 v89, v89, v12, vcc
    v_add_u32 v14, 2, v13
    v_cmp_le_u32 vcc, v14, v3
    s_nop 1
    v_cndmask_b32 v154, v12, v154, vcc
    v_cndmask_b32 v90, v90, v12, vcc
    v_add_u32 v14, 3, v13
    v_cmp_le_u32 vcc, v14, v3
    s_nop 1
    v_cndmask_b32 v155, v12, v155, vcc
    v_cndmask_b32 v91, v91, v12, vcc
    s_cmp_ge_u32 s20, 16
    s_nop 0
    s_cbranch_scc1 Lsk_59
    s_cmp_ge_u32 s20, 16
    s_cselect_b64 s[28:29], -1, 0
    v_cndmask_b32 v88, v12, v88, s[28:29]
    v_cndmask_b32 v89, v12, v89, s[28:29]
    v_cndmask_b32 v90, v12, v90, s[28:29]
    v_cndmask_b32 v91, v12, v91, s[28:29]
    s_cmp_ge_u32 s20, 15
    s_cselect_b64 s[28:29], -1, 0
    v_cndmask_b32 v92, v12, v92, s[28:29]
    v_cndmask_b32 v93, v12, v93, s[28:29]
    v_cndmask_b32 v94, v12, v94, s[28:29]
    v_cndmask_b32 v95, v12, v95, s[28:29]
    s_cmp_ge_u32 s20, 14
    s_cselect_b64 s[28:29], -1, 0
    v_cndmask_b32 v96, v12, v96, s[28:29]
    v_cndmask_b32 v97, v12, v97, s[28:29]
    v_cndmask_b32 v98, v12, v98, s[28:29]
    v_cndmask_b32 v99, v12, v99, s[28:29]
    s_cmp_ge_u32 s20, 13
    s_cselect_b64 s[28:29], -1, 0
    v_cndmask_b32 v100, v12, v100, s[28:29]
    v_cndmask_b32 v101, v12, v101, s[28:29]
    v_cndmask_b32 v102, v12, v102, s[28:29]
    v_cndmask_b32 v103, v12, v103, s[28:29]
    s_cmp_ge_u32 s20, 12
    s_cselect_b64 s[28:29], -1, 0
    v_cndmask_b32 v104, v12, v104, s[28:29]
    v_cndmask_b32 v105, v12, v105, s[28:29]
    v_cndmask_b32 v106, v12, v106, s[28:29]
    v_cndmask_b32 v107, v12, v107, s[28:29]
    s_cmp_ge_u32 s20, 11
    s_cselect_b64 s[28:29], -1, 0
    v_cndmask_b32 v108, v12, v108, s[28:29]
    v_cndmask_b32 v109, v12, v109, s[28:29]
    v_cndmask_b32 v110, v12, v110, s[28:29]
    v_cndmask_b32 v111, v12, v111, s[28:29]
    s_cmp_ge_u32 s20, 10
    s_cselect_b64 s[28:29], -1, 0
    v_cndmask_b32 v112, v12, v112, s[28:29]
    v_cndmask_b32 v113, v12, v113, s[28:29]
    v_cndmask_b32 v114, v12, v114, s[28:29]
    v_cndmask_b32 v115, v12, v115, s[28:29]
    s_cmp_ge_u32 s20, 9
    s_cselect_b64 s[28:29], -1, 0
    v_cndmask_b32 v116, v12, v116, s[28:29]
    v_cndmask_b32 v117, v12, v117, s[28:29]
    v_cndmask_b32 v118, v12, v118, s[28:29]
    v_cndmask_b32 v119, v12, v119, s[28:29]
    s_cmp_ge_u32 s20, 8
    s_cselect_b64 s[28:29], -1, 0
    v_cndmask_b32 v120, v12, v120, s[28:29]
    v_cndmask_b32 v121, v12, v121, s[28:29]
    v_cndmask_b32 v122, v12, v122, s[28:29]
    v_cndmask_b32 v123, v12, v123, s[28:29]
    s_cmp_ge_u32 s20, 7
    s_cselect_b64 s[28:29], -1, 0
    v_cndmask_b32 v124, v12, v124, s[28:29]
    v_cndmask_b32 v125, v12, v125, s[28:29]
    v_cndmask_b32 v126, v12, v126, s[28:29]
    v_cndmask_b32 v127, v12, v127, s[28:29]
    s_cmp_ge_u32 s20, 6
    s_cselect_b64 s[28:29], -1, 0
    v_cndmask_b32 v128, v12, v128, s[28:29]
    v_cndmask_b32 v129, v12, v129, s[28:29]
    v_cndmask_b32 v130, v12, v130, s[28:29]
    v_cndmask_b32 v131, v12, v131, s[28:29]
    s_cmp_ge_u32 s20, 5
    s_cselect_b64 s[28:29], -1, 0
    v_cndmask_b32 v132, v12, v132, s[28:29]
    v_cndmask_b32 v133, v12, v133, s[28:29]
    v_cndmask_b32 v134, v12, v134, s[28:29]
    v_cndmask_b32 v135, v12, v135, s[28:29]
    s_cmp_ge_u32 s20, 4
    s_cselect_b64 s[28:29], -1, 0
    v_cndmask_b32 v136, v12, v136, s[28:29]
    v_cndmask_b32 v137, v12, v137, s[28:29]
    v_cndmask_b32 v138, v12, v138, s[28:29]
    v_cndmask_b32 v139, v12, v139, s[28:29]
    s_cmp_ge_u32 s20, 3
    s_cselect_b64 s[28:29], -1, 0
    v_cndmask_b32 v140, v12, v140, s[28:29]
    v_cndmask_b32 v141, v12, v141, s[28:29]
    v_cndmask_b32 v142, v12, v142, s[28:29]
    v_cndmask_b32 v143, v12, v143, s[28:29]
    s_cmp_ge_u32 s20, 2
    s_cselect_b64 s[28:29], -1, 0
    v_cndmask_b32 v144, v12, v144, s[28:29]
    v_cndmask_b32 v145, v12, v145, s[28:29]
    v_cndmask_b32 v146, v12, v146, s[28:29]
    v_cndmask_b32 v147, v12, v147, s[28:29]
    s_cmp_ge_u32 s20, 1
    s_cselect_b64 s[28:29], -1, 0
    v_cndmask_b32 v148, v12, v148, s[28:29]
    v_cndmask_b32 v149, v12, v149, s[28:29]
    v_cndmask_b32 v150, v12, v150, s[28:29]
    v_cndmask_b32 v151, v12, v151, s[28:29]
    s_nop 1
Lsk_59:
    v_max3_f32 v12, v88, v89, v90
    v_max3_f32 v13, v91, v92, v93
    v_max3_f32 v12, v12, v94, v95
    v_max3_f32 v13, v13, v96, v97
    v_max3_f32 v12, v12, v98, v99
    v_max3_f32 v13, v13, v100, v101
    v_max3_f32 v12, v12, v102, v103
    v_max3_f32 v13, v13, v104, v105
    v_max3_f32 v12, v12, v106, v107
    v_max3_f32 v13, v13, v108, v109
    v_max3_f32 v12, v12, v110, v111
    v_max3_f32 v13, v13, v112, v113
    v_max3_f32 v12, v12, v114, v115
    v_max3_f32 v13, v13, v116, v117
    v_max3_f32 v12, v12, v118, v119
    v_max3_f32 v13, v13, v120, v121
    v_max3_f32 v12, v12, v122, v123
    v_max3_f32 v13, v13, v124, v125
    v_max3_f32 v12, v12, v126, v127
    v_max3_f32 v13, v13, v128, v129
    v_max3_f32 v12, v12, v130, v131
    v_max3_f32 v13, v13, v132, v133
    v_max3_f32 v12, v12, v134, v135
    v_max3_f32 v13, v13, v136, v137
    v_max3_f32 v12, v12, v138, v139
    v_max3_f32 v13, v13, v140, v141
    v_max3_f32 v12, v12, v142, v143
    v_max3_f32 v13, v13, v144, v145
    v_max3_f32 v12, v12, v146, v147
    v_max3_f32 v13, v13, v148, v149
    v_max3_f32 v12, v12, v150, v151
    v_max3_f32 v13, v13, v152, v153
    v_max3_f32 v12, v12, v154, v155
    v_max_f32 v12, v12, v13
    v_mov_b32 v13, v12
    s_nop 1
    v_permlane16_swap_b32 v12, v13
    v_max_f32 v12, v12, v13
    v_mov_b32 v13, v12
    s_nop 1
    v_permlane32_swap_b32 v12, v13
    v_max_f32 v12, v12, v13
    s_mov_b32 s31, 0x3fb8aa3b
    v_sub_f32 v88, v88, v12
    v_sub_f32 v89, v89, v12
    v_sub_f32 v90, v90, v12
    v_sub_f32 v91, v91, v12
    v_sub_f32 v92, v92, v12
    v_sub_f32 v93, v93, v12
    v_sub_f32 v94, v94, v12
    v_sub_f32 v95, v95, v12
    v_sub_f32 v96, v96, v12
    v_sub_f32 v97, v97, v12
    v_sub_f32 v98, v98, v12
    v_sub_f32 v99, v99, v12
    v_sub_f32 v100, v100, v12
    v_sub_f32 v101, v101, v12
    v_sub_f32 v102, v102, v12
    v_sub_f32 v103, v103, v12
    v_sub_f32 v104, v104, v12
    v_sub_f32 v105, v105, v12
    v_sub_f32 v106, v106, v12
    v_sub_f32 v107, v107, v12
    v_sub_f32 v108, v108, v12
    v_sub_f32 v109, v109, v12
    v_sub_f32 v110, v110, v12
    v_sub_f32 v111, v111, v12
    v_sub_f32 v112, v112, v12
    v_sub_f32 v113, v113, v12
    v_sub_f32 v114, v114, v12
    v_sub_f32 v115, v115, v12
    v_sub_f32 v116, v116, v12
    v_sub_f32 v117, v117, v12
    v_sub_f32 v118, v118, v12
    v_sub_f32 v119, v119, v12
    v_sub_f32 v120, v120, v12
    v_sub_f32 v121, v121, v12
    v_sub_f32 v122, v122, v12
    v_sub_f32 v123, v123, v12
    v_sub_f32 v124, v124, v12
    v_sub_f32 v125, v125, v12
    v_sub_f32 v126, v126, v12
    v_sub_f32 v127, v127, v12
    v_sub_f32 v128, v128, v12
    v_sub_f32 v129, v129, v12
    v_sub_f32 v130, v130, v12
    v_sub_f32 v131, v131, v12
    v_sub_f32 v132, v132, v12
    v_sub_f32 v133, v133, v12
    v_sub_f32 v134, v134, v12
    v_sub_f32 v135, v135, v12
    v_sub_f32 v136, v136, v12
    v_sub_f32 v137, v137, v12
    v_sub_f32 v138, v138, v12
    v_sub_f32 v139, v139, v12
    v_sub_f32 v140, v140, v12
    v_sub_f32 v141, v141, v12
    v_sub_f32 v142, v142, v12
    v_sub_f32 v143, v143, v12
    v_sub_f32 v144, v144, v12
    v_sub_f32 v145, v145, v12
    v_sub_f32 v146, v146, v12
    v_sub_f32 v147, v147, v12
    v_sub_f32 v148, v148, v12
    v_sub_f32 v149, v149, v12
    v_sub_f32 v150, v150, v12
    v_sub_f32 v151, v151, v12
    v_sub_f32 v152, v152, v12
    v_sub_f32 v153, v153, v12
    v_sub_f32 v154, v154, v12
    v_sub_f32 v155, v155, v12
    v_mul_f32 v88, s31, v88
    v_mul_f32 v89, s31, v89
    v_mul_f32 v90, s31, v90
    v_mul_f32 v91, s31, v91
    v_mul_f32 v92, s31, v92
    v_mul_f32 v93, s31, v93
    v_mul_f32 v94, s31, v94
    v_mul_f32 v95, s31, v95
    v_mul_f32 v96, s31, v96
    v_mul_f32 v97, s31, v97
    v_mul_f32 v98, s31, v98
    v_mul_f32 v99, s31, v99
    v_mul_f32 v100, s31, v100
    v_mul_f32 v101, s31, v101
    v_mul_f32 v102, s31, v102
    v_mul_f32 v103, s31, v103
    v_mul_f32 v104, s31, v104
    v_mul_f32 v105, s31, v105
    v_mul_f32 v106, s31, v106
    v_mul_f32 v107, s31, v107
    v_mul_f32 v108, s31, v108
    v_mul_f32 v109, s31, v109
    v_mul_f32 v110, s31, v110
    v_mul_f32 v111, s31, v111
    v_mul_f32 v112, s31, v112
    v_mul_f32 v113, s31, v113
    v_mul_f32 v114, s31, v114
    v_mul_f32 v115, s31, v115
    v_mul_f32 v116, s31, v116
    v_mul_f32 v117, s31, v117
    v_mul_f32 v118, s31, v118
    v_mul_f32 v119, s31, v119
    v_mul_f32 v120, s31, v120
    v_mul_f32 v121, s31, v121
    v_mul_f32 v122, s31, v122
    v_mul_f32 v123, s31, v123
    v_mul_f32 v124, s31, v124
    v_mul_f32 v125, s31, v125
    v_mul_f32 v126, s31, v126
    v_mul_f32 v127, s31, v127
    v_mul_f32 v128, s31, v128
    v_mul_f32 v129, s31, v129
    v_mul_f32 v130, s31, v130
    v_mul_f32 v131, s31, v131
    v_mul_f32 v132, s31, v132
    v_mul_f32 v133, s31, v133
    v_mul_f32 v134, s31, v134
    v_mul_f32 v135, s31, v135
    v_mul_f32 v136, s31, v136
    v_mul_f32 v137, s31, v137
    v_mul_f32 v138, s31, v138
    v_mul_f32 v139, s31, v139
    v_mul_f32 v140, s31, v140
    v_mul_f32 v141, s31, v141
    v_mul_f32 v142, s31, v142
    v_mul_f32 v143, s31, v143
    v_mul_f32 v144, s31, v144
    v_mul_f32 v145, s31, v145
    v_mul_f32 v146, s31, v146
    v_mul_f32 v147, s31, v147
    v_mul_f32 v148, s31, v148
    v_mul_f32 v149, s31, v149
    v_mul_f32 v150, s31, v150
    v_mul_f32 v151, s31, v151
    v_mul_f32 v152, s31, v152
    v_mul_f32 v153, s31, v153
    v_mul_f32 v154, s31, v154
    v_mul_f32 v155, s31, v155
    v_exp_f32 v88, v88
    v_exp_f32 v89, v89
    v_exp_f32 v90, v90
    v_exp_f32 v91, v91
    v_exp_f32 v92, v92
    v_exp_f32 v93, v93
    v_exp_f32 v94, v94
    v_exp_f32 v95, v95
    v_exp_f32 v96, v96
    v_exp_f32 v97, v97
    v_exp_f32 v98, v98
    v_exp_f32 v99, v99
    v_exp_f32 v100, v100
    v_exp_f32 v101, v101
    v_exp_f32 v102, v102
    v_exp_f32 v103, v103
    v_exp_f32 v104, v104
    v_exp_f32 v105, v105
    v_exp_f32 v106, v106
    v_exp_f32 v107, v107
    v_exp_f32 v108, v108
    v_exp_f32 v109, v109
    v_exp_f32 v110, v110
    v_exp_f32 v111, v111
    v_exp_f32 v112, v112
    v_exp_f32 v113, v113
    v_exp_f32 v114, v114
    v_exp_f32 v115, v115
    v_exp_f32 v116, v116
    v_exp_f32 v117, v117
    v_exp_f32 v118, v118
    v_exp_f32 v119, v119
    v_exp_f32 v120, v120
    v_exp_f32 v121, v121
    v_exp_f32 v122, v122
    v_exp_f32 v123, v123
    v_exp_f32 v124, v124
    v_exp_f32 v125, v125
    v_exp_f32 v126, v126
    v_exp_f32 v127, v127
    v_exp_f32 v128, v128
    v_exp_f32 v129, v129
    v_exp_f32 v130, v130
    v_exp_f32 v131, v131
    v_exp_f32 v132, v132
    v_exp_f32 v133, v133
    v_exp_f32 v134, v134
    v_exp_f32 v135, v135
    v_exp_f32 v136, v136
    v_exp_f32 v137, v137
    v_exp_f32 v138, v138
    v_exp_f32 v139, v139
    v_exp_f32 v140, v140
    v_exp_f32 v141, v141
    v_exp_f32 v142, v142
    v_exp_f32 v143, v143
    v_exp_f32 v144, v144
    v_exp_f32 v145, v145
    v_exp_f32 v146, v146
    v_exp_f32 v147, v147
    v_exp_f32 v148, v148
    v_exp_f32 v149, v149
    v_exp_f32 v150, v150
    v_exp_f32 v151, v151
    v_exp_f32 v152, v152
    v_exp_f32 v153, v153
    v_exp_f32 v154, v154
    v_exp_f32 v155, v155
    v_pk_add_f32 v[12:13], v[88:89], v[90:91]
    v_pk_add_f32 v[12:13], v[12:13], v[92:93]
    v_pk_add_f32 v[12:13], v[12:13], v[94:95]
    v_pk_add_f32 v[12:13], v[12:13], v[96:97]
    v_pk_add_f32 v[12:13], v[12:13], v[98:99]
    v_pk_add_f32 v[12:13], v[12:13], v[100:101]
    v_pk_add_f32 v[12:13], v[12:13], v[102:103]
    v_pk_add_f32 v[12:13], v[12:13], v[104:105]
    v_pk_add_f32 v[12:13], v[12:13], v[106:107]
    v_pk_add_f32 v[12:13], v[12:13], v[108:109]
    v_pk_add_f32 v[12:13], v[12:13], v[110:111]
    v_pk_add_f32 v[12:13], v[12:13], v[112:113]
    v_pk_add_f32 v[12:13], v[12:13], v[114:115]
    v_pk_add_f32 v[12:13], v[12:13], v[116:117]
    v_pk_add_f32 v[12:13], v[12:13], v[118:119]
    v_pk_add_f32 v[12:13], v[12:13], v[120:121]
    v_pk_add_f32 v[12:13], v[12:13], v[122:123]
    v_pk_add_f32 v[12:13], v[12:13], v[124:125]
    v_pk_add_f32 v[12:13], v[12:13], v[126:127]
    v_pk_add_f32 v[12:13], v[12:13], v[128:129]
    v_pk_add_f32 v[12:13], v[12:13], v[130:131]
    v_pk_add_f32 v[12:13], v[12:13], v[132:133]
    v_pk_add_f32 v[12:13], v[12:13], v[134:135]
    v_pk_add_f32 v[12:13], v[12:13], v[136:137]
    v_pk_add_f32 v[12:13], v[12:13], v[138:139]
    v_pk_add_f32 v[12:13], v[12:13], v[140:141]
    v_pk_add_f32 v[12:13], v[12:13], v[142:143]
    v_pk_add_f32 v[12:13], v[12:13], v[144:145]
    v_pk_add_f32 v[12:13], v[12:13], v[146:147]
    v_pk_add_f32 v[12:13], v[12:13], v[148:149]
    v_pk_add_f32 v[12:13], v[12:13], v[150:151]
    v_pk_add_f32 v[12:13], v[12:13], v[152:153]
    v_pk_add_f32 v[12:13], v[12:13], v[154:155]
    v_add_f32 v12, v12, v13
    v_mov_b32 v13, v12
    s_nop 1
    v_permlane16_swap_b32 v12, v13
    v_add_f32 v12, v12, v13
    v_mov_b32 v13, v12
    s_nop 1
    v_permlane32_swap_b32 v12, v13
    v_add_f32 v12, v12, v13
    v_rcp_f32 v12, v12
    s_nop 0
    v_mov_b32 v13, v12
    v_pk_mul_f32 v[88:89], v[88:89], v[12:13]
    v_pk_mul_f32 v[90:91], v[90:91], v[12:13]
    v_pk_mul_f32 v[92:93], v[92:93], v[12:13]
    v_pk_mul_f32 v[94:95], v[94:95], v[12:13]
    v_pk_mul_f32 v[96:97], v[96:97], v[12:13]
    v_pk_mul_f32 v[98:99], v[98:99], v[12:13]
    v_pk_mul_f32 v[100:101], v[100:101], v[12:13]
    v_pk_mul_f32 v[102:103], v[102:103], v[12:13]
    v_pk_mul_f32 v[104:105], v[104:105], v[12:13]
    v_pk_mul_f32 v[106:107], v[106:107], v[12:13]
    v_pk_mul_f32 v[108:109], v[108:109], v[12:13]
    v_pk_mul_f32 v[110:111], v[110:111], v[12:13]
    v_pk_mul_f32 v[112:113], v[112:113], v[12:13]
    v_pk_mul_f32 v[114:115], v[114:115], v[12:13]
    v_pk_mul_f32 v[116:117], v[116:117], v[12:13]
    v_pk_mul_f32 v[118:119], v[118:119], v[12:13]
    v_pk_mul_f32 v[120:121], v[120:121], v[12:13]
    v_pk_mul_f32 v[122:123], v[122:123], v[12:13]
    v_pk_mul_f32 v[124:125], v[124:125], v[12:13]
    v_pk_mul_f32 v[126:127], v[126:127], v[12:13]
    v_pk_mul_f32 v[128:129], v[128:129], v[12:13]
    v_pk_mul_f32 v[130:131], v[130:131], v[12:13]
    v_pk_mul_f32 v[132:133], v[132:133], v[12:13]
    v_pk_mul_f32 v[134:135], v[134:135], v[12:13]
    v_pk_mul_f32 v[136:137], v[136:137], v[12:13]
    v_pk_mul_f32 v[138:139], v[138:139], v[12:13]
    v_pk_mul_f32 v[140:141], v[140:141], v[12:13]
    v_pk_mul_f32 v[142:143], v[142:143], v[12:13]
    v_pk_mul_f32 v[144:145], v[144:145], v[12:13]
    v_pk_mul_f32 v[146:147], v[146:147], v[12:13]
    v_pk_mul_f32 v[148:149], v[148:149], v[12:13]
    v_pk_mul_f32 v[150:151], v[150:151], v[12:13]
    v_pk_mul_f32 v[152:153], v[152:153], v[12:13]
    v_pk_mul_f32 v[154:155], v[154:155], v[12:13]
    v_cvt_pk_bf16_f32 v16, v88, v89
    v_cvt_pk_bf16_f32 v17, v90, v91
    v_cvt_pk_bf16_f32 v18, v92, v93
    v_cvt_pk_bf16_f32 v19, v94, v95
    v_cvt_pk_bf16_f32 v20, v96, v97
    v_cvt_pk_bf16_f32 v21, v98, v99
    v_cvt_pk_bf16_f32 v22, v100, v101
    v_cvt_pk_bf16_f32 v23, v102, v103
    v_cvt_pk_bf16_f32 v24, v104, v105
    v_cvt_pk_bf16_f32 v25, v106, v107
    v_cvt_pk_bf16_f32 v26, v108, v109
    v_cvt_pk_bf16_f32 v27, v110, v111
    v_cvt_pk_bf16_f32 v28, v112, v113
    v_cvt_pk_bf16_f32 v29, v114, v115
    v_cvt_pk_bf16_f32 v30, v116, v117
    v_cvt_pk_bf16_f32 v31, v118, v119
    v_cvt_pk_bf16_f32 v32, v120, v121
    v_cvt_pk_bf16_f32 v33, v122, v123
    v_cvt_pk_bf16_f32 v34, v124, v125
    v_cvt_pk_bf16_f32 v35, v126, v127
    v_cvt_pk_bf16_f32 v36, v128, v129
    v_cvt_pk_bf16_f32 v37, v130, v131
    v_cvt_pk_bf16_f32 v38, v132, v133
    v_cvt_pk_bf16_f32 v39, v134, v135
    v_cvt_pk_bf16_f32 v40, v136, v137
    v_cvt_pk_bf16_f32 v41, v138, v139
    v_cvt_pk_bf16_f32 v42, v140, v141
    v_cvt_pk_bf16_f32 v43, v142, v143
    v_cvt_pk_bf16_f32 v44, v144, v145
    v_cvt_pk_bf16_f32 v45, v146, v147
    v_cvt_pk_bf16_f32 v46, v148, v149
    v_cvt_pk_bf16_f32 v47, v150, v151
    v_cvt_pk_bf16_f32 v48, v152, v153
    v_cvt_pk_bf16_f32 v49, v154, v155
    v_mov_b32 v50, 0
    v_mov_b32 v51, 0
    s_waitcnt vmcnt(0)
    v_mfma_f32_16x16x32_bf16 v[60:63], v[160:163], v[16:19], 0
    v_mfma_f32_16x16x32_bf16 v[64:67], v[196:199], v[16:19], 0
    v_mfma_f32_16x16x32_bf16 v[60:63], v[164:167], v[20:23], v[60:63]
    v_mfma_f32_16x16x32_bf16 v[64:67], v[200:203], v[20:23], v[64:67]
    v_mfma_f32_16x16x32_bf16 v[60:63], v[168:171], v[24:27], v[60:63]
    v_mfma_f32_16x16x32_bf16 v[64:67], v[204:207], v[24:27], v[64:67]
    v_mfma_f32_16x16x32_bf16 v[60:63], v[172:175], v[28:31], v[60:63]
    v_mfma_f32_16x16x32_bf16 v[64:67], v[208:211], v[28:31], v[64:67]
    v_mfma_f32_16x16x32_bf16 v[60:63], v[176:179], v[32:35], v[60:63]
    v_mfma_f32_16x16x32_bf16 v[64:67], v[212:215], v[32:35], v[64:67]
    v_mfma_f32_16x16x32_bf16 v[60:63], v[180:183], v[36:39], v[60:63]
    v_mfma_f32_16x16x32_bf16 v[64:67], v[216:219], v[36:39], v[64:67]
    v_mfma_f32_16x16x32_bf16 v[60:63], v[184:187], v[40:43], v[60:63]
    v_mfma_f32_16x16x32_bf16 v[64:67], v[220:223], v[40:43], v[64:67]
    v_mfma_f32_16x16x32_bf16 v[60:63], v[188:191], v[44:47], v[60:63]
    v_mfma_f32_16x16x32_bf16 v[64:67], v[224:227], v[44:47], v[64:67]
    v_mfma_f32_16x16x32_bf16 v[60:63], v[192:195], v[48:51], v[60:63]
    v_mfma_f32_16x16x32_bf16 v[64:67], v[228:231], v[48:51], v[64:67]
    v_mul_u32_u24 v5, 1152, v3
    v_lshl_add_u32 v5, v4, 3, v5
    s_mul_i32 s22, s21, 36
    s_mul_i32 s23, s20, 18432
    s_add_u32 s22, s22, s23
    s_add_u32 s22, s22, 79691776
    s_nop 0
    v_cvt_pk_bf16_f32 v60, v60, v61
    v_cvt_pk_bf16_f32 v61, v62, v63
    v_cvt_pk_bf16_f32 v64, v64, v65
    buffer_store_dwordx2 v[60:61], v5, s[16:19], s22 offen sc1
    s_mov_b64 exec, 0xffff
    buffer_store_dword v64, v5, s[16:19], s22 offen offset:32 sc1
    s_mov_b64 exec, -1
    s_lshr_b32 s22, s20, 1
    s_lshl_b32 s23, s22, 7
    s_add_u32 s23, s23, 98578688
    s_waitcnt vmcnt(0)
    s_barrier
    s_cmp_lg_u32 s100, 0
    s_cbranch_scc1 Lsig_60
    v_mov_b32 v1, s23
    v_mov_b32 v2, 1
    s_mov_b64 exec, 1
    buffer_atomic_add v2, v1, s[16:19], 0 offen
    s_mov_b64 exec, -1
Lsig_60:
    s_branch Lnext_33
Lt_40:
    s_sub_u32 s4, s101, 2930
    s_mov_b32 s7, 165191050
    s_mul_hi_u32 s20, s4, s7
    s_mul_i32 s21, s20, 26
    s_sub_u32 s21, s4, s21
    s_cmp_ge_u32 s21, 8
    s_cbranch_scc1 Lfinal_43
    s_lshl_b32 s21, s21, 2
    s_add_u32 s21, s21, s100
    s_lshr_b32 s22, s20, 2
    s_lshl_b32 s22, s22, 7
    s_add_u32 s22, s22, 98566400
    s_add_u32 s23, s22, 2048
    s_lshl_b32 s24, s20, 7
    s_add_u32 s24, s24, 98570496
    s_mov_b32 s35, s24
    s_cmp_lg_u32 s100, 0
    s_cbranch_scc1 Lwd_62
    s_mov_b32 s6, 0
    v_mov_b32 v1, s22
    v_writelane_b32 v1, s23, 1
    s_mov_b64 exec, 3
    s_nop 0
Lw_61:
    buffer_load_dword v2, v1, s[16:19], 0 offen sc1
    s_waitcnt vmcnt(0)
    s_mov_b32 s7, 1
    v_readlane_b32 s4, v2, 0
    s_cmp_ge_u32 s4, 64
    s_cselect_b32 s7, s7, 0
    v_readlane_b32 s4, v2, 1
    s_cmp_ge_u32 s4, 46
    s_cselect_b32 s7, s7, 0
    s_cmp_eq_u32 s7, 1
    s_nop 1
    s_cbranch_scc1 Lwd_62
    s_sleep 16
    s_add_u32 s6, s6, 1
    s_cmp_lt_u32 s6, 131072
    s_cbranch_scc1 Lw_61
Lwd_62:
    s_mov_b64 exec, -1
    s_barrier
    s_mov_b32 s8, s64
    s_and_b32 s9, s65, 0xffff
    s_mov_b32 s10, 2359296
    s_mov_b32 s11, 0x00020000
    s_mov_b32 s12, s84
    s_and_b32 s13, s85, 0xffff
    s_mov_b32 s14, 1152
    s_mov_b32 s15, 0x00020000
    v_and_b32 v1, 63, v0
    v_lshlrev_b32 v2, 4, v1
    v_and_b32 v3, 15, v1
    v_lshrrev_b32 v4, 4, v1
    v_and_b32 v5, 7, v1
    v_lshl_add_u32 v5, v4, 3, v5
    v_lshlrev_b32 v5, 4, v5
    v_and_b32 v6, 31, v1
    v_lshlrev_b32 v6, 4, v6
    s_lshl_b32 s22, s20, 18
    s_lshl_b32 s23, s21, 12
    s_add_u32 s22, s22, s23
    s_add_u32 s24, s22, 0
    buffer_load_dwordx4 v[16:19], v2, s[16:19], s24 offen offset:0
    buffer_load_dwordx4 v[20:23], v2, s[16:19], s24 offen offset:1024
    buffer_load_dwordx4 v[24:27], v2, s[16:19], s24 offen offset:2048
    buffer_load_dwordx4 v[28:31], v2, s[16:19], s24 offen offset:3072
    s_add_u32 s24, s22, 131072
    buffer_load_dwordx4 v[32:35], v2, s[16:19], s24 offen offset:0
    buffer_load_dwordx4 v[36:39], v2, s[16:19], s24 offen offset:1024
    buffer_load_dwordx4 v[40:43], v2, s[16:19], s24 offen offset:2048
    buffer_load_dwordx4 v[44:47], v2, s[16:19], s24 offen offset:3072
    s_add_u32 s24, s22, 16777216
    buffer_load_dwordx4 v[48:51], v2, s[16:19], s24 offen offset:0
    buffer_load_dwordx4 v[52:55], v2, s[16:19], s24 offen offset:1024
    buffer_load_dwordx4 v[56:59], v2, s[16:19], s24 offen offset:2048
    buffer_load_dwordx4 v[60:63], v2, s[16:19], s24 offen offset:3072
    s_add_u32 s24, s22, 16908288
    buffer_load_dwordx4 v[64:67], v2, s[16:19], s24 offen offset:0
    buffer_load_dwordx4 v[68:71], v2, s[16:19], s24 offen offset:1024
    buffer_load_dwordx4 v[72:75], v2, s[16:19], s24 offen offset:2048
    buffer_load_dwordx4 v[76:79], v2, s[16:19], s24 offen offset:3072
    s_lshl_b32 s24, s20, 18
    s_lshl_b32 s26, s21, 13
    s_add_u32 s24, s24, s26
    s_add_u32 s24, s24, 33554432
    s_add_u32 s26, s24, 4096
    buffer_load_dwordx4 v[96:99], v2, s[16:19], s24 offen offset:0
    buffer_load_dwordx4 v[100:103], v2, s[16:19], s24 offen offset:1024
    buffer_load_dwordx4 v[104:107], v2, s[16:19], s24 offen offset:2048
    buffer_load_dwordx4 v[108:111], v2, s[16:19], s24 offen offset:3072
    buffer_load_dwordx4 v[112:115], v2, s[16:19], s26 offen offset:0
    buffer_load_dwordx4 v[116:119], v2, s[16:19], s26 offen offset:1024
    buffer_load_dwordx4 v[120:123], v2, s[16:19], s26 offen offset:2048
    buffer_load_dwordx4 v[124:127], v2, s[16:19], s26 offen offset:3072
    s_lshl_b32 s27, s20, 5
    s_add_u32 s27, s27, s21
    s_mul_i32 s28, s27, 1152
    buffer_load_dwordx4 v[200:203], v2, s[8:11], s28 offen
    buffer_load_dwordx4 v[204:207], v2, s[12:15], 0 offen
    v_mov_b32 v208, 0
    v_mov_b32 v209, 0
    v_mov_b32 v210, 0
    v_mov_b32 v211, 0
    v_mov_b32 v212, 0
    v_mov_b32 v213, 0
    v_mov_b32 v214, 0
    v_mov_b32 v215, 0
    s_mov_b64 exec, 0xff
    buffer_load_dwordx4 v[208:211], v2, s[8:11], s28 offen offset:1024
    buffer_load_dwordx4 v[212:215], v2, s[12:15], 0 offen offset:1024
    s_mov_b64 exec, -1
    v_mov_b32 v216, v1
    v_mov_b32 v217, v2
    s_cmp_lg_u32 s100, 0
    s_nop 0
    s_cbranch_scc1 Lwd_64
    s_mov_b32 s6, 0
    v_mov_b32 v1, s35
    s_mov_b64 exec, 1
    s_nop 0
Lw_63:
    buffer_load_dword v2, v1, s[16:19], 0 offen sc1
    s_waitcnt vmcnt(0)
    s_mov_b32 s7, 1
    v_readlane_b32 s4, v2, 0
    s_cmp_ge_u32 s4, 128
    s_cselect_b32 s7, s7, 0
    s_cmp_eq_u32 s7, 1
    s_nop 1
    s_cbranch_scc1 Lwd_64
    s_sleep 16
    s_add_u32 s6, s6, 1
    s_cmp_lt_u32 s6, 131072
    s_cbranch_scc1 Lw_63
Lwd_64:
    s_mov_b64 exec, -1
    s_barrier
    v_mov_b32 v1, v216
    v_mov_b32 v2, v217
    s_lshl_b32 s24, s20, 16
    s_lshl_b32 s26, s21, 11
    s_add_u32 s24, s24, s26
    s_add_u32 s26, s24, 83886080
    buffer_load_dwordx4 v[80:83], v5, s[16:19], s26 offen offset:0
    buffer_load_dwordx4 v[84:87], v5, s[16:19], s26 offen offset:512
    buffer_load_dwordx4 v[88:91], v5, s[16:19], s26 offen offset:1024
    buffer_load_dwordx4 v[92:95], v5, s[16:19], s26 offen offset:1536
    s_add_u32 s26, s24, 88080384
    buffer_load_dwordx4 v[128:131], v6, s[16:19], s26 offen offset:0
    buffer_load_dwordx4 v[132:135], v6, s[16:19], s26 offen offset:512
    buffer_load_dwordx4 v[136:139], v6, s[16:19], s26 offen offset:1024
    buffer_load_dwordx4 v[140:143], v6, s[16:19], s26 offen offset:1536
    s_waitcnt vmcnt(4)
    v_mfma_f32_16x16x32_bf16 v[144:147], v[48:51], v[16:19], 0
    v_mfma_f32_16x16x32_bf16 v[148:151], v[48:51], v[32:35], 0
    v_mfma_f32_16x16x32_bf16 v[152:155], v[64:67], v[32:35], 0
    v_mfma_f32_16x16x32_bf16 v[156:159], v[80:83], v[16:19], 0
    v_mfma_f32_16x16x32_bf16 v[160:163], v[80:83], v[32:35], 0
    v_mfma_f32_16x16x32_bf16 v[144:147], v[52:55], v[20:23], v[144:147]
    v_mfma_f32_16x16x32_bf16 v[148:151], v[52:55], v[36:39], v[148:151]
    v_mfma_f32_16x16x32_bf16 v[152:155], v[68:71], v[36:39], v[152:155]
    v_mfma_f32_16x16x32_bf16 v[156:159], v[84:87], v[20:23], v[156:159]
    v_mfma_f32_16x16x32_bf16 v[160:163], v[84:87], v[36:39], v[160:163]
    v_mfma_f32_16x16x32_bf16 v[144:147], v[56:59], v[24:27], v[144:147]
    v_mfma_f32_16x16x32_bf16 v[148:151], v[56:59], v[40:43], v[148:151]
    v_mfma_f32_16x16x32_bf16 v[152:155], v[72:75], v[40:43], v[152:155]
    v_mfma_f32_16x16x32_bf16 v[156:159], v[88:91], v[24:27], v[156:159]
    v_mfma_f32_16x16x32_bf16 v[160:163], v[88:91], v[40:43], v[160:163]
    v_mfma_f32_16x16x32_bf16 v[144:147], v[60:63], v[28:31], v[144:147]
    v_mfma_f32_16x16x32_bf16 v[148:151], v[60:63], v[44:47], v[148:151]
    v_mfma_f32_16x16x32_bf16 v[152:155], v[76:79], v[44:47], v[152:155]
    v_mfma_f32_16x16x32_bf16 v[156:159], v[92:95], v[28:31], v[156:159]
    v_mfma_f32_16x16x32_bf16 v[160:163], v[92:95], v[44:47], v[160:163]
    s_nop 3
    v_cvt_pk_bf16_f32 v7, v144, v145
    v_lshlrev_b32 v144, 16, v7
    v_and_b32 v145, 0xffff0000, v7
    v_cvt_pk_bf16_f32 v7, v146, v147
    v_lshlrev_b32 v146, 16, v7
    v_and_b32 v147, 0xffff0000, v7
    v_cvt_pk_bf16_f32 v7, v148, v149
    v_lshlrev_b32 v148, 16, v7
    v_and_b32 v149, 0xffff0000, v7
    v_cvt_pk_bf16_f32 v7, v150, v151
    v_lshlrev_b32 v150, 16, v7
    v_and_b32 v151, 0xffff0000, v7
    v_cvt_pk_bf16_f32 v7, v152, v153
    v_lshlrev_b32 v152, 16, v7
    v_and_b32 v153, 0xffff0000, v7
    v_cvt_pk_bf16_f32 v7, v154, v155
    v_lshlrev_b32 v154, 16, v7
    v_and_b32 v155, 0xffff0000, v7
    v_cvt_pk_bf16_f32 v7, v156, v157
    v_lshlrev_b32 v156, 16, v7
    v_and_b32 v157, 0xffff0000, v7
    v_cvt_pk_bf16_f32 v7, v158, v159
    v_lshlrev_b32 v158, 16, v7
    v_and_b32 v159, 0xffff0000, v7
    v_cvt_pk_bf16_f32 v7, v160, v161
    v_lshlrev_b32 v160, 16, v7
    v_and_b32 v161, 0xffff0000, v7
    v_cvt_pk_bf16_f32 v7, v162, v163
    v_lshlrev_b32 v162, 16, v7
    v_and_b32 v163, 0xffff0000, v7
    s_mov_b32 s30, 0x3db504f3
    v_mul_f32 v144, s30, v144
    v_mul_f32 v145, s30, v145
    v_mul_f32 v146, s30, v146
    v_mul_f32 v147, s30, v147
    v_mul_f32 v148, s30, v148
    v_mul_f32 v149, s30, v149
    v_mul_f32 v150, s30, v150
    v_mul_f32 v151, s30, v151
    v_mul_f32 v152, s30, v152
    v_mul_f32 v153, s30, v153
    v_mul_f32 v154, s30, v154
    v_mul_f32 v155, s30, v155
    v_mul_f32 v156, s30, v156
    v_mul_f32 v157, s30, v157
    v_mul_f32 v158, s30, v158
    v_mul_f32 v159, s30, v159
    v_mul_f32 v160, s30, v160
    v_mul_f32 v161, s30, v161
    v_mul_f32 v162, s30, v162
    v_mul_f32 v163, s30, v163
    v_cvt_pk_bf16_f32 v7, v144, v145
    v_lshlrev_b32 v144, 16, v7
    v_and_b32 v145, 0xffff0000, v7
    v_cvt_pk_bf16_f32 v7, v146, v147
    v_lshlrev_b32 v146, 16, v7
    v_and_b32 v147, 0xffff0000, v7
    v_cvt_pk_bf16_f32 v7, v148, v149
    v_lshlrev_b32 v148, 16, v7
    v_and_b32 v149, 0xffff0000, v7
    v_cvt_pk_bf16_f32 v7, v150, v151
    v_lshlrev_b32 v150, 16, v7
    v_and_b32 v151, 0xffff0000, v7
    v_cvt_pk_bf16_f32 v7, v152, v153
    v_lshlrev_b32 v152, 16, v7
    v_and_b32 v153, 0xffff0000, v7
    v_cvt_pk_bf16_f32 v7, v154, v155
    v_lshlrev_b32 v154, 16, v7
    v_and_b32 v155, 0xffff0000, v7
    v_cvt_pk_bf16_f32 v7, v156, v157
    v_lshlrev_b32 v156, 16, v7
    v_and_b32 v157, 0xffff0000, v7
    v_cvt_pk_bf16_f32 v7, v158, v159
    v_lshlrev_b32 v158, 16, v7
    v_and_b32 v159, 0xffff0000, v7
    v_cvt_pk_bf16_f32 v7, v160, v161
    v_lshlrev_b32 v160, 16, v7
    v_and_b32 v161, 0xffff0000, v7
    v_cvt_pk_bf16_f32 v7, v162, v163
    v_lshlrev_b32 v162, 16, v7
    v_and_b32 v163, 0xffff0000, v7
    v_mov_b32 v8, 0xf149f2ca
    v_lshlrev_b32 v9, 2, v4
    v_add_u32 v10, 0, v9
    v_cmp_le_u32 vcc, v10, v3
    s_nop 1
    v_cndmask_b32 v144, v8, v144, vcc
    v_cndmask_b32 v152, v8, v152, vcc
    v_add_u32 v10, 1, v9
    v_cmp_le_u32 vcc, v10, v3
    s_nop 1
    v_cndmask_b32 v145, v8, v145, vcc
    v_cndmask_b32 v153, v8, v153, vcc
    v_add_u32 v10, 2, v9
    v_cmp_le_u32 vcc, v10, v3
    s_nop 1
    v_cndmask_b32 v146, v8, v146, vcc
    v_cndmask_b32 v154, v8, v154, vcc
    v_add_u32 v10, 3, v9
    v_cmp_le_u32 vcc, v10, v3
    s_nop 1
    v_cndmask_b32 v147, v8, v147, vcc
    v_cndmask_b32 v155, v8, v155, vcc
    v_cmp_gt_u32 vcc, 2, v4
    s_nop 1
    v_cndmask_b32 v156, v8, v156, vcc
    v_cndmask_b32 v160, v8, v160, vcc
    v_cndmask_b32 v157, v8, v157, vcc
    v_cndmask_b32 v161, v8, v161, vcc
    v_cndmask_b32 v158, v8, v158, vcc
    v_cndmask_b32 v162, v8, v162, vcc
    v_cndmask_b32 v159, v8, v159, vcc
    v_cndmask_b32 v163, v8, v163, vcc
    s_mov_b32 s31, 0x3fb8aa3b
    v_max3_f32 v10, v144, v145, v146
    v_max3_f32 v10, v10, v147, v156
    v_max3_f32 v10, v10, v157, v158
    v_max_f32 v10, v10, v159
    v_mov_b32 v11, v10
    s_nop 1
    v_permlane16_swap_b32 v10, v11
    v_max_f32 v10, v10, v11
    v_mov_b32 v11, v10
    s_nop 1
    v_permlane32_swap_b32 v10, v11
    v_max_f32 v10, v10, v11
    v_sub_f32 v144, v144, v10
    v_sub_f32 v145, v145, v10
    v_sub_f32 v146, v146, v10
    v_sub_f32 v147, v147, v10
    v_sub_f32 v156, v156, v10
    v_sub_f32 v157, v157, v10
    v_sub_f32 v158, v158, v10
    v_sub_f32 v159, v159, v10
    v_mul_f32 v144, s31, v144
    v_mul_f32 v145, s31, v145
    v_mul_f32 v146, s31, v146
    v_mul_f32 v147, s31, v147
    v_mul_f32 v156, s31, v156
    v_mul_f32 v157, s31, v157
    v_mul_f32 v158, s31, v158
    v_mul_f32 v159, s31, v159
    v_exp_f32 v144, v144
    v_exp_f32 v145, v145
    v_exp_f32 v146, v146
    v_exp_f32 v147, v147
    v_exp_f32 v156, v156
    v_exp_f32 v157, v157
    v_exp_f32 v158, v158
    v_exp_f32 v159, v159
    v_add_f32 v10, v144, v145
    v_add_f32 v10, v10, v146
    v_add_f32 v10, v10, v147
    v_add_f32 v10, v10, v156
    v_add_f32 v10, v10, v157
    v_add_f32 v10, v10, v158
    v_add_f32 v10, v10, v159
    v_mov_b32 v11, v10
    s_nop 1
    v_permlane16_swap_b32 v10, v11
    v_add_f32 v10, v10, v11
    v_mov_b32 v11, v10
    s_nop 1
    v_permlane32_swap_b32 v10, v11
    v_add_f32 v10, v10, v11
    v_rcp_f32 v10, v10
    s_nop 0
    v_mul_f32 v144, v144, v10
    v_mul_f32 v145, v145, v10
    v_mul_f32 v146, v146, v10
    v_mul_f32 v147, v147, v10
    v_mul_f32 v156, v156, v10
    v_mul_f32 v157, v157, v10
    v_mul_f32 v158, v158, v10
    v_mul_f32 v159, v159, v10
    v_max3_f32 v12, v148, v149, v150
    v_max3_f32 v12, v12, v151, v152
    v_max3_f32 v12, v12, v153, v154
    v_max3_f32 v12, v12, v155, v160
    v_max3_f32 v12, v12, v161, v162
    v_max_f32 v12, v12, v163
    v_mov_b32 v13, v12
    s_nop 1
    v_permlane16_swap_b32 v12, v13
    v_max_f32 v12, v12, v13
    v_mov_b32 v13, v12
    s_nop 1
    v_permlane32_swap_b32 v12, v13
    v_max_f32 v12, v12, v13
    v_sub_f32 v148, v148, v12
    v_sub_f32 v149, v149, v12
    v_sub_f32 v150, v150, v12
    v_sub_f32 v151, v151, v12
    v_sub_f32 v152, v152, v12
    v_sub_f32 v153, v153, v12
    v_sub_f32 v154, v154, v12
    v_sub_f32 v155, v155, v12
    v_sub_f32 v160, v160, v12
    v_sub_f32 v161, v161, v12
    v_sub_f32 v162, v162, v12
    v_sub_f32 v163, v163, v12
    v_mul_f32 v148, s31, v148
    v_mul_f32 v149, s31, v149
    v_mul_f32 v150, s31, v150
    v_mul_f32 v151, s31, v151
    v_mul_f32 v152, s31, v152
    v_mul_f32 v153, s31, v153
    v_mul_f32 v154, s31, v154
    v_mul_f32 v155, s31, v155
    v_mul_f32 v160, s31, v160
    v_mul_f32 v161, s31, v161
    v_mul_f32 v162, s31, v162
    v_mul_f32 v163, s31, v163
    v_exp_f32 v148, v148
    v_exp_f32 v149, v149
    v_exp_f32 v150, v150
    v_exp_f32 v151, v151
    v_exp_f32 v152, v152
    v_exp_f32 v153, v153
    v_exp_f32 v154, v154
    v_exp_f32 v155, v155
    v_exp_f32 v160, v160
    v_exp_f32 v161, v161
    v_exp_f32 v162, v162
    v_exp_f32 v163, v163
    v_add_f32 v12, v148, v149
    v_add_f32 v12, v12, v150
    v_add_f32 v12, v12, v151
    v_add_f32 v12, v12, v152
    v_add_f32 v12, v12, v153
    v_add_f32 v12, v12, v154
    v_add_f32 v12, v12, v155
    v_add_f32 v12, v12, v160
    v_add_f32 v12, v12, v161
    v_add_f32 v12, v12, v162
    v_add_f32 v12, v12, v163
    v_mov_b32 v13, v12
    s_nop 1
    v_permlane16_swap_b32 v12, v13
    v_add_f32 v12, v12, v13
    v_mov_b32 v13, v12
    s_nop 1
    v_permlane32_swap_b32 v12, v13
    v_add_f32 v12, v12, v13
    v_rcp_f32 v12, v12
    s_nop 0
    v_mul_f32 v148, v148, v12
    v_mul_f32 v149, v149, v12
    v_mul_f32 v150, v150, v12
    v_mul_f32 v151, v151, v12
    v_mul_f32 v152, v152, v12
    v_mul_f32 v153, v153, v12
    v_mul_f32 v154, v154, v12
    v_mul_f32 v155, v155, v12
    v_mul_f32 v160, v160, v12
    v_mul_f32 v161, v161, v12
    v_mul_f32 v162, v162, v12
    v_mul_f32 v163, v163, v12
    v_cvt_pk_bf16_f32 v164, v144, v145
    v_cvt_pk_bf16_f32 v165, v146, v147
    v_mov_b32 v166, 0
    v_mov_b32 v167, 0
    v_cvt_pk_bf16_f32 v168, v156, v157
    v_cvt_pk_bf16_f32 v169, v158, v159
    v_cvt_pk_bf16_f32 v170, v160, v161
    v_cvt_pk_bf16_f32 v171, v162, v163
    v_cvt_pk_bf16_f32 v172, v148, v149
    v_cvt_pk_bf16_f32 v173, v150, v151
    v_cvt_pk_bf16_f32 v174, v152, v153
    v_cvt_pk_bf16_f32 v175, v154, v155
    s_waitcnt vmcnt(0)
    v_mfma_f32_16x16x32_bf16 v[16:19], v[96:99], v[164:167], 0
    v_mfma_f32_16x16x32_bf16 v[20:23], v[100:103], v[164:167], 0
    v_mfma_f32_16x16x32_bf16 v[24:27], v[104:107], v[164:167], 0
    v_mfma_f32_16x16x32_bf16 v[28:31], v[108:111], v[164:167], 0
    v_mfma_f32_16x16x32_bf16 v[32:35], v[112:115], v[164:167], 0
    v_mfma_f32_16x16x32_bf16 v[36:39], v[116:119], v[164:167], 0
    v_mfma_f32_16x16x32_bf16 v[40:43], v[120:123], v[164:167], 0
    v_mfma_f32_16x16x32_bf16 v[44:47], v[124:127], v[164:167], 0
    v_mfma_f32_16x16x16_bf16 v[16:19], v[128:129], v[168:169], v[16:19]
    v_mfma_f32_16x16x16_bf16 v[20:23], v[130:131], v[168:169], v[20:23]
    v_mfma_f32_16x16x16_bf16 v[24:27], v[132:133], v[168:169], v[24:27]
    v_mfma_f32_16x16x16_bf16 v[28:31], v[134:135], v[168:169], v[28:31]
    v_mfma_f32_16x16x16_bf16 v[32:35], v[136:137], v[168:169], v[32:35]
    v_mfma_f32_16x16x16_bf16 v[36:39], v[138:139], v[168:169], v[36:39]
    v_mfma_f32_16x16x16_bf16 v[40:43], v[140:141], v[168:169], v[40:43]
    v_mfma_f32_16x16x16_bf16 v[44:47], v[142:143], v[168:169], v[44:47]
    v_mfma_f32_16x16x32_bf16 v[48:51], v[96:99], v[172:175], 0
    v_mfma_f32_16x16x32_bf16 v[52:55], v[100:103], v[172:175], 0
    v_mfma_f32_16x16x32_bf16 v[56:59], v[104:107], v[172:175], 0
    v_mfma_f32_16x16x32_bf16 v[60:63], v[108:111], v[172:175], 0
    v_mfma_f32_16x16x32_bf16 v[64:67], v[112:115], v[172:175], 0
    v_mfma_f32_16x16x32_bf16 v[68:71], v[116:119], v[172:175], 0
    v_mfma_f32_16x16x32_bf16 v[72:75], v[120:123], v[172:175], 0
    v_mfma_f32_16x16x32_bf16 v[76:79], v[124:127], v[172:175], 0
    v_mfma_f32_16x16x16_bf16 v[48:51], v[128:129], v[170:171], v[48:51]
    v_mfma_f32_16x16x16_bf16 v[52:55], v[130:131], v[170:171], v[52:55]
    v_mfma_f32_16x16x16_bf16 v[56:59], v[132:133], v[170:171], v[56:59]
    v_mfma_f32_16x16x16_bf16 v[60:63], v[134:135], v[170:171], v[60:63]
    v_mfma_f32_16x16x16_bf16 v[64:67], v[136:137], v[170:171], v[64:67]
    v_mfma_f32_16x16x16_bf16 v[68:71], v[138:139], v[170:171], v[68:71]
    v_mfma_f32_16x16x16_bf16 v[72:75], v[140:141], v[170:171], v[72:75]
    v_mfma_f32_16x16x16_bf16 v[76:79], v[142:143], v[170:171], v[76:79]
    s_add_u32 s24, s22, 50331648
    v_cvt_pk_bf16_f32 v16, v16, v17
    v_cvt_pk_bf16_f32 v17, v18, v19
    v_cvt_pk_bf16_f32 v18, v20, v21
    v_cvt_pk_bf16_f32 v19, v22, v23
    buffer_store_dwordx4 v[16:19], v2, s[16:19], s24 offen offset:0 sc1
    v_cvt_pk_bf16_f32 v24, v24, v25
    v_cvt_pk_bf16_f32 v25, v26, v27
    v_cvt_pk_bf16_f32 v26, v28, v29
    v_cvt_pk_bf16_f32 v27, v30, v31
    buffer_store_dwordx4 v[24:27], v2, s[16:19], s24 offen offset:1024 sc1
    v_cvt_pk_bf16_f32 v32, v32, v33
    v_cvt_pk_bf16_f32 v33, v34, v35
    v_cvt_pk_bf16_f32 v34, v36, v37
    v_cvt_pk_bf16_f32 v35, v38, v39
    buffer_store_dwordx4 v[32:35], v2, s[16:19], s24 offen offset:2048 sc1
    v_cvt_pk_bf16_f32 v40, v40, v41
    v_cvt_pk_bf16_f32 v41, v42, v43
    v_cvt_pk_bf16_f32 v42, v44, v45
    v_cvt_pk_bf16_f32 v43, v46, v47
    buffer_store_dwordx4 v[40:43], v2, s[16:19], s24 offen offset:3072 sc1
    s_add_u32 s24, s22, 50462720
    v_cvt_pk_bf16_f32 v48, v48, v49
    v_cvt_pk_bf16_f32 v49, v50, v51
    v_cvt_pk_bf16_f32 v50, v52, v53
    v_cvt_pk_bf16_f32 v51, v54, v55
    buffer_store_dwordx4 v[48:51], v2, s[16:19], s24 offen offset:0 sc1
    v_cvt_pk_bf16_f32 v56, v56, v57
    v_cvt_pk_bf16_f32 v57, v58, v59
    v_cvt_pk_bf16_f32 v58, v60, v61
    v_cvt_pk_bf16_f32 v59, v62, v63
    buffer_store_dwordx4 v[56:59], v2, s[16:19], s24 offen offset:1024 sc1
    v_cvt_pk_bf16_f32 v64, v64, v65
    v_cvt_pk_bf16_f32 v65, v66, v67
    v_cvt_pk_bf16_f32 v66, v68, v69
    v_cvt_pk_bf16_f32 v67, v70, v71
    buffer_store_dwordx4 v[64:67], v2, s[16:19], s24 offen offset:2048 sc1
    v_cvt_pk_bf16_f32 v72, v72, v73
    v_cvt_pk_bf16_f32 v73, v74, v75
    v_cvt_pk_bf16_f32 v74, v76, v77
    v_cvt_pk_bf16_f32 v75, v78, v79
    buffer_store_dwordx4 v[72:75], v2, s[16:19], s24 offen offset:3072 sc1
    s_waitcnt vmcnt(8)
    v_mov_b32 v100, 0
    v_lshlrev_b32 v96, 16, v200
    v_and_b32 v97, 0xffff0000, v200
    v_lshlrev_b32 v98, 16, v204
    v_and_b32 v99, 0xffff0000, v204
    v_mul_f32 v96, v96, v98
    v_mul_f32 v97, v97, v99
    v_cvt_pk_bf16_f32 v98, v96, v97
    v_lshlrev_b32 v96, 16, v98
    v_and_b32 v97, 0xffff0000, v98
    v_add_f32 v100, v100, v96
    v_add_f32 v100, v100, v97
    v_lshlrev_b32 v96, 16, v201
    v_and_b32 v97, 0xffff0000, v201
    v_lshlrev_b32 v98, 16, v205
    v_and_b32 v99, 0xffff0000, v205
    v_mul_f32 v96, v96, v98
    v_mul_f32 v97, v97, v99
    v_cvt_pk_bf16_f32 v98, v96, v97
    v_lshlrev_b32 v96, 16, v98
    v_and_b32 v97, 0xffff0000, v98
    v_add_f32 v100, v100, v96
    v_add_f32 v100, v100, v97
    v_lshlrev_b32 v96, 16, v202
    v_and_b32 v97, 0xffff0000, v202
    v_lshlrev_b32 v98, 16, v206
    v_and_b32 v99, 0xffff0000, v206
    v_mul_f32 v96, v96, v98
    v_mul_f32 v97, v97, v99
    v_cvt_pk_bf16_f32 v98, v96, v97
    v_lshlrev_b32 v96, 16, v98
    v_and_b32 v97, 0xffff0000, v98
    v_add_f32 v100, v100, v96
    v_add_f32 v100, v100, v97
    v_lshlrev_b32 v96, 16, v203
    v_and_b32 v97, 0xffff0000, v203
    v_lshlrev_b32 v98, 16, v207
    v_and_b32 v99, 0xffff0000, v207
    v_mul_f32 v96, v96, v98
    v_mul_f32 v97, v97, v99
    v_cvt_pk_bf16_f32 v98, v96, v97
    v_lshlrev_b32 v96, 16, v98
    v_and_b32 v97, 0xffff0000, v98
    v_add_f32 v100, v100, v96
    v_add_f32 v100, v100, v97
    v_lshlrev_b32 v96, 16, v208
    v_and_b32 v97, 0xffff0000, v208
    v_lshlrev_b32 v98, 16, v212
    v_and_b32 v99, 0xffff0000, v212
    v_mul_f32 v96, v96, v98
    v_mul_f32 v97, v97, v99
    v_cvt_pk_bf16_f32 v98, v96, v97
    v_lshlrev_b32 v96, 16, v98
    v_and_b32 v97, 0xffff0000, v98
    v_add_f32 v100, v100, v96
    v_add_f32 v100, v100, v97
    v_lshlrev_b32 v96, 16, v209
    v_and_b32 v97, 0xffff0000, v209
    v_lshlrev_b32 v98, 16, v213
    v_and_b32 v99, 0xffff0000, v213
    v_mul_f32 v96, v96, v98
    v_mul_f32 v97, v97, v99
    v_cvt_pk_bf16_f32 v98, v96, v97
    v_lshlrev_b32 v96, 16, v98
    v_and_b32 v97, 0xffff0000, v98
    v_add_f32 v100, v100, v96
    v_add_f32 v100, v100, v97
    v_lshlrev_b32 v96, 16, v210
    v_and_b32 v97, 0xffff0000, v210
    v_lshlrev_b32 v98, 16, v214
    v_and_b32 v99, 0xffff0000, v214
    v_mul_f32 v96, v96, v98
    v_mul_f32 v97, v97, v99
    v_cvt_pk_bf16_f32 v98, v96, v97
    v_lshlrev_b32 v96, 16, v98
    v_and_b32 v97, 0xffff0000, v98
    v_add_f32 v100, v100, v96
    v_add_f32 v100, v100, v97
    v_lshlrev_b32 v96, 16, v211
    v_and_b32 v97, 0xffff0000, v211
    v_lshlrev_b32 v98, 16, v215
    v_and_b32 v99, 0xffff0000, v215
    v_mul_f32 v96, v96, v98
    v_mul_f32 v97, v97, v99
    v_cvt_pk_bf16_f32 v98, v96, v97
    v_lshlrev_b32 v96, 16, v98
    v_and_b32 v97, 0xffff0000, v98
    v_add_f32 v100, v100, v96
    v_add_f32 v100, v100, v97
    s_nop 1
    v_add_f32_dpp v100, v100, v100 quad_perm:[1,0,3,2] row_mask:0xf bank_mask:0xf
    s_nop 1
    v_add_f32_dpp v100, v100, v100 quad_perm:[2,3,0,1] row_mask:0xf bank_mask:0xf
    s_nop 1
    v_add_f32_dpp v100, v100, v100 row_half_mirror row_mask:0xf bank_mask:0xf
    s_nop 1
    v_add_f32_dpp v100, v100, v100 row_mirror row_mask:0xf bank_mask:0xf
    v_mov_b32 v101, v100
    s_nop 1
    v_permlane16_swap_b32 v100, v101
    v_add_f32 v100, v100, v101
    v_mov_b32 v101, v100
    s_nop 1
    v_permlane32_swap_b32 v100, v101
    v_add_f32 v100, v100, v101
    v_mov_b32 v101, v100
    v_cvt_pk_bf16_f32 v98, v100, v101
    v_lshlrev_b32 v100, 16, v98
    v_and_b32 v101, 0xffff0000, v98
    v_mul_f32 v100, 0xbfb8aa3b, v100
    v_exp_f32 v100, v100
    s_nop 0
    v_add_f32 v100, 1.0, v100
    v_rcp_f32 v100, v100
    s_nop 0
    v_mov_b32 v101, v100
    v_cvt_pk_bf16_f32 v98, v100, v101
    v_lshlrev_b32 v100, 16, v98
    v_and_b32 v101, 0xffff0000, v98
    s_lshl_b32 s27, s27, 2
    s_add_u32 s27, s27, 92274688
    v_mov_b32 v101, 0
    s_mov_b64 exec, 1
    buffer_store_dword v100, v101, s[16:19], s27 offen sc1
    s_mov_b64 exec, -1
    s_lshr_b32 s22, s20, 0
    s_lshl_b32 s23, s22, 7
    s_add_u32 s23, s23, 98578688
    s_waitcnt vmcnt(0)
    s_barrier
    s_cmp_lg_u32 s100, 0
    s_cbranch_scc1 Lsig_65
    v_mov_b32 v1, s23
    v_mov_b32 v2, 1
    s_mov_b64 exec, 1
    buffer_atomic_add v2, v1, s[16:19], 0 offen
    s_mov_b64 exec, -1
Lsig_65:
    s_branch Lnext_33
Lfinal_43:
    s_sub_u32 s21, s21, 8
    s_mov_b32 s24, 98566272
    s_cmp_lg_u32 s100, 0
    s_cbranch_scc1 Lwd_67
    s_mov_b32 s6, 0
    v_mov_b32 v1, s24
    s_mov_b64 exec, 1
    s_nop 0
Lw_66:
    buffer_load_dword v2, v1, s[16:19], 0 offen sc1
    s_waitcnt vmcnt(0)
    s_mov_b32 s7, 1
    v_readlane_b32 s4, v2, 0
    s_cmp_ge_u32 s4, 146
    s_cselect_b32 s7, s7, 0
    s_cmp_eq_u32 s7, 1
    s_nop 1
    s_cbranch_scc1 Lwd_67
    s_sleep 16
    s_add_u32 s6, s6, 1
    s_cmp_lt_u32 s6, 131072
    s_cbranch_scc1 Lw_66
Lwd_67:
    s_mov_b64 exec, -1
    s_barrier
    s_mov_b32 s8, s86
    s_and_b32 s9, s87, 0xffff
    s_mov_b32 s10, 2359296
    s_mov_b32 s11, 0x00020000
    v_and_b32 v1, 63, v0
    v_lshlrev_b32 v2, 4, v1
    v_and_b32 v3, 15, v1
    v_lshrrev_b32 v4, 4, v1
    v_mul_u32_u24 v5, 1152, v3
    v_lshl_add_u32 v5, v4, 4, v5
    s_mul_i32 s26, s100, 36864
    s_mul_i32 s27, s21, 2048
    s_add_u32 s26, s26, s27
    s_add_u32 s26, s26, 100663296
    v_accvgpr_write_b32 a0, 0
    v_accvgpr_write_b32 a1, 0
    v_accvgpr_write_b32 a2, 0
    v_accvgpr_write_b32 a3, 0
    v_accvgpr_write_b32 a4, 0
    v_accvgpr_write_b32 a5, 0
    v_accvgpr_write_b32 a6, 0
    v_accvgpr_write_b32 a7, 0
    v_accvgpr_write_b32 a8, 0
    v_accvgpr_write_b32 a9, 0
    v_accvgpr_write_b32 a10, 0
    v_accvgpr_write_b32 a11, 0
    v_accvgpr_write_b32 a12, 0
    v_accvgpr_write_b32 a13, 0
    v_accvgpr_write_b32 a14, 0
    v_accvgpr_write_b32 a15, 0
    v_accvgpr_write_b32 a16, 0
    v_accvgpr_write_b32 a17, 0
    v_accvgpr_write_b32 a18, 0
    v_accvgpr_write_b32 a19, 0
    v_accvgpr_write_b32 a20, 0
    v_accvgpr_write_b32 a21, 0
    v_accvgpr_write_b32 a22, 0
    v_accvgpr_write_b32 a23, 0
    v_accvgpr_write_b32 a24, 0
    v_accvgpr_write_b32 a25, 0
    v_accvgpr_write_b32 a26, 0
    v_accvgpr_write_b32 a27, 0
    v_accvgpr_write_b32 a28, 0
    v_accvgpr_write_b32 a29, 0
    v_accvgpr_write_b32 a30, 0
    v_accvgpr_write_b32 a31, 0
    buffer_load_dwordx4 a[32:35], v2, s[16:19], s26 offen offset:0
    buffer_load_dwordx4 a[36:39], v2, s[16:19], s26 offen offset:1024
    s_add_u32 s26, s26, 147456
    buffer_load_dwordx4 a[40:43], v2, s[16:19], s26 offen offset:0
    buffer_load_dwordx4 a[44:47], v2, s[16:19], s26 offen offset:1024
    s_add_u32 s26, s26, 147456
    buffer_load_dwordx4 a[48:51], v2, s[16:19], s26 offen offset:0
    buffer_load_dwordx4 a[52:55], v2, s[16:19], s26 offen offset:1024
    s_add_u32 s26, s26, 147456
    buffer_load_dwordx4 a[56:59], v2, s[16:19], s26 offen offset:0
    buffer_load_dwordx4 a[60:63], v2, s[16:19], s26 offen offset:1024
    s_add_u32 s26, s26, 147456
    buffer_load_dwordx4 a[64:67], v2, s[16:19], s26 offen offset:0
    buffer_load_dwordx4 a[68:71], v2, s[16:19], s26 offen offset:1024
    s_add_u32 s26, s26, 147456
    buffer_load_dwordx4 a[72:75], v2, s[16:19], s26 offen offset:0
    buffer_load_dwordx4 a[76:79], v2, s[16:19], s26 offen offset:1024
    s_add_u32 s26, s26, 147456
    buffer_load_dwordx4 a[80:83], v2, s[16:19], s26 offen offset:0
    buffer_load_dwordx4 a[84:87], v2, s[16:19], s26 offen offset:1024
    s_add_u32 s26, s26, 147456
    buffer_load_dwordx4 a[88:91], v2, s[16:19], s26 offen offset:0
    buffer_load_dwordx4 a[92:95], v2, s[16:19], s26 offen offset:1024
    s_add_u32 s26, s26, 147456
    buffer_load_dwordx4 a[96:99], v2, s[16:19], s26 offen offset:0
    buffer_load_dwordx4 a[100:103], v2, s[16:19], s26 offen offset:1024
    s_add_u32 s26, s26, 147456
    buffer_load_dwordx4 a[104:107], v2, s[16:19], s26 offen offset:0
    buffer_load_dwordx4 a[108:111], v2, s[16:19], s26 offen offset:1024
    s_add_u32 s26, s26, 147456
    buffer_load_dwordx4 a[112:115], v2, s[16:19], s26 offen offset:0
    buffer_load_dwordx4 a[116:119], v2, s[16:19], s26 offen offset:1024
    s_add_u32 s26, s26, 147456
    buffer_load_dwordx4 a[120:123], v2, s[16:19], s26 offen offset:0
    buffer_load_dwordx4 a[124:127], v2, s[16:19], s26 offen offset:1024
    s_add_u32 s26, s26, 147456
    buffer_load_dwordx4 a[128:131], v2, s[16:19], s26 offen offset:0
    buffer_load_dwordx4 a[132:135], v2, s[16:19], s26 offen offset:1024
    s_add_u32 s26, s26, 147456
    buffer_load_dwordx4 a[136:139], v2, s[16:19], s26 offen offset:0
    buffer_load_dwordx4 a[140:143], v2, s[16:19], s26 offen offset:1024
    s_add_u32 s26, s26, 147456
    buffer_load_dwordx4 a[144:147], v2, s[16:19], s26 offen offset:0
    buffer_load_dwordx4 a[148:151], v2, s[16:19], s26 offen offset:1024
    s_add_u32 s26, s26, 147456
    buffer_load_dwordx4 a[152:155], v2, s[16:19], s26 offen offset:0
    buffer_load_dwordx4 a[156:159], v2, s[16:19], s26 offen offset:1024
    s_add_u32 s26, s26, 147456
    buffer_load_dwordx4 a[160:163], v2, s[16:19], s26 offen offset:0
    buffer_load_dwordx4 a[164:167], v2, s[16:19], s26 offen offset:1024
    s_add_u32 s26, s26, 147456
    buffer_load_dwordx4 a[168:171], v2, s[16:19], s26 offen offset:0
    buffer_load_dwordx4 a[172:175], v2, s[16:19], s26 offen offset:1024
    s_add_u32 s26, s26, 147456
    buffer_load_dwordx4 a[176:179], v2, s[16:19], s26 offen offset:0
    buffer_load_dwordx4 a[180:183], v2, s[16:19], s26 offen offset:1024
    s_add_u32 s26, s26, 147456
    buffer_load_dwordx4 a[184:187], v2, s[16:19], s26 offen offset:0
    buffer_load_dwordx4 a[188:191], v2, s[16:19], s26 offen offset:1024
    s_add_u32 s26, s26, 147456
    buffer_load_dwordx4 a[192:195], v2, s[16:19], s26 offen offset:0
    buffer_load_dwordx4 a[196:199], v2, s[16:19], s26 offen offset:1024
    s_add_u32 s26, s26, 147456
    buffer_load_dwordx4 a[200:203], v2, s[16:19], s26 offen offset:0
    buffer_load_dwordx4 a[204:207], v2, s[16:19], s26 offen offset:1024
    s_add_u32 s26, s26, 147456
    buffer_load_dwordx4 a[208:211], v2, s[16:19], s26 offen offset:0
    buffer_load_dwordx4 a[212:215], v2, s[16:19], s26 offen offset:1024
    s_add_u32 s26, s26, 147456
    buffer_load_dwordx4 a[216:219], v2, s[16:19], s26 offen offset:0
    buffer_load_dwordx4 a[220:223], v2, s[16:19], s26 offen offset:1024
    s_add_u32 s26, s26, 147456
    buffer_load_dwordx4 a[224:227], v2, s[16:19], s26 offen offset:0
    buffer_load_dwordx4 a[228:231], v2, s[16:19], s26 offen offset:1024
    s_add_u32 s26, s26, 147456
    buffer_load_dwordx4 a[232:235], v2, s[16:19], s26 offen offset:0
    buffer_load_dwordx4 a[236:239], v2, s[16:19], s26 offen offset:1024
    s_add_u32 s26, s26, 147456
    buffer_load_dwordx4 a[240:243], v2, s[16:19], s26 offen offset:0
    buffer_load_dwordx4 a[244:247], v2, s[16:19], s26 offen offset:1024
    s_add_u32 s26, s26, 147456
    buffer_load_dwordx4 a[248:251], v2, s[16:19], s26 offen offset:0
    buffer_load_dwordx4 a[252:255], v2, s[16:19], s26 offen offset:1024
    s_add_u32 s26, s26, 147456
    buffer_load_dwordx4 v[184:187], v2, s[16:19], s26 offen offset:0
    buffer_load_dwordx4 v[188:191], v2, s[16:19], s26 offen offset:1024
    s_add_u32 s26, s26, 147456
    buffer_load_dwordx4 v[192:195], v2, s[16:19], s26 offen offset:0
    buffer_load_dwordx4 v[196:199], v2, s[16:19], s26 offen offset:1024
    s_add_u32 s26, s26, 147456
    buffer_load_dwordx4 v[200:203], v2, s[16:19], s26 offen offset:0
    buffer_load_dwordx4 v[204:207], v2, s[16:19], s26 offen offset:1024
    s_add_u32 s26, s26, 147456
    buffer_load_dwordx4 v[208:211], v2, s[16:19], s26 offen offset:0
    buffer_load_dwordx4 v[212:215], v2, s[16:19], s26 offen offset:1024
    s_add_u32 s26, s26, 147456
    buffer_load_dwordx4 v[216:219], v2, s[16:19], s26 offen offset:0
    buffer_load_dwordx4 v[220:223], v2, s[16:19], s26 offen offset:1024
    s_add_u32 s26, s26, 147456
    buffer_load_dwordx4 v[224:227], v2, s[16:19], s26 offen offset:0
    buffer_load_dwordx4 v[228:231], v2, s[16:19], s26 offen offset:1024
    s_add_u32 s26, s26, 147456
    buffer_load_dwordx4 v[232:235], v2, s[16:19], s26 offen offset:0
    buffer_load_dwordx4 v[236:239], v2, s[16:19], s26 offen offset:1024
    s_add_u32 s26, s26, 147456
    buffer_load_dwordx4 v[240:243], v2, s[16:19], s26 offen offset:0
    buffer_load_dwordx4 v[244:247], v2, s[16:19], s26 offen offset:1024
    s_add_u32 s26, s26, 147456
    buffer_load_dwordx4 v[248:251], v2, s[16:19], s26 offen offset:0
    buffer_load_dwordx4 v[252:255], v2, s[16:19], s26 offen offset:1024
    s_add_u32 s26, s26, 147456
    v_mov_b32 v12, v1
    v_mov_b32 v13, v2
    s_lshl_b32 s22, s20, 7
    s_add_u32 s22, s22, 98578688
    s_cmp_lg_u32 s100, 0
    s_cbranch_scc1 Lwd_69
    s_mov_b32 s6, 0
    v_mov_b32 v1, s22
    s_mov_b64 exec, 1
    s_nop 0
Lw_68:
    buffer_load_dword v2, v1, s[16:19], 0 offen sc1
    s_waitcnt vmcnt(0)
    s_mov_b32 s7, 1
    v_readlane_b32 s4, v2, 0
    s_cmp_ge_u32 s4, 24
    s_cselect_b32 s7, s7, 0
    s_cmp_eq_u32 s7, 1
    s_nop 1
    s_cbranch_scc1 Lwd_69
    s_sleep 16
    s_add_u32 s6, s6, 1
    s_cmp_lt_u32 s6, 131072
    s_cbranch_scc1 Lw_68
Lwd_69:
    s_mov_b64 exec, -1
    s_barrier
    v_mov_b32 v1, v12
    v_mov_b32 v2, v13
    s_lshl_b32 s24, s20, 18
    s_lshl_b32 s25, s100, 10
    s_add_u32 s24, s24, s25
    s_add_u32 s24, s24, 50331648
    s_add_u32 s25, s24, 131072
    buffer_load_dwordx4 v[16:19], v2, s[16:19], s24 offen
    buffer_load_dwordx4 v[20:23], v2, s[16:19], s25 offen
    s_add_u32 s24, s24, 4096
    s_add_u32 s25, s25, 4096
    buffer_load_dwordx4 v[24:27], v2, s[16:19], s24 offen
    buffer_load_dwordx4 v[28:31], v2, s[16:19], s25 offen
    s_add_u32 s24, s24, 4096
    s_add_u32 s25, s25, 4096
    buffer_load_dwordx4 v[32:35], v2, s[16:19], s24 offen
    buffer_load_dwordx4 v[36:39], v2, s[16:19], s25 offen
    s_add_u32 s24, s24, 4096
    s_add_u32 s25, s25, 4096
    buffer_load_dwordx4 v[40:43], v2, s[16:19], s24 offen
    buffer_load_dwordx4 v[44:47], v2, s[16:19], s25 offen
    s_add_u32 s24, s24, 4096
    s_add_u32 s25, s25, 4096
    buffer_load_dwordx4 v[48:51], v2, s[16:19], s24 offen
    buffer_load_dwordx4 v[52:55], v2, s[16:19], s25 offen
    s_add_u32 s24, s24, 4096
    s_add_u32 s25, s25, 4096
    buffer_load_dwordx4 v[56:59], v2, s[16:19], s24 offen
    buffer_load_dwordx4 v[60:63], v2, s[16:19], s25 offen
    s_add_u32 s24, s24, 4096
    s_add_u32 s25, s25, 4096
    buffer_load_dwordx4 v[64:67], v2, s[16:19], s24 offen
    buffer_load_dwordx4 v[68:71], v2, s[16:19], s25 offen
    s_add_u32 s24, s24, 4096
    s_add_u32 s25, s25, 4096
    buffer_load_dwordx4 v[72:75], v2, s[16:19], s24 offen
    buffer_load_dwordx4 v[76:79], v2, s[16:19], s25 offen
    s_add_u32 s24, s24, 4096
    s_add_u32 s25, s25, 4096
    buffer_load_dwordx4 v[80:83], v2, s[16:19], s24 offen
    buffer_load_dwordx4 v[84:87], v2, s[16:19], s25 offen
    s_add_u32 s24, s24, 4096
    s_add_u32 s25, s25, 4096
    buffer_load_dwordx4 v[88:91], v2, s[16:19], s24 offen
    buffer_load_dwordx4 v[92:95], v2, s[16:19], s25 offen
    s_add_u32 s24, s24, 4096
    s_add_u32 s25, s25, 4096
    buffer_load_dwordx4 v[96:99], v2, s[16:19], s24 offen
    buffer_load_dwordx4 v[100:103], v2, s[16:19], s25 offen
    s_add_u32 s24, s24, 4096
    s_add_u32 s25, s25, 4096
    buffer_load_dwordx4 v[104:107], v2, s[16:19], s24 offen
    buffer_load_dwordx4 v[108:111], v2, s[16:19], s25 offen
    s_add_u32 s24, s24, 4096
    s_add_u32 s25, s25, 4096
    buffer_load_dwordx4 v[112:115], v2, s[16:19], s24 offen
    buffer_load_dwordx4 v[116:119], v2, s[16:19], s25 offen
    s_add_u32 s24, s24, 4096
    s_add_u32 s25, s25, 4096
    buffer_load_dwordx4 v[120:123], v2, s[16:19], s24 offen
    buffer_load_dwordx4 v[124:127], v2, s[16:19], s25 offen
    s_add_u32 s24, s24, 4096
    s_add_u32 s25, s25, 4096
    buffer_load_dwordx4 v[128:131], v2, s[16:19], s24 offen
    buffer_load_dwordx4 v[132:135], v2, s[16:19], s25 offen
    s_add_u32 s24, s24, 4096
    s_add_u32 s25, s25, 4096
    buffer_load_dwordx4 v[136:139], v2, s[16:19], s24 offen
    buffer_load_dwordx4 v[140:143], v2, s[16:19], s25 offen
    s_add_u32 s24, s24, 4096
    s_add_u32 s25, s25, 4096
    buffer_load_dwordx4 v[144:147], v2, s[16:19], s24 offen
    buffer_load_dwordx4 v[148:151], v2, s[16:19], s25 offen
    s_add_u32 s24, s24, 4096
    s_add_u32 s25, s25, 4096
    buffer_load_dwordx4 v[152:155], v2, s[16:19], s24 offen
    buffer_load_dwordx4 v[156:159], v2, s[16:19], s25 offen
    s_add_u32 s24, s24, 4096
    s_add_u32 s25, s25, 4096
    buffer_load_dwordx4 v[160:163], v2, s[16:19], s24 offen
    buffer_load_dwordx4 v[164:167], v2, s[16:19], s25 offen
    s_add_u32 s24, s24, 4096
    s_add_u32 s25, s25, 4096
    buffer_load_dwordx4 v[168:171], v2, s[16:19], s24 offen
    buffer_load_dwordx4 v[172:175], v2, s[16:19], s25 offen
    s_add_u32 s24, s24, 4096
    s_add_u32 s25, s25, 4096
    buffer_load_dwordx4 v[176:179], v2, s[16:19], s24 offen
    buffer_load_dwordx4 v[180:183], v2, s[16:19], s25 offen
    s_add_u32 s24, s24, 4096
    s_add_u32 s25, s25, 4096
    s_waitcnt vmcnt(40)
    v_mfma_f32_16x16x32_bf16 a[0:3], a[32:35], v[16:19], a[0:3]
    v_mfma_f32_16x16x32_bf16 a[4:7], a[36:39], v[16:19], a[4:7]
    v_mfma_f32_16x16x32_bf16 a[8:11], a[32:35], v[20:23], a[8:11]
    v_mfma_f32_16x16x32_bf16 a[12:15], a[36:39], v[20:23], a[12:15]
    buffer_load_dwordx4 v[16:19], v2, s[16:19], s24 offen
    buffer_load_dwordx4 v[20:23], v2, s[16:19], s25 offen
    s_add_u32 s24, s24, 4096
    s_add_u32 s25, s25, 4096
    s_waitcnt vmcnt(40)
    v_mfma_f32_16x16x32_bf16 a[0:3], a[40:43], v[24:27], a[0:3]
    v_mfma_f32_16x16x32_bf16 a[4:7], a[44:47], v[24:27], a[4:7]
    v_mfma_f32_16x16x32_bf16 a[8:11], a[40:43], v[28:31], a[8:11]
    v_mfma_f32_16x16x32_bf16 a[12:15], a[44:47], v[28:31], a[12:15]
    buffer_load_dwordx4 v[24:27], v2, s[16:19], s24 offen
    buffer_load_dwordx4 v[28:31], v2, s[16:19], s25 offen
    s_add_u32 s24, s24, 4096
    s_add_u32 s25, s25, 4096
    s_waitcnt vmcnt(40)
    v_mfma_f32_16x16x32_bf16 a[0:3], a[48:51], v[32:35], a[0:3]
    v_mfma_f32_16x16x32_bf16 a[4:7], a[52:55], v[32:35], a[4:7]
    v_mfma_f32_16x16x32_bf16 a[8:11], a[48:51], v[36:39], a[8:11]
    v_mfma_f32_16x16x32_bf16 a[12:15], a[52:55], v[36:39], a[12:15]
    buffer_load_dwordx4 v[32:35], v2, s[16:19], s24 offen
    buffer_load_dwordx4 v[36:39], v2, s[16:19], s25 offen
    s_add_u32 s24, s24, 4096
    s_add_u32 s25, s25, 4096
    s_waitcnt vmcnt(40)
    v_mfma_f32_16x16x32_bf16 a[0:3], a[56:59], v[40:43], a[0:3]
    v_mfma_f32_16x16x32_bf16 a[4:7], a[60:63], v[40:43], a[4:7]
    v_mfma_f32_16x16x32_bf16 a[8:11], a[56:59], v[44:47], a[8:11]
    v_mfma_f32_16x16x32_bf16 a[12:15], a[60:63], v[44:47], a[12:15]
    buffer_load_dwordx4 v[40:43], v2, s[16:19], s24 offen
    buffer_load_dwordx4 v[44:47], v2, s[16:19], s25 offen
    s_add_u32 s24, s24, 4096
    s_add_u32 s25, s25, 4096
    s_waitcnt vmcnt(40)
    v_mfma_f32_16x16x32_bf16 a[0:3], a[64:67], v[48:51], a[0:3]
    v_mfma_f32_16x16x32_bf16 a[4:7], a[68:71], v[48:51], a[4:7]
    v_mfma_f32_16x16x32_bf16 a[8:11], a[64:67], v[52:55], a[8:11]
    v_mfma_f32_16x16x32_bf16 a[12:15], a[68:71], v[52:55], a[12:15]
    buffer_load_dwordx4 v[48:51], v2, s[16:19], s24 offen
    buffer_load_dwordx4 v[52:55], v2, s[16:19], s25 offen
    s_add_u32 s24, s24, 4096
    s_add_u32 s25, s25, 4096
    s_waitcnt vmcnt(40)
    v_mfma_f32_16x16x32_bf16 a[0:3], a[72:75], v[56:59], a[0:3]
    v_mfma_f32_16x16x32_bf16 a[4:7], a[76:79], v[56:59], a[4:7]
    v_mfma_f32_16x16x32_bf16 a[8:11], a[72:75], v[60:63], a[8:11]
    v_mfma_f32_16x16x32_bf16 a[12:15], a[76:79], v[60:63], a[12:15]
    buffer_load_dwordx4 v[56:59], v2, s[16:19], s24 offen
    buffer_load_dwordx4 v[60:63], v2, s[16:19], s25 offen
    s_add_u32 s24, s24, 4096
    s_add_u32 s25, s25, 4096
    s_waitcnt vmcnt(40)
    v_mfma_f32_16x16x32_bf16 a[0:3], a[80:83], v[64:67], a[0:3]
    v_mfma_f32_16x16x32_bf16 a[4:7], a[84:87], v[64:67], a[4:7]
    v_mfma_f32_16x16x32_bf16 a[8:11], a[80:83], v[68:71], a[8:11]
    v_mfma_f32_16x16x32_bf16 a[12:15], a[84:87], v[68:71], a[12:15]
    buffer_load_dwordx4 v[64:67], v2, s[16:19], s24 offen
    buffer_load_dwordx4 v[68:71], v2, s[16:19], s25 offen
    s_add_u32 s24, s24, 4096
    s_add_u32 s25, s25, 4096
    s_waitcnt vmcnt(40)
    v_mfma_f32_16x16x32_bf16 a[0:3], a[88:91], v[72:75], a[0:3]
    v_mfma_f32_16x16x32_bf16 a[4:7], a[92:95], v[72:75], a[4:7]
    v_mfma_f32_16x16x32_bf16 a[8:11], a[88:91], v[76:79], a[8:11]
    v_mfma_f32_16x16x32_bf16 a[12:15], a[92:95], v[76:79], a[12:15]
    buffer_load_dwordx4 v[72:75], v2, s[16:19], s24 offen
    buffer_load_dwordx4 v[76:79], v2, s[16:19], s25 offen
    s_add_u32 s24, s24, 4096
    s_add_u32 s25, s25, 4096
    s_waitcnt vmcnt(40)
    v_mfma_f32_16x16x32_bf16 a[0:3], a[96:99], v[80:83], a[0:3]
    v_mfma_f32_16x16x32_bf16 a[4:7], a[100:103], v[80:83], a[4:7]
    v_mfma_f32_16x16x32_bf16 a[8:11], a[96:99], v[84:87], a[8:11]
    v_mfma_f32_16x16x32_bf16 a[12:15], a[100:103], v[84:87], a[12:15]
    buffer_load_dwordx4 v[80:83], v2, s[16:19], s24 offen
    buffer_load_dwordx4 v[84:87], v2, s[16:19], s25 offen
    s_add_u32 s24, s24, 4096
    s_add_u32 s25, s25, 4096
    s_waitcnt vmcnt(40)
    v_mfma_f32_16x16x32_bf16 a[0:3], a[104:107], v[88:91], a[0:3]
    v_mfma_f32_16x16x32_bf16 a[4:7], a[108:111], v[88:91], a[4:7]
    v_mfma_f32_16x16x32_bf16 a[8:11], a[104:107], v[92:95], a[8:11]
    v_mfma_f32_16x16x32_bf16 a[12:15], a[108:111], v[92:95], a[12:15]
    buffer_load_dwordx4 v[88:91], v2, s[16:19], s24 offen
    buffer_load_dwordx4 v[92:95], v2, s[16:19], s25 offen
    s_add_u32 s24, s24, 4096
    s_add_u32 s25, s25, 4096
    s_waitcnt vmcnt(40)
    v_mfma_f32_16x16x32_bf16 a[0:3], a[112:115], v[96:99], a[0:3]
    v_mfma_f32_16x16x32_bf16 a[4:7], a[116:119], v[96:99], a[4:7]
    v_mfma_f32_16x16x32_bf16 a[8:11], a[112:115], v[100:103], a[8:11]
    v_mfma_f32_16x16x32_bf16 a[12:15], a[116:119], v[100:103], a[12:15]
    buffer_load_dwordx4 v[96:99], v2, s[16:19], s24 offen
    buffer_load_dwordx4 v[100:103], v2, s[16:19], s25 offen
    s_add_u32 s24, s24, 4096
    s_add_u32 s25, s25, 4096
    s_waitcnt vmcnt(40)
    v_mfma_f32_16x16x32_bf16 a[0:3], a[120:123], v[104:107], a[0:3]
    v_mfma_f32_16x16x32_bf16 a[4:7], a[124:127], v[104:107], a[4:7]
    v_mfma_f32_16x16x32_bf16 a[8:11], a[120:123], v[108:111], a[8:11]
    v_mfma_f32_16x16x32_bf16 a[12:15], a[124:127], v[108:111], a[12:15]
    s_mul_i32 s24, s20, 36864
    s_lshl_b32 s25, s100, 6
    s_add_u32 s24, s24, s25
    s_add_u32 s24, s24, 79691776
    s_add_u32 s25, s24, 18432
    buffer_load_dwordx4 v[104:107], v5, s[16:19], s24 offen
    buffer_load_dwordx4 v[108:111], v5, s[16:19], s25 offen
    s_add_u32 s24, s24, 256
    s_add_u32 s25, s25, 256
    s_waitcnt vmcnt(40)
    v_mfma_f32_16x16x32_bf16 a[0:3], a[128:131], v[112:115], a[0:3]
    v_mfma_f32_16x16x32_bf16 a[4:7], a[132:135], v[112:115], a[4:7]
    v_mfma_f32_16x16x32_bf16 a[8:11], a[128:131], v[116:119], a[8:11]
    v_mfma_f32_16x16x32_bf16 a[12:15], a[132:135], v[116:119], a[12:15]
    buffer_load_dwordx4 v[112:115], v5, s[16:19], s24 offen
    buffer_load_dwordx4 v[116:119], v5, s[16:19], s25 offen
    s_add_u32 s24, s24, 256
    s_add_u32 s25, s25, 256
    s_waitcnt vmcnt(40)
    v_mfma_f32_16x16x32_bf16 a[0:3], a[136:139], v[120:123], a[0:3]
    v_mfma_f32_16x16x32_bf16 a[4:7], a[140:143], v[120:123], a[4:7]
    v_mfma_f32_16x16x32_bf16 a[8:11], a[136:139], v[124:127], a[8:11]
    v_mfma_f32_16x16x32_bf16 a[12:15], a[140:143], v[124:127], a[12:15]
    buffer_load_dwordx4 v[120:123], v5, s[16:19], s24 offen
    buffer_load_dwordx4 v[124:127], v5, s[16:19], s25 offen
    s_add_u32 s24, s24, 256
    s_add_u32 s25, s25, 256
    s_waitcnt vmcnt(40)
    v_mfma_f32_16x16x32_bf16 a[0:3], a[144:147], v[128:131], a[0:3]
    v_mfma_f32_16x16x32_bf16 a[4:7], a[148:151], v[128:131], a[4:7]
    v_mfma_f32_16x16x32_bf16 a[8:11], a[144:147], v[132:135], a[8:11]
    v_mfma_f32_16x16x32_bf16 a[12:15], a[148:151], v[132:135], a[12:15]
    buffer_load_dwordx4 v[128:131], v5, s[16:19], s24 offen
    buffer_load_dwordx4 v[132:135], v5, s[16:19], s25 offen
    s_add_u32 s24, s24, 256
    s_add_u32 s25, s25, 256
    s_waitcnt vmcnt(40)
    v_mfma_f32_16x16x32_bf16 a[0:3], a[152:155], v[136:139], a[0:3]
    v_mfma_f32_16x16x32_bf16 a[4:7], a[156:159], v[136:139], a[4:7]
    v_mfma_f32_16x16x32_bf16 a[8:11], a[152:155], v[140:143], a[8:11]
    v_mfma_f32_16x16x32_bf16 a[12:15], a[156:159], v[140:143], a[12:15]
    s_cmp_ge_u32 s100, 2
    s_cselect_b32 s27, 256, 0
    s_sub_u32 s24, s24, s27
    s_sub_u32 s25, s25, s27
    buffer_load_dwordx4 v[136:139], v5, s[16:19], s24 offen
    buffer_load_dwordx4 v[140:143], v5, s[16:19], s25 offen
    s_add_u32 s24, s24, 256
    s_add_u32 s25, s25, 256
    s_waitcnt vmcnt(40)
    v_mfma_f32_16x16x32_bf16 a[0:3], a[160:163], v[144:147], a[0:3]
    v_mfma_f32_16x16x32_bf16 a[4:7], a[164:167], v[144:147], a[4:7]
    v_mfma_f32_16x16x32_bf16 a[8:11], a[160:163], v[148:151], a[8:11]
    v_mfma_f32_16x16x32_bf16 a[12:15], a[164:167], v[148:151], a[12:15]
    s_waitcnt vmcnt(38)
    v_mfma_f32_16x16x32_bf16 a[0:3], a[168:171], v[152:155], a[0:3]
    v_mfma_f32_16x16x32_bf16 a[4:7], a[172:175], v[152:155], a[4:7]
    v_mfma_f32_16x16x32_bf16 a[8:11], a[168:171], v[156:159], a[8:11]
    v_mfma_f32_16x16x32_bf16 a[12:15], a[172:175], v[156:159], a[12:15]
    s_waitcnt vmcnt(36)
    v_mfma_f32_16x16x32_bf16 a[0:3], a[176:179], v[160:163], a[0:3]
    v_mfma_f32_16x16x32_bf16 a[4:7], a[180:183], v[160:163], a[4:7]
    v_mfma_f32_16x16x32_bf16 a[8:11], a[176:179], v[164:167], a[8:11]
    v_mfma_f32_16x16x32_bf16 a[12:15], a[180:183], v[164:167], a[12:15]
    s_waitcnt vmcnt(34)
    v_mfma_f32_16x16x32_bf16 a[0:3], a[184:187], v[168:171], a[0:3]
    v_mfma_f32_16x16x32_bf16 a[4:7], a[188:191], v[168:171], a[4:7]
    v_mfma_f32_16x16x32_bf16 a[8:11], a[184:187], v[172:175], a[8:11]
    v_mfma_f32_16x16x32_bf16 a[12:15], a[188:191], v[172:175], a[12:15]
    s_waitcnt vmcnt(32)
    v_mfma_f32_16x16x32_bf16 a[0:3], a[192:195], v[176:179], a[0:3]
    v_mfma_f32_16x16x32_bf16 a[4:7], a[196:199], v[176:179], a[4:7]
    v_mfma_f32_16x16x32_bf16 a[8:11], a[192:195], v[180:183], a[8:11]
    v_mfma_f32_16x16x32_bf16 a[12:15], a[196:199], v[180:183], a[12:15]
    s_waitcnt vmcnt(30)
    v_mfma_f32_16x16x32_bf16 a[0:3], a[200:203], v[16:19], a[0:3]
    v_mfma_f32_16x16x32_bf16 a[4:7], a[204:207], v[16:19], a[4:7]
    v_mfma_f32_16x16x32_bf16 a[8:11], a[200:203], v[20:23], a[8:11]
    v_mfma_f32_16x16x32_bf16 a[12:15], a[204:207], v[20:23], a[12:15]
    s_waitcnt vmcnt(28)
    v_mfma_f32_16x16x32_bf16 a[0:3], a[208:211], v[24:27], a[0:3]
    v_mfma_f32_16x16x32_bf16 a[4:7], a[212:215], v[24:27], a[4:7]
    v_mfma_f32_16x16x32_bf16 a[8:11], a[208:211], v[28:31], a[8:11]
    v_mfma_f32_16x16x32_bf16 a[12:15], a[212:215], v[28:31], a[12:15]
    s_waitcnt vmcnt(26)
    v_mfma_f32_16x16x32_bf16 a[0:3], a[216:219], v[32:35], a[0:3]
    v_mfma_f32_16x16x32_bf16 a[4:7], a[220:223], v[32:35], a[4:7]
    v_mfma_f32_16x16x32_bf16 a[8:11], a[216:219], v[36:39], a[8:11]
    v_mfma_f32_16x16x32_bf16 a[12:15], a[220:223], v[36:39], a[12:15]
    s_waitcnt vmcnt(24)
    v_mfma_f32_16x16x32_bf16 a[0:3], a[224:227], v[40:43], a[0:3]
    v_mfma_f32_16x16x32_bf16 a[4:7], a[228:231], v[40:43], a[4:7]
    v_mfma_f32_16x16x32_bf16 a[8:11], a[224:227], v[44:47], a[8:11]
    v_mfma_f32_16x16x32_bf16 a[12:15], a[228:231], v[44:47], a[12:15]
    s_waitcnt vmcnt(22)
    v_mfma_f32_16x16x32_bf16 a[0:3], a[232:235], v[48:51], a[0:3]
    v_mfma_f32_16x16x32_bf16 a[4:7], a[236:239], v[48:51], a[4:7]
    v_mfma_f32_16x16x32_bf16 a[8:11], a[232:235], v[52:55], a[8:11]
    v_mfma_f32_16x16x32_bf16 a[12:15], a[236:239], v[52:55], a[12:15]
    s_waitcnt vmcnt(20)
    v_mfma_f32_16x16x32_bf16 a[0:3], a[240:243], v[56:59], a[0:3]
    v_mfma_f32_16x16x32_bf16 a[4:7], a[244:247], v[56:59], a[4:7]
    v_mfma_f32_16x16x32_bf16 a[8:11], a[240:243], v[60:63], a[8:11]
    v_mfma_f32_16x16x32_bf16 a[12:15], a[244:247], v[60:63], a[12:15]
    s_waitcnt vmcnt(18)
    v_mfma_f32_16x16x32_bf16 a[0:3], a[248:251], v[64:67], a[0:3]
    v_mfma_f32_16x16x32_bf16 a[4:7], a[252:255], v[64:67], a[4:7]
    v_mfma_f32_16x16x32_bf16 a[8:11], a[248:251], v[68:71], a[8:11]
    v_mfma_f32_16x16x32_bf16 a[12:15], a[252:255], v[68:71], a[12:15]
    s_waitcnt vmcnt(16)
    v_mfma_f32_16x16x32_bf16 a[0:3], v[184:187], v[72:75], a[0:3]
    v_mfma_f32_16x16x32_bf16 a[4:7], v[188:191], v[72:75], a[4:7]
    v_mfma_f32_16x16x32_bf16 a[8:11], v[184:187], v[76:79], a[8:11]
    v_mfma_f32_16x16x32_bf16 a[12:15], v[188:191], v[76:79], a[12:15]
    s_waitcnt vmcnt(14)
    v_mfma_f32_16x16x32_bf16 a[0:3], v[192:195], v[80:83], a[0:3]
    v_mfma_f32_16x16x32_bf16 a[4:7], v[196:199], v[80:83], a[4:7]
    v_mfma_f32_16x16x32_bf16 a[8:11], v[192:195], v[84:87], a[8:11]
    v_mfma_f32_16x16x32_bf16 a[12:15], v[196:199], v[84:87], a[12:15]
    s_waitcnt vmcnt(12)
    v_mfma_f32_16x16x32_bf16 a[0:3], v[200:203], v[88:91], a[0:3]
    v_mfma_f32_16x16x32_bf16 a[4:7], v[204:207], v[88:91], a[4:7]
    v_mfma_f32_16x16x32_bf16 a[8:11], v[200:203], v[92:95], a[8:11]
    v_mfma_f32_16x16x32_bf16 a[12:15], v[204:207], v[92:95], a[12:15]
    s_waitcnt vmcnt(10)
    v_mfma_f32_16x16x32_bf16 a[0:3], v[208:211], v[96:99], a[0:3]
    v_mfma_f32_16x16x32_bf16 a[4:7], v[212:215], v[96:99], a[4:7]
    v_mfma_f32_16x16x32_bf16 a[8:11], v[208:211], v[100:103], a[8:11]
    v_mfma_f32_16x16x32_bf16 a[12:15], v[212:215], v[100:103], a[12:15]
    s_waitcnt vmcnt(8)
    v_mfma_f32_16x16x32_bf16 a[16:19], v[216:219], v[104:107], a[16:19]
    v_mfma_f32_16x16x32_bf16 a[20:23], v[220:223], v[104:107], a[20:23]
    v_mfma_f32_16x16x32_bf16 a[24:27], v[216:219], v[108:111], a[24:27]
    v_mfma_f32_16x16x32_bf16 a[28:31], v[220:223], v[108:111], a[28:31]
    s_waitcnt vmcnt(6)
    v_mfma_f32_16x16x32_bf16 a[16:19], v[224:227], v[112:115], a[16:19]
    v_mfma_f32_16x16x32_bf16 a[20:23], v[228:231], v[112:115], a[20:23]
    v_mfma_f32_16x16x32_bf16 a[24:27], v[224:227], v[116:119], a[24:27]
    v_mfma_f32_16x16x32_bf16 a[28:31], v[228:231], v[116:119], a[28:31]
    s_waitcnt vmcnt(4)
    v_mfma_f32_16x16x32_bf16 a[16:19], v[232:235], v[120:123], a[16:19]
    v_mfma_f32_16x16x32_bf16 a[20:23], v[236:239], v[120:123], a[20:23]
    v_mfma_f32_16x16x32_bf16 a[24:27], v[232:235], v[124:127], a[24:27]
    v_mfma_f32_16x16x32_bf16 a[28:31], v[236:239], v[124:127], a[28:31]
    s_waitcnt vmcnt(2)
    v_mfma_f32_16x16x32_bf16 a[16:19], v[240:243], v[128:131], a[16:19]
    v_mfma_f32_16x16x32_bf16 a[20:23], v[244:247], v[128:131], a[20:23]
    v_mfma_f32_16x16x32_bf16 a[24:27], v[240:243], v[132:135], a[24:27]
    v_mfma_f32_16x16x32_bf16 a[28:31], v[244:247], v[132:135], a[28:31]
    s_waitcnt vmcnt(0)
    s_cmp_ge_u32 s100, 2
    s_nop 5
    s_cbranch_scc1 Lfs_70
    v_mfma_f32_16x16x32_bf16 a[16:19], v[248:251], v[136:139], a[16:19]
    v_mfma_f32_16x16x32_bf16 a[20:23], v[252:255], v[136:139], a[20:23]
    v_mfma_f32_16x16x32_bf16 a[24:27], v[248:251], v[140:143], a[24:27]
    v_mfma_f32_16x16x32_bf16 a[28:31], v[252:255], v[140:143], a[28:31]
    s_nop 7
Lfs_70:
    s_mul_i32 s24, s100, 8192
    v_add_u32 v6, s24, v2
    ds_write_b128 v6, a[0:3] offset:0
    ds_write_b128 v6, a[4:7] offset:1024
    ds_write_b128 v6, a[8:11] offset:2048
    ds_write_b128 v6, a[12:15] offset:3072
    ds_write_b128 v6, a[16:19] offset:4096
    ds_write_b128 v6, a[20:23] offset:5120
    ds_write_b128 v6, a[24:27] offset:6144
    ds_write_b128 v6, a[28:31] offset:7168
    s_waitcnt lgkmcnt(0)
    s_barrier
    s_mul_i32 s24, s100, 1024
    v_add_u32 v6, s24, v2
    s_lshr_b32 s25, s100, 1
    s_lshl_b32 s26, s20, 5
    s_lshl_b32 s27, s25, 4
    s_add_u32 s26, s26, s27
    v_add_u32 v7, s26, v3
    v_lshlrev_b32 v8, 2, v7
    s_mov_b32 s27, 92274688
    buffer_load_dword v9, v8, s[16:19], s27 offen
    ds_read_b128 v[16:19], v6 offset:0
    ds_read_b128 v[20:23], v6 offset:8192
    ds_read_b128 v[24:27], v6 offset:16384
    ds_read_b128 v[28:31], v6 offset:24576
    ds_read_b128 v[32:35], v6 offset:4096
    ds_read_b128 v[36:39], v6 offset:12288
    ds_read_b128 v[40:43], v6 offset:20480
    ds_read_b128 v[44:47], v6 offset:28672
    v_mul_u32_u24 v8, 1152, v7
    v_lshl_add_u32 v8, v4, 3, v8
    s_and_b32 s25, s100, 1
    s_mul_i32 s25, s25, 32
    s_mul_i32 s26, s21, 64
    s_add_u32 s25, s25, s26
    v_add_u32 v8, s25, v8
    s_waitcnt vmcnt(0) lgkmcnt(0)
    v_sub_f32 v10, 1.0, v9
    v_mov_b32 v11, v10
    v_cvt_pk_bf16_f32 v12, v10, v11
    v_lshlrev_b32 v10, 16, v12
    v_and_b32 v11, 0xffff0000, v12
    v_pk_add_f32 v[16:17], v[16:17], v[20:21]
    v_pk_add_f32 v[24:25], v[24:25], v[28:29]
    v_pk_add_f32 v[18:19], v[18:19], v[22:23]
    v_pk_add_f32 v[26:27], v[26:27], v[30:31]
    v_pk_add_f32 v[16:17], v[16:17], v[24:25]
    v_pk_add_f32 v[18:19], v[18:19], v[26:27]
    v_pk_add_f32 v[32:33], v[32:33], v[36:37]
    v_pk_add_f32 v[40:41], v[40:41], v[44:45]
    v_pk_add_f32 v[34:35], v[34:35], v[38:39]
    v_pk_add_f32 v[42:43], v[42:43], v[46:47]
    v_pk_add_f32 v[32:33], v[32:33], v[40:41]
    v_pk_add_f32 v[34:35], v[34:35], v[42:43]
    v_cvt_pk_bf16_f32 v12, v16, v17
    v_lshlrev_b32 v16, 16, v12
    v_and_b32 v17, 0xffff0000, v12
    v_cvt_pk_bf16_f32 v12, v18, v19
    v_lshlrev_b32 v18, 16, v12
    v_and_b32 v19, 0xffff0000, v12
    v_cvt_pk_bf16_f32 v12, v32, v33
    v_lshlrev_b32 v32, 16, v12
    v_and_b32 v33, 0xffff0000, v12
    v_cvt_pk_bf16_f32 v12, v34, v35
    v_lshlrev_b32 v34, 16, v12
    v_and_b32 v35, 0xffff0000, v12
    v_mul_f32 v16, v9, v16
    v_mul_f32 v32, v10, v32
    v_mul_f32 v17, v9, v17
    v_mul_f32 v33, v10, v33
    v_mul_f32 v18, v9, v18
    v_mul_f32 v34, v10, v34
    v_mul_f32 v19, v9, v19
    v_mul_f32 v35, v10, v35
    v_cvt_pk_bf16_f32 v12, v16, v17
    v_lshlrev_b32 v16, 16, v12
    v_and_b32 v17, 0xffff0000, v12
    v_cvt_pk_bf16_f32 v12, v18, v19
    v_lshlrev_b32 v18, 16, v12
    v_and_b32 v19, 0xffff0000, v12
    v_cvt_pk_bf16_f32 v12, v32, v33
    v_lshlrev_b32 v32, 16, v12
    v_and_b32 v33, 0xffff0000, v12
    v_cvt_pk_bf16_f32 v12, v34, v35
    v_lshlrev_b32 v34, 16, v12
    v_and_b32 v35, 0xffff0000, v12
    v_add_f32 v16, v16, v32
    v_add_f32 v17, v17, v33
    v_add_f32 v18, v18, v34
    v_add_f32 v19, v19, v35
    v_cvt_pk_bf16_f32 v20, v16, v17
    v_cvt_pk_bf16_f32 v21, v18, v19
    buffer_store_dwordx2 v[20:21], v8, s[8:11], 0 offen offset:0
    s_barrier
    s_branch Lnext_33
Lend_1:
    s_endpgm
.section .rodata,"a"
.p2align 6
.amdhsa_kernel chain_kernel
  .amdhsa_next_free_vgpr 512
  .amdhsa_next_free_sgpr 102
  .amdhsa_accum_offset 256
  .amdhsa_group_segment_fixed_size 0
  .amdhsa_kernarg_size 112
  .amdhsa_user_sgpr_count 2
  .amdhsa_user_sgpr_kernarg_segment_ptr 1
  .amdhsa_system_sgpr_workgroup_id_x 1
.end_amdhsa_kernel
```
